```python
import torch

def _softmax(x, axis=-1):
    return torch.softmax(x, dim=axis)
def _gelu(x):
    return torch.nn.functional.gelu(x, approximate="tanh")
def _silu(x):
    return torch.nn.functional.silu(x)
def _sigmoid(x):
    return torch.sigmoid(x)
def _layernorm(x, axis=-1, eps=1e-5):
    m = x.mean(dim=axis, keepdim=True)
    v = x.var(dim=axis, keepdim=True, unbiased=False)
    return (x - m) / torch.sqrt(v + eps)
def _scatter_add(tgt, idx, src, axis=0):
    return tgt.clone().index_add_(axis, idx, src)
def _segment_sum(src, seg, n):
    out = torch.zeros((n,) + src.shape[1:], dtype=src.dtype)
    return out.index_add_(0, seg, src)
def _pad(x, pw):
    flat = tuple(v for pair in reversed(pw) for v in pair)
    return torch.nn.functional.pad(x, flat)

kernel_name = 'concat_heads__ssm_conv_s4d__mha_block__prompt'

def setup_inputs():

    _w = (lambda a: (lambda t: t.to(torch.bfloat16) if t.is_floating_point() else t)(torch.as_tensor(a)))
    def _A_setup():
        Bsz, L, D, N = 1, 2048, 640, 128
        return {
            "u": _w((lambda *s: torch.randn(*s, dtype=torch.bfloat16) * 0.05)(Bsz, L, D)),
            "log_A_real": _w((lambda *s: torch.randn(*s, dtype=torch.bfloat16) * 3.2)(D, N) * 0.5),
            "A_imag": _w((lambda *s: torch.randn(*s, dtype=torch.bfloat16) * 0.1)(D, N) * 3.14),
            "C_real": _w((lambda *s: torch.randn(*s, dtype=torch.bfloat16) * 1.6)(D, N) / N ** 0.5),
            "C_imag": _w((lambda *s: torch.randn(*s, dtype=torch.bfloat16) * 1.6)(D, N) / N ** 0.5),
            "log_dt": _w((lambda *s: torch.randn(*s, dtype=torch.bfloat16) * 0.1)(D) * 0.5 - 4.0),
            "D_skip": _w((lambda *s: torch.randn(*s, dtype=torch.bfloat16) * 0.1)(D)),
        }
    _A_in = _A_setup()

    def _B_setup():
        B, S, D, H = 1, 2048, 640, 32
        return {
            "x": _w((lambda *s: torch.randn(*s, dtype=torch.bfloat16) * 0.2)(B, S, D)),
            "wqkv": _w((lambda *s: torch.randn(*s, dtype=torch.bfloat16) * 0.2)(D, 3 * D)),
            "wo": _w((lambda *s: torch.randn(*s, dtype=torch.bfloat16) * 0.05)(D, D)),
        }
    _B_in = _B_setup()

    return {
        "A_u": _A_in["u"],
        "A_log_A_real": _A_in["log_A_real"],
        "A_A_imag": _A_in["A_imag"],
        "A_C_real": _A_in["C_real"],
        "A_C_imag": _A_in["C_imag"],
        "A_log_dt": _A_in["log_dt"],
        "A_D_skip": _A_in["D_skip"],
        "B_x": _B_in["x"],
        "B_wqkv": _B_in["wqkv"],
        "B_wo": _B_in["wo"],
    }

def reference(A_u, A_log_A_real, A_A_imag, A_C_real, A_C_imag, A_log_dt, A_D_skip, B_x, B_wqkv, B_wo):
    def _A_ref(u, log_A_real, A_imag, C_real, C_imag, log_dt, D_skip):
        L = u.shape[1]
        dt = torch.exp(log_dt)
        A = -torch.exp(log_A_real) + 1j * A_imag
        C = (C_real + 1j * C_imag) * dt[:, None]
        pos = (lambda x, dt: x.to(dt))(torch.arange(L), log_dt.dtype)
        P = torch.exp((A * dt[:, None])[:, :, None] * pos[None, None, :])
        K = 2.0 * torch.einsum("dn,dnl->dl", C, P).real
        L2 = 2 * L
        u_t = (lambda x, *d: x.permute(*d))(u, 0, 2, 1)
        Kf = (lambda x, *a, **k: torch.fft.rfft(x.float(), *a, **k))(K, L2)
        Uf = (lambda x, *a, **k: torch.fft.rfft(x.float(), *a, **k))(u_t, L2)
        y = (lambda x, *a, **k: torch.fft.irfft(x, *a, **k).to(torch.bfloat16))(Uf * Kf[None, :, :], L2)[:, :, :L]
        y = (lambda x, *d: x.permute(*d))(y, 0, 2, 1)
        return y + u * D_skip[None, None, :]

    def _B_ref(x, wqkv, wo):
        B, S, D = x.shape
        H = 32
        Dh = D // H
        qkv = (lambda x, *d: x.permute(*d))((x @ wqkv).reshape(B, S, 3, H, Dh), 2, 0, 3, 1, 4)
        q, k, v = qkv[0], qkv[1], qkv[2]
        scores = torch.einsum("bhqd,bhkd->bhqk", q, k) * (Dh ** -0.5)
        p = _softmax(scores, axis=-1)
        o = torch.einsum("bhqk,bhkd->bhqd", p, v)
        return (lambda x, *d: x.permute(*d))(o, 0, 2, 1, 3).reshape(B, S, D) @ wo

    a = _A_ref(A_u, A_log_A_real, A_A_imag, A_C_real, A_C_imag, A_log_dt, A_D_skip)
    b = _B_ref(B_x, B_wqkv, B_wo)
    return torch.concatenate([a, b], axis=-1)
```

```asm
; @launch grid=(256,1,1) block=(512,1,1) lds=163840
.amdgcn_target "amdgcn-amd-amdhsa--gfx950"
.text
.globl concat_heads__ssm_conv_s4d__mha_block__prompt_kernel
.p2align 8
.type concat_heads__ssm_conv_s4d__mha_block__prompt_kernel,@function
concat_heads__ssm_conv_s4d__mha_block__prompt_kernel:
    s_load_dwordx16 s[64:79], s[0:1], 0
    s_load_dwordx8 s[80:87], s[0:1], 64
    s_load_dwordx2 s[88:89], s[0:1], 96
    s_cmp_ge_u32 s2, 256
    s_cbranch_scc1 L_end
    v_lshrrev_b32 v1, 6, v0
    v_and_b32 v250, 63, v0
    v_readfirstlane_b32 s32, v1
    s_and_b32 s30, s2, 0x38
    s_cbranch_scc1 L_nopf
    s_getpc_b64 s[28:29]
L_pc:
    v_lshlrev_b32 v2, 7, v0
    v_min_u32 v2, (L_codeend-L_pc-4), v2
    global_load_dword v249, v2, s[28:29]
L_nopf:
    s_and_b32 s37, s2, 7
    s_lshr_b32 s38, s2, 3
    s_and_b32 s30, s37, 3
    s_lshl_b32 s30, s30, 2
    s_and_b32 s31, s38, 3
    s_add_u32 s33, s30, s31
    s_lshl_b32 s30, s37, 2
    s_add_u32 s39, s30, s31
    s_lshr_b32 s30, s37, 2
    s_lshl_b32 s30, s30, 3
    s_lshr_b32 s31, s38, 2
    s_add_u32 s34, s30, s31
    s_lshl_b32 s31, s31, 3
    s_add_u32 s40, s31, s32
    s_cmp_eq_u32 s34, 15
    s_cbranch_scc1 L_spare
    s_cmp_lt_u32 s32, 4
    s_cbranch_scc1 L_compute
    s_memrealtime s[60:61]
    s_setprio 2
    s_and_b32 s41, s32, 3
    s_mul_i32 s50, s37, 20
    s_add_u32 s50, s50, s38
    s_lshl_b32 s50, s50, 2
    s_add_u32 s50, s50, s41
    s_cmp_ge_u32 s38, 20
    s_cbranch_scc1 L_a_np
    v_lshlrev_b32 v240, 2, v250
    s_lshl_b32 s30, s50, 8
    v_add_u32 v240, s30, v240
    s_lshl_b32 s30, s50, 1
    v_mov_b32 v241, s30
    s_waitcnt lgkmcnt(0)
    global_load_ushort v148, v241, s[74:75]
    global_load_dword v144, v240, s[66:67]
    global_load_dword v145, v240, s[68:69]
    global_load_dword v146, v240, s[70:71]
    global_load_dword v147, v240, s[72:73]
    global_load_ushort v149, v241, s[76:77]
L_a_np:
    s_waitcnt lgkmcnt(0)
    v_mov_b32 v244, 0
    v_lshlrev_b32 v242, 2, v250
    v_min_u32 v242, 124, v242
    v_add_u32 v242, 163712, v242
    ds_write_b32 v242, v244
    s_or_b32 s30, s2, s41
    s_cmp_lg_u32 s30, 0
    s_cbranch_scc1 L_a_nonn
    s_or_b32 s61, s61, 0x80000000
    v_mov_b32 v240, s60
    v_mov_b32 v241, s61
    v_mov_b32 v242, 0
    v_mov_b32 v243, 0
    s_mov_b64 exec, 1
    global_atomic_cmpswap_x2 v244, v[240:243], s[86:87] sc1
    s_mov_b64 exec, -1
    s_nop 1
L_a_nonn:
    s_waitcnt lgkmcnt(0)
    s_barrier
    s_and_b32 s41, s32, 3
    v_lshrrev_b32 v240, 4, v250
    v_and_b32 v243, 1, v240
    v_lshlrev_b32 v243, 2, v243
    v_and_b32 v241, 7, v250
    v_xor_b32 v243, v243, v241
    v_lshlrev_b32 v243, 4, v243
    v_lshrrev_b32 v241, 3, v250
    v_mul_u32_u24 v241, 1280, v241
    v_add_u32 v243, v243, v241
    s_mul_i32 s30, s41, 10240
    s_mul_i32 s31, s33, 163840
    s_add_u32 s30, s30, s31
    v_add_u32 v220, s30, v243
    v_add_u32 v221, 40960, v220
    v_add_u32 v222, 81920, v220
    v_add_u32 v223, 122880, v220
    v_lshlrev_b32 v241, 2, v240
    v_and_b32 v242, 15, v250
    v_xor_b32 v241, v241, v242
    v_lshlrev_b32 v241, 4, v241
    v_mul_u32_u24 v240, 3840, v240
    v_add_u32 v240, v240, v241
    s_mul_i32 s30, s41, 15360
    s_lshl_b32 s31, s34, 8
    s_add_u32 s30, s30, s31
    v_add_u32 v234, s30, v240
    v_add_u32 v235, 61440, v234
    v_add_u32 v236, 122880, v234
    v_add_u32 v237, 184320, v234
    s_lshr_b32 s30, s38, 2
    s_add_u32 s30, s30, s38
    s_and_b32 s30, s30, 3
    s_lshl_b32 s30, s30, 2
    s_lshr_b32 s0, 0x8530, s30
    s_and_b32 s0, s0, 15
    s_lshl_b32 s46, s0, 7
    s_mul_i32 s47, s0, 245760
    s_mul_i32 s3, s41, 1040
    s_lshl_b32 s1, s41, 4
    s_sub_u32 s1, 16640, s1
    s_waitcnt lgkmcnt(0)
    s_mov_b32 s8, s78
    s_and_b32 s9, s79, 0xffff
    s_mov_b32 s10, 2621440
    s_mov_b32 s11, 0x00020000
    s_mov_b32 s12, s80
    s_and_b32 s13, s81, 0xffff
    s_mov_b32 s14, 2457600
    s_mov_b32 s15, 0x00020000
    s_mov_b32 s16, s88
    s_and_b32 s17, s89, 0xffff
    s_mov_b32 s18, 33554432
    s_mov_b32 s19, 0x00020000
    s_mov_b32 s20, s64
    s_and_b32 s21, s65, 0xffff
    s_mov_b32 s22, 2621440
    s_mov_b32 s23, 0x00020000
    v_lshrrev_b32 v238, 3, v250
    v_mul_u32_u24 v238, 1280, v238
    v_and_b32 v239, 7, v250
    v_lshl_add_u32 v238, v239, 4, v238
    v_bfe_u32 v239, v250, 2, 2
    v_lshlrev_b32 v239, 7, v239
    v_lshrrev_b32 v201, 4, v250
    v_lshl_add_u32 v239, v201, 5, v239
    v_and_b32 v201, 3, v250
    v_lshl_add_u32 v239, v201, 3, v239
    s_mul_i32 s94, s32, 3072
    s_add_u32 s94, s94, 86784
    v_add_u32 v239, s94, v239
    v_lshlrev_b32 v201, 4, v250
    s_mul_i32 s95, s2, 10240
    s_sub_u32 s90, s32, 4
    s_mov_b32 s91, s32
    s_add_u32 s92, s32, 4
    s_min_u32 s92, s92, 9
    s_mov_b32 s61, 0
    s_mul_i32 s51, s41, 9216
    s_add_u32 s51, s51, 126720
    s_mul_i32 s93, s41, 8464
    s_add_u32 s93, s93, 92864
    s_add_u32 s0, s0, 5
    s_sub_u32 s30, s0, 10
    s_cmp_ge_u32 s0, 10
    s_cselect_b32 s0, s30, s0
    s_lshl_b32 s46, s0, 7
    s_mul_i32 s47, s0, 245760
    s_add_u32 s3, s3, 66048
    s_cmp_ge_u32 s38, 20
    s_cbranch_scc1 L_a_plain
    v_bfe_u32 v8, v250, 1, 2
    v_lshlrev_b32 v8, 4, v8
    v_lshl_add_u32 v8, v250, 6, v8
    v_add_u32 v0, s51, v8
    v_xor_b32 v1, 16, v0
    v_xor_b32 v2, 32, v0
    v_xor_b32 v3, 48, v0
    v_lshrrev_b32 v8, 5, v250
    v_bfe_u32 v9, v250, 2, 2
    v_lshl_add_u32 v8, v8, 3, v9
    v_bfe_u32 v9, v250, 4, 1
    v_bfe_u32 v10, v250, 1, 1
    v_lshl_add_u32 v9, v9, 1, v10
    v_bfe_u32 v10, v250, 3, 1
    v_xor_b32 v9, v9, v10
    v_lshlrev_b32 v9, 4, v9
    v_lshl_add_u32 v8, v8, 6, v9
    v_and_b32 v9, 1, v250
    v_lshl_add_u32 v8, v9, 3, v8
    v_add_u32 v4, s51, v8
    v_xor_b32 v5, 32, v4
    s_mov_b32 s24, 0x3fb8aa3b
    s_mov_b32 s25, 0x32a57060
    s_mov_b32 s26, 0x3f317218
    s_mov_b32 s27, 0x3e22f983
    s_waitcnt vmcnt(0)
    v_lshlrev_b32 v148, 16, v148
    v_mul_f32 v8, s24, v148
    v_fma_f32 v9, v148, s24, -v8
    v_fma_f32 v9, v148, s25, v9
    v_exp_f32 v8, v8
    v_mul_f32 v9, s26, v9
    v_fma_f32 v8, v8, v9, v8
    v_cvt_pk_bf16_f32 v8, v8, v8
    v_lshlrev_b32 v21, 16, v8
    v_add_f32 v22, v21, v21
    v_lshlrev_b32 v60, 16, v144
    v_lshlrev_b32 v61, 16, v145
    v_lshlrev_b32 v62, 16, v146
    v_lshlrev_b32 v63, 16, v147
    v_mul_f32 v10, s24, v60
    v_fma_f32 v11, v60, s24, -v10
    v_fma_f32 v11, v60, s25, v11
    v_exp_f32 v10, v10
    v_mul_f32 v11, s26, v11
    v_fma_f32 v10, v10, v11, v10
    v_cvt_pk_bf16_f32 v10, v10, v10
    v_lshlrev_b32 v60, 16, v10
    v_mul_f32 v23, v60, v21
    v_mul_f32 v7, v61, v21
    v_mul_f32 v23, s24, v23
    v_mul_f32 v7, s27, v7
    v_sub_f32 v23, 0, v23
    v_mul_f32 v218, v62, v22
    v_mul_f32 v219, v63, v22
    v_mul_f32 v8, 0x41000000, v23
    v_mul_f32 v10, 0x3f800000, v23
    v_mul_f32 v12, 0x43800000, v23
    v_mul_f32 v9, 0x41000000, v7
    v_mul_f32 v11, 0x3f800000, v7
    v_mul_f32 v13, 0x43800000, v7
    v_exp_f32 v8, v8
    v_exp_f32 v10, v10
    v_exp_f32 v12, v12
    v_fract_f32 v9, v9
    v_fract_f32 v11, v11
    v_fract_f32 v13, v13
    v_cos_f32 v212, v9
    v_cos_f32 v214, v11
    v_cos_f32 v216, v13
    v_sin_f32 v213, v9
    v_sin_f32 v215, v11
    v_sin_f32 v217, v13
    v_mul_f32 v212, v212, v8
    v_mul_f32 v214, v214, v10
    v_mul_f32 v216, v216, v12
    v_mul_f32 v213, v213, v8
    v_mul_f32 v215, v215, v10
    v_mul_f32 v217, v217, v12
    v_and_b32 v60, 0xffff0000, v144
    v_and_b32 v61, 0xffff0000, v145
    v_and_b32 v62, 0xffff0000, v146
    v_and_b32 v63, 0xffff0000, v147
    v_mul_f32 v10, s24, v60
    v_fma_f32 v11, v60, s24, -v10
    v_fma_f32 v11, v60, s25, v11
    v_exp_f32 v10, v10
    v_mul_f32 v11, s26, v11
    v_fma_f32 v10, v10, v11, v10
    v_cvt_pk_bf16_f32 v10, v10, v10
    v_lshlrev_b32 v60, 16, v10
    v_mul_f32 v23, v60, v21
    v_mul_f32 v7, v61, v21
    v_mul_f32 v23, s24, v23
    v_mul_f32 v7, s27, v7
    v_sub_f32 v23, 0, v23
    v_mul_f32 v158, v62, v22
    v_mul_f32 v159, v63, v22
    v_mul_f32 v8, 0x41000000, v23
    v_mul_f32 v10, 0x3f800000, v23
    v_mul_f32 v12, 0x43800000, v23
    v_mul_f32 v9, 0x41000000, v7
    v_mul_f32 v11, 0x3f800000, v7
    v_mul_f32 v13, 0x43800000, v7
    v_exp_f32 v8, v8
    v_exp_f32 v10, v10
    v_exp_f32 v12, v12
    v_fract_f32 v9, v9
    v_fract_f32 v11, v11
    v_fract_f32 v13, v13
    v_cos_f32 v152, v9
    v_cos_f32 v154, v11
    v_cos_f32 v156, v13
    v_sin_f32 v153, v9
    v_sin_f32 v155, v11
    v_sin_f32 v157, v13
    v_mul_f32 v152, v152, v8
    v_mul_f32 v154, v154, v10
    v_mul_f32 v156, v156, v12
    v_mul_f32 v153, v153, v8
    v_mul_f32 v155, v155, v10
    v_mul_f32 v157, v157, v12
    v_mov_b32 v50, v212
    v_mov_b32 v51, v213
    v_mov_b32 v48, 1.0
    v_mov_b32 v49, 0
    v_pk_mul_f32 v[12:13], v[50:51], v[50:51] op_sel:[0,0] op_sel_hi:[0,1]
    v_pk_mul_f32 v[16:17], v[214:215], v[214:215] op_sel:[0,0] op_sel_hi:[0,1]
    v_pk_mul_f32 v[18:19], v[216:217], v[216:217] op_sel:[0,0] op_sel_hi:[0,1]
    v_pk_fma_f32 v[52:53], v[50:51], v[50:51], v[12:13] op_sel:[1,1,0] op_sel_hi:[1,0,1] neg_lo:[0,1,0]
    v_pk_fma_f32 v[8:9], v[214:215], v[214:215], v[16:17] op_sel:[1,1,0] op_sel_hi:[1,0,1] neg_lo:[0,1,0]
    v_pk_fma_f32 v[20:21], v[216:217], v[216:217], v[18:19] op_sel:[1,1,0] op_sel_hi:[1,0,1] neg_lo:[0,1,0]
    v_pk_mul_f32 v[12:13], v[52:53], v[50:51] op_sel:[0,0] op_sel_hi:[0,1]
    v_pk_mul_f32 v[16:17], v[52:53], v[52:53] op_sel:[0,0] op_sel_hi:[0,1]
    v_pk_mul_f32 v[18:19], v[8:9], v[8:9] op_sel:[0,0] op_sel_hi:[0,1]
    v_pk_mul_f32 v[150:151], v[20:21], v[20:21] op_sel:[0,0] op_sel_hi:[0,1]
    v_pk_fma_f32 v[54:55], v[52:53], v[50:51], v[12:13] op_sel:[1,1,0] op_sel_hi:[1,0,1] neg_lo:[0,1,0]
    v_pk_fma_f32 v[56:57], v[52:53], v[52:53], v[16:17] op_sel:[1,1,0] op_sel_hi:[1,0,1] neg_lo:[0,1,0]
    v_pk_fma_f32 v[10:11], v[8:9], v[8:9], v[18:19] op_sel:[1,1,0] op_sel_hi:[1,0,1] neg_lo:[0,1,0]
    v_pk_fma_f32 v[22:23], v[20:21], v[20:21], v[150:151] op_sel:[1,1,0] op_sel_hi:[1,0,1] neg_lo:[0,1,0]
    v_pk_mul_f32 v[12:13], v[50:51], v[56:57] op_sel:[0,0] op_sel_hi:[0,1]
    v_pk_mul_f32 v[16:17], v[52:53], v[56:57] op_sel:[0,0] op_sel_hi:[0,1]
    v_pk_mul_f32 v[18:19], v[54:55], v[56:57] op_sel:[0,0] op_sel_hi:[0,1]
    v_pk_mul_f32 v[150:151], v[56:57], v[56:57] op_sel:[0,0] op_sel_hi:[0,1]
    v_pk_fma_f32 v[58:59], v[50:51], v[56:57], v[12:13] op_sel:[1,1,0] op_sel_hi:[1,0,1] neg_lo:[0,1,0]
    v_pk_fma_f32 v[60:61], v[52:53], v[56:57], v[16:17] op_sel:[1,1,0] op_sel_hi:[1,0,1] neg_lo:[0,1,0]
    v_pk_fma_f32 v[62:63], v[54:55], v[56:57], v[18:19] op_sel:[1,1,0] op_sel_hi:[1,0,1] neg_lo:[0,1,0]
    v_pk_fma_f32 v[64:65], v[56:57], v[56:57], v[150:151] op_sel:[1,1,0] op_sel_hi:[1,0,1] neg_lo:[0,1,0]
    v_pk_mul_f32 v[12:13], v[58:59], v[56:57] op_sel:[0,0] op_sel_hi:[0,1]
    v_pk_mul_f32 v[16:17], v[60:61], v[56:57] op_sel:[0,0] op_sel_hi:[0,1]
    v_pk_mul_f32 v[18:19], v[62:63], v[56:57] op_sel:[0,0] op_sel_hi:[0,1]
    v_pk_mul_f32 v[150:151], v[64:65], v[56:57] op_sel:[0,0] op_sel_hi:[0,1]
    v_pk_fma_f32 v[66:67], v[58:59], v[56:57], v[12:13] op_sel:[1,1,0] op_sel_hi:[1,0,1] neg_lo:[0,1,0]
    v_pk_fma_f32 v[68:69], v[60:61], v[56:57], v[16:17] op_sel:[1,1,0] op_sel_hi:[1,0,1] neg_lo:[0,1,0]
    v_pk_fma_f32 v[70:71], v[62:63], v[56:57], v[18:19] op_sel:[1,1,0] op_sel_hi:[1,0,1] neg_lo:[0,1,0]
    v_pk_fma_f32 v[72:73], v[64:65], v[56:57], v[150:151] op_sel:[1,1,0] op_sel_hi:[1,0,1] neg_lo:[0,1,0]
    v_cvt_pk_bf16_f32 v24, v48, v50
    v_cvt_pk_bf16_f32 v25, v52, v54
    v_cvt_pk_bf16_f32 v26, v56, v58
    v_cvt_pk_bf16_f32 v27, v60, v62
    ds_write_b128 v0, v[24:27] offset:0
    v_pk_mul_f32 v[12:13], v[66:67], v[56:57] op_sel:[0,0] op_sel_hi:[0,1]
    v_pk_mul_f32 v[16:17], v[68:69], v[56:57] op_sel:[0,0] op_sel_hi:[0,1]
    v_pk_mul_f32 v[18:19], v[70:71], v[56:57] op_sel:[0,0] op_sel_hi:[0,1]
    v_pk_mul_f32 v[150:151], v[72:73], v[56:57] op_sel:[0,0] op_sel_hi:[0,1]
    v_pk_fma_f32 v[74:75], v[66:67], v[56:57], v[12:13] op_sel:[1,1,0] op_sel_hi:[1,0,1] neg_lo:[0,1,0]
    v_pk_fma_f32 v[76:77], v[68:69], v[56:57], v[16:17] op_sel:[1,1,0] op_sel_hi:[1,0,1] neg_lo:[0,1,0]
    v_pk_fma_f32 v[78:79], v[70:71], v[56:57], v[18:19] op_sel:[1,1,0] op_sel_hi:[1,0,1] neg_lo:[0,1,0]
    v_pk_fma_f32 v[80:81], v[72:73], v[56:57], v[150:151] op_sel:[1,1,0] op_sel_hi:[1,0,1] neg_lo:[0,1,0]
    v_cvt_pk_bf16_f32 v28, v49, v51
    v_cvt_pk_bf16_f32 v29, v53, v55
    v_cvt_pk_bf16_f32 v30, v57, v59
    v_cvt_pk_bf16_f32 v31, v61, v63
    ds_write_b128 v0, v[28:31] offset:4096
    v_pk_mul_f32 v[12:13], v[74:75], v[56:57] op_sel:[0,0] op_sel_hi:[0,1]
    v_pk_mul_f32 v[16:17], v[76:77], v[56:57] op_sel:[0,0] op_sel_hi:[0,1]
    v_pk_mul_f32 v[18:19], v[78:79], v[56:57] op_sel:[0,0] op_sel_hi:[0,1]
    v_pk_mul_f32 v[150:151], v[80:81], v[56:57] op_sel:[0,0] op_sel_hi:[0,1]
    v_pk_fma_f32 v[82:83], v[74:75], v[56:57], v[12:13] op_sel:[1,1,0] op_sel_hi:[1,0,1] neg_lo:[0,1,0]
    v_pk_fma_f32 v[84:85], v[76:77], v[56:57], v[16:17] op_sel:[1,1,0] op_sel_hi:[1,0,1] neg_lo:[0,1,0]
    v_pk_fma_f32 v[86:87], v[78:79], v[56:57], v[18:19] op_sel:[1,1,0] op_sel_hi:[1,0,1] neg_lo:[0,1,0]
    v_pk_fma_f32 v[88:89], v[80:81], v[56:57], v[150:151] op_sel:[1,1,0] op_sel_hi:[1,0,1] neg_lo:[0,1,0]
    v_cvt_pk_bf16_f32 v24, v64, v66
    v_cvt_pk_bf16_f32 v25, v68, v70
    v_cvt_pk_bf16_f32 v26, v72, v74
    v_cvt_pk_bf16_f32 v27, v76, v78
    ds_write_b128 v1, v[24:27] offset:0
    v_pk_mul_f32 v[12:13], v[82:83], v[56:57] op_sel:[0,0] op_sel_hi:[0,1]
    v_pk_mul_f32 v[16:17], v[84:85], v[56:57] op_sel:[0,0] op_sel_hi:[0,1]
    v_pk_mul_f32 v[18:19], v[86:87], v[56:57] op_sel:[0,0] op_sel_hi:[0,1]
    v_pk_mul_f32 v[150:151], v[88:89], v[56:57] op_sel:[0,0] op_sel_hi:[0,1]
    v_pk_fma_f32 v[90:91], v[82:83], v[56:57], v[12:13] op_sel:[1,1,0] op_sel_hi:[1,0,1] neg_lo:[0,1,0]
    v_pk_fma_f32 v[92:93], v[84:85], v[56:57], v[16:17] op_sel:[1,1,0] op_sel_hi:[1,0,1] neg_lo:[0,1,0]
    v_pk_fma_f32 v[94:95], v[86:87], v[56:57], v[18:19] op_sel:[1,1,0] op_sel_hi:[1,0,1] neg_lo:[0,1,0]
    v_pk_fma_f32 v[96:97], v[88:89], v[56:57], v[150:151] op_sel:[1,1,0] op_sel_hi:[1,0,1] neg_lo:[0,1,0]
    v_cvt_pk_bf16_f32 v28, v65, v67
    v_cvt_pk_bf16_f32 v29, v69, v71
    v_cvt_pk_bf16_f32 v30, v73, v75
    v_cvt_pk_bf16_f32 v31, v77, v79
    ds_write_b128 v1, v[28:31] offset:4096
    v_pk_mul_f32 v[12:13], v[90:91], v[56:57] op_sel:[0,0] op_sel_hi:[0,1]
    v_pk_mul_f32 v[16:17], v[92:93], v[56:57] op_sel:[0,0] op_sel_hi:[0,1]
    v_pk_mul_f32 v[18:19], v[94:95], v[56:57] op_sel:[0,0] op_sel_hi:[0,1]
    v_pk_mul_f32 v[150:151], v[96:97], v[56:57] op_sel:[0,0] op_sel_hi:[0,1]
    v_pk_fma_f32 v[98:99], v[90:91], v[56:57], v[12:13] op_sel:[1,1,0] op_sel_hi:[1,0,1] neg_lo:[0,1,0]
    v_pk_fma_f32 v[100:101], v[92:93], v[56:57], v[16:17] op_sel:[1,1,0] op_sel_hi:[1,0,1] neg_lo:[0,1,0]
    v_pk_fma_f32 v[102:103], v[94:95], v[56:57], v[18:19] op_sel:[1,1,0] op_sel_hi:[1,0,1] neg_lo:[0,1,0]
    v_pk_fma_f32 v[104:105], v[96:97], v[56:57], v[150:151] op_sel:[1,1,0] op_sel_hi:[1,0,1] neg_lo:[0,1,0]
    v_cvt_pk_bf16_f32 v24, v80, v82
    v_cvt_pk_bf16_f32 v25, v84, v86
    v_cvt_pk_bf16_f32 v26, v88, v90
    v_cvt_pk_bf16_f32 v27, v92, v94
    ds_write_b128 v2, v[24:27] offset:0
    v_pk_mul_f32 v[12:13], v[98:99], v[56:57] op_sel:[0,0] op_sel_hi:[0,1]
    v_pk_mul_f32 v[16:17], v[100:101], v[56:57] op_sel:[0,0] op_sel_hi:[0,1]
    v_pk_mul_f32 v[18:19], v[102:103], v[56:57] op_sel:[0,0] op_sel_hi:[0,1]
    v_pk_mul_f32 v[150:151], v[218:219], v[214:215] op_sel:[0,0] op_sel_hi:[0,1]
    v_pk_fma_f32 v[106:107], v[98:99], v[56:57], v[12:13] op_sel:[1,1,0] op_sel_hi:[1,0,1] neg_lo:[0,1,0]
    v_pk_fma_f32 v[108:109], v[100:101], v[56:57], v[16:17] op_sel:[1,1,0] op_sel_hi:[1,0,1] neg_lo:[0,1,0]
    v_pk_fma_f32 v[110:111], v[102:103], v[56:57], v[18:19] op_sel:[1,1,0] op_sel_hi:[1,0,1] neg_lo:[0,1,0]
    v_pk_fma_f32 v[50:51], v[218:219], v[214:215], v[150:151] op_sel:[1,1,0] op_sel_hi:[1,0,1] neg_lo:[0,1,0]
    v_cvt_pk_bf16_f32 v28, v81, v83
    v_cvt_pk_bf16_f32 v29, v85, v87
    v_cvt_pk_bf16_f32 v30, v89, v91
    v_cvt_pk_bf16_f32 v31, v93, v95
    ds_write_b128 v2, v[28:31] offset:4096
    v_mov_b64 v[48:49], v[218:219]
    v_pk_mul_f32 v[12:13], v[218:219], v[8:9] op_sel:[0,0] op_sel_hi:[0,1]
    v_pk_mul_f32 v[16:17], v[50:51], v[8:9] op_sel:[0,0] op_sel_hi:[0,1]
    v_pk_mul_f32 v[18:19], v[218:219], v[10:11] op_sel:[0,0] op_sel_hi:[0,1]
    v_pk_mul_f32 v[150:151], v[50:51], v[10:11] op_sel:[0,0] op_sel_hi:[0,1]
    v_pk_fma_f32 v[52:53], v[218:219], v[8:9], v[12:13] op_sel:[1,1,0] op_sel_hi:[1,0,1] neg_lo:[0,1,0]
    v_pk_fma_f32 v[54:55], v[50:51], v[8:9], v[16:17] op_sel:[1,1,0] op_sel_hi:[1,0,1] neg_lo:[0,1,0]
    v_pk_fma_f32 v[56:57], v[218:219], v[10:11], v[18:19] op_sel:[1,1,0] op_sel_hi:[1,0,1] neg_lo:[0,1,0]
    v_pk_fma_f32 v[58:59], v[50:51], v[10:11], v[150:151] op_sel:[1,1,0] op_sel_hi:[1,0,1] neg_lo:[0,1,0]
    v_cvt_pk_bf16_f32 v24, v96, v98
    v_cvt_pk_bf16_f32 v25, v100, v102
    v_cvt_pk_bf16_f32 v26, v104, v106
    v_cvt_pk_bf16_f32 v27, v108, v110
    ds_write_b128 v3, v[24:27] offset:0
    v_pk_mul_f32 v[12:13], v[52:53], v[10:11] op_sel:[0,0] op_sel_hi:[0,1]
    v_pk_mul_f32 v[16:17], v[54:55], v[10:11] op_sel:[0,0] op_sel_hi:[0,1]
    v_pk_mul_f32 v[18:19], v[56:57], v[10:11] op_sel:[0,0] op_sel_hi:[0,1]
    v_pk_mul_f32 v[150:151], v[218:219], v[216:217] op_sel:[0,0] op_sel_hi:[0,1]
    v_pk_fma_f32 v[60:61], v[52:53], v[10:11], v[12:13] op_sel:[1,1,0] op_sel_hi:[1,0,1] neg_lo:[0,1,0]
    v_pk_fma_f32 v[62:63], v[54:55], v[10:11], v[16:17] op_sel:[1,1,0] op_sel_hi:[1,0,1] neg_lo:[0,1,0]
    v_pk_fma_f32 v[64:65], v[56:57], v[10:11], v[18:19] op_sel:[1,1,0] op_sel_hi:[1,0,1] neg_lo:[0,1,0]
    v_pk_fma_f32 v[66:67], v[218:219], v[216:217], v[150:151] op_sel:[1,1,0] op_sel_hi:[1,0,1] neg_lo:[0,1,0]
    v_cvt_pk_bf16_f32 v28, v97, v99
    v_cvt_pk_bf16_f32 v29, v101, v103
    v_cvt_pk_bf16_f32 v30, v105, v107
    v_cvt_pk_bf16_f32 v31, v109, v111
    ds_write_b128 v3, v[28:31] offset:4096
    ds_read_b64_tr_b16 v[112:113], v4 offset:0
    ds_read_b64_tr_b16 v[114:115], v5 offset:256
    ds_read_b64_tr_b16 v[116:117], v4 offset:1024
    ds_read_b64_tr_b16 v[118:119], v5 offset:1280
    ds_read_b64_tr_b16 v[120:121], v4 offset:2048
    ds_read_b64_tr_b16 v[122:123], v5 offset:2304
    ds_read_b64_tr_b16 v[124:125], v4 offset:3072
    ds_read_b64_tr_b16 v[126:127], v5 offset:3328
    v_pk_mul_f32 v[12:13], v[52:53], v[216:217] op_sel:[0,0] op_sel_hi:[0,1]
    v_pk_mul_f32 v[16:17], v[56:57], v[216:217] op_sel:[0,0] op_sel_hi:[0,1]
    v_pk_mul_f32 v[18:19], v[60:61], v[216:217] op_sel:[0,0] op_sel_hi:[0,1]
    v_pk_mul_f32 v[150:151], v[64:65], v[216:217] op_sel:[0,0] op_sel_hi:[0,1]
    v_pk_fma_f32 v[68:69], v[52:53], v[216:217], v[12:13] op_sel:[1,1,0] op_sel_hi:[1,0,1] neg_lo:[0,1,0]
    v_pk_fma_f32 v[70:71], v[56:57], v[216:217], v[16:17] op_sel:[1,1,0] op_sel_hi:[1,0,1] neg_lo:[0,1,0]
    v_pk_fma_f32 v[72:73], v[60:61], v[216:217], v[18:19] op_sel:[1,1,0] op_sel_hi:[1,0,1] neg_lo:[0,1,0]
    v_pk_fma_f32 v[74:75], v[64:65], v[216:217], v[150:151] op_sel:[1,1,0] op_sel_hi:[1,0,1] neg_lo:[0,1,0]
    ds_read_b64_tr_b16 v[128:129], v4 offset:4096
    ds_read_b64_tr_b16 v[130:131], v5 offset:4352
    ds_read_b64_tr_b16 v[132:133], v4 offset:5120
    ds_read_b64_tr_b16 v[134:135], v5 offset:5376
    ds_read_b64_tr_b16 v[136:137], v4 offset:6144
    ds_read_b64_tr_b16 v[138:139], v5 offset:6400
    ds_read_b64_tr_b16 v[140:141], v4 offset:7168
    ds_read_b64_tr_b16 v[142:143], v5 offset:7424
    v_cvt_pk_bf16_f32 v24, v48, v50
    v_cvt_pk_bf16_f32 v25, v52, v54
    v_cvt_pk_bf16_f32 v26, v66, v66
    v_cvt_pk_bf16_f32 v27, v68, v70
    ds_write_b128 v0, v[24:27] offset:0
    v_pk_mul_f32 v[12:13], v[218:219], v[20:21] op_sel:[0,0] op_sel_hi:[0,1]
    v_pk_mul_f32 v[16:17], v[56:57], v[20:21] op_sel:[0,0] op_sel_hi:[0,1]
    v_pk_mul_f32 v[18:19], v[64:65], v[20:21] op_sel:[0,0] op_sel_hi:[0,1]
    v_pk_mul_f32 v[150:151], v[66:67], v[20:21] op_sel:[0,0] op_sel_hi:[0,1]
    v_pk_fma_f32 v[76:77], v[218:219], v[20:21], v[12:13] op_sel:[1,1,0] op_sel_hi:[1,0,1] neg_lo:[0,1,0]
    v_pk_fma_f32 v[78:79], v[56:57], v[20:21], v[16:17] op_sel:[1,1,0] op_sel_hi:[1,0,1] neg_lo:[0,1,0]
    v_pk_fma_f32 v[80:81], v[64:65], v[20:21], v[18:19] op_sel:[1,1,0] op_sel_hi:[1,0,1] neg_lo:[0,1,0]
    v_pk_fma_f32 v[82:83], v[66:67], v[20:21], v[150:151] op_sel:[1,1,0] op_sel_hi:[1,0,1] neg_lo:[0,1,0]
    v_cvt_pk_bf16_f32 v28, v56, v58
    v_cvt_pk_bf16_f32 v29, v60, v62
    v_cvt_pk_bf16_f32 v30, v70, v70
    v_cvt_pk_bf16_f32 v31, v72, v74
    ds_write_b128 v1, v[28:31] offset:0
    v_pk_mul_f32 v[12:13], v[70:71], v[20:21] op_sel:[0,0] op_sel_hi:[0,1]
    v_pk_mul_f32 v[16:17], v[74:75], v[20:21] op_sel:[0,0] op_sel_hi:[0,1]
    v_pk_mul_f32 v[18:19], v[218:219], v[22:23] op_sel:[0,0] op_sel_hi:[0,1]
    v_pk_mul_f32 v[150:151], v[76:77], v[22:23] op_sel:[0,0] op_sel_hi:[0,1]
    v_pk_fma_f32 v[84:85], v[70:71], v[20:21], v[12:13] op_sel:[1,1,0] op_sel_hi:[1,0,1] neg_lo:[0,1,0]
    v_pk_fma_f32 v[86:87], v[74:75], v[20:21], v[16:17] op_sel:[1,1,0] op_sel_hi:[1,0,1] neg_lo:[0,1,0]
    v_pk_fma_f32 v[88:89], v[218:219], v[22:23], v[18:19] op_sel:[1,1,0] op_sel_hi:[1,0,1] neg_lo:[0,1,0]
    v_pk_fma_f32 v[96:97], v[76:77], v[22:23], v[150:151] op_sel:[1,1,0] op_sel_hi:[1,0,1] neg_lo:[0,1,0]
    v_cvt_pk_bf16_f32 v24, -v49, -v51
    v_cvt_pk_bf16_f32 v25, -v53, -v55
    v_cvt_pk_bf16_f32 v26, -v67, -v67
    v_cvt_pk_bf16_f32 v27, -v69, -v71
    ds_write_b128 v0, v[24:27] offset:4096
    v_pk_mul_f32 v[12:13], v[64:65], v[22:23] op_sel:[0,0] op_sel_hi:[0,1]
    v_pk_mul_f32 v[16:17], v[66:67], v[22:23] op_sel:[0,0] op_sel_hi:[0,1]
    v_pk_mul_f32 v[18:19], v[74:75], v[22:23] op_sel:[0,0] op_sel_hi:[0,1]
    v_pk_fma_f32 v[90:91], v[64:65], v[22:23], v[12:13] op_sel:[1,1,0] op_sel_hi:[1,0,1] neg_lo:[0,1,0]
    v_pk_fma_f32 v[92:93], v[66:67], v[22:23], v[16:17] op_sel:[1,1,0] op_sel_hi:[1,0,1] neg_lo:[0,1,0]
    v_pk_fma_f32 v[94:95], v[74:75], v[22:23], v[18:19] op_sel:[1,1,0] op_sel_hi:[1,0,1] neg_lo:[0,1,0]
    v_cvt_pk_bf16_f32 v28, v76, v78
    v_cvt_pk_bf16_f32 v29, v80, v88
    v_cvt_pk_bf16_f32 v30, v82, v84
    v_cvt_pk_bf16_f32 v31, v86, v96
    ds_write_b128 v2, v[28:31] offset:0
    v_pk_mul_f32 v[12:13], v[80:81], v[22:23] op_sel:[0,0] op_sel_hi:[0,1]
    v_pk_mul_f32 v[16:17], v[82:83], v[22:23] op_sel:[0,0] op_sel_hi:[0,1]
    v_pk_mul_f32 v[18:19], v[86:87], v[22:23] op_sel:[0,0] op_sel_hi:[0,1]
    v_pk_fma_f32 v[98:99], v[80:81], v[22:23], v[12:13] op_sel:[1,1,0] op_sel_hi:[1,0,1] neg_lo:[0,1,0]
    v_pk_fma_f32 v[100:101], v[82:83], v[22:23], v[16:17] op_sel:[1,1,0] op_sel_hi:[1,0,1] neg_lo:[0,1,0]
    v_pk_fma_f32 v[102:103], v[86:87], v[22:23], v[18:19] op_sel:[1,1,0] op_sel_hi:[1,0,1] neg_lo:[0,1,0]
    v_cvt_pk_bf16_f32 v24, -v57, -v59
    v_cvt_pk_bf16_f32 v25, -v61, -v63
    v_cvt_pk_bf16_f32 v26, -v71, -v71
    v_cvt_pk_bf16_f32 v27, -v73, -v75
    ds_write_b128 v1, v[24:27] offset:4096
    v_cvt_pk_bf16_f32 v28, v90, v92
    v_cvt_pk_bf16_f32 v29, v94, v94
    v_cvt_pk_bf16_f32 v30, v98, v100
    v_cvt_pk_bf16_f32 v31, v102, v102
    ds_write_b128 v3, v[28:31] offset:0
    ds_read_b64_tr_b16 v[160:161], v4 offset:0
    ds_read_b64_tr_b16 v[162:163], v5 offset:256
    ds_read_b64_tr_b16 v[164:165], v4 offset:1024
    ds_read_b64_tr_b16 v[166:167], v5 offset:1280
    ds_read_b64_tr_b16 v[168:169], v4 offset:2048
    ds_read_b64_tr_b16 v[170:171], v5 offset:2304
    ds_read_b64_tr_b16 v[172:173], v4 offset:3072
    ds_read_b64_tr_b16 v[174:175], v5 offset:3328
    v_cvt_pk_bf16_f32 v24, -v77, -v79
    v_cvt_pk_bf16_f32 v25, -v81, -v89
    v_cvt_pk_bf16_f32 v26, -v83, -v85
    v_cvt_pk_bf16_f32 v27, -v87, -v97
    ds_write_b128 v2, v[24:27] offset:4096
    s_waitcnt lgkmcnt(7)
    v_mfma_f32_32x32x16_bf16 v[32:47], v[160:163], v[112:115], 0
    v_cvt_pk_bf16_f32 v28, -v91, -v93
    v_cvt_pk_bf16_f32 v29, -v95, -v95
    v_cvt_pk_bf16_f32 v30, -v99, -v101
    v_cvt_pk_bf16_f32 v31, -v103, -v103
    ds_write_b128 v3, v[28:31] offset:4096
    s_waitcnt lgkmcnt(6)
    v_mfma_f32_32x32x16_bf16 v[32:47], v[164:167], v[116:119], v[32:47]
    ds_read_b64_tr_b16 v[48:49], v4 offset:4096
    ds_read_b64_tr_b16 v[50:51], v5 offset:4352
    ds_read_b64_tr_b16 v[52:53], v4 offset:5120
    ds_read_b64_tr_b16 v[54:55], v5 offset:5376
    s_waitcnt lgkmcnt(8)
    v_mfma_f32_32x32x16_bf16 v[32:47], v[168:171], v[120:123], v[32:47]
    ds_read_b64_tr_b16 v[56:57], v4 offset:6144
    ds_read_b64_tr_b16 v[58:59], v5 offset:6400
    ds_read_b64_tr_b16 v[60:61], v4 offset:7168
    ds_read_b64_tr_b16 v[62:63], v5 offset:7424
    s_waitcnt lgkmcnt(10)
    v_mfma_f32_32x32x16_bf16 v[32:47], v[172:175], v[124:127], v[32:47]
    s_waitcnt lgkmcnt(6)
    v_mfma_f32_32x32x16_bf16 v[32:47], v[48:51], v[128:131], v[32:47]
    s_waitcnt lgkmcnt(4)
    v_mfma_f32_32x32x16_bf16 v[32:47], v[52:55], v[132:135], v[32:47]
    s_waitcnt lgkmcnt(2)
    v_mfma_f32_32x32x16_bf16 v[32:47], v[56:59], v[136:139], v[32:47]
    s_waitcnt lgkmcnt(0)
    v_mfma_f32_32x32x16_bf16 v[32:47], v[60:63], v[140:143], v[32:47]
    s_setprio 0
    s_add_u32 m0, s94, 0
    s_lshl_b32 s30, s90, 7
    s_add_u32 s30, s30, s95
    buffer_load_dwordx4 v238, s[20:23], s30 offen lds
    s_add_u32 m0, s94, 1024
    s_lshl_b32 s30, s91, 7
    s_add_u32 s30, s30, s95
    buffer_load_dwordx4 v238, s[20:23], s30 offen lds
    s_add_u32 m0, s94, 2048
    s_lshl_b32 s30, s92, 7
    s_add_u32 s30, s30, s95
    buffer_load_dwordx4 v238, s[20:23], s30 offen lds
    global_load_dwordx2 v[246:247], v244, s[86:87] sc1
    v_mov_b32 v50, v152
    v_mov_b32 v51, v153
    v_mov_b32 v48, 1.0
    v_mov_b32 v49, 0
    v_pk_mul_f32 v[12:13], v[50:51], v[50:51] op_sel:[0,0] op_sel_hi:[0,1]
    v_pk_mul_f32 v[16:17], v[154:155], v[154:155] op_sel:[0,0] op_sel_hi:[0,1]
    v_pk_mul_f32 v[18:19], v[156:157], v[156:157] op_sel:[0,0] op_sel_hi:[0,1]
    v_pk_fma_f32 v[52:53], v[50:51], v[50:51], v[12:13] op_sel:[1,1,0] op_sel_hi:[1,0,1] neg_lo:[0,1,0]
    v_pk_fma_f32 v[8:9], v[154:155], v[154:155], v[16:17] op_sel:[1,1,0] op_sel_hi:[1,0,1] neg_lo:[0,1,0]
    v_pk_fma_f32 v[20:21], v[156:157], v[156:157], v[18:19] op_sel:[1,1,0] op_sel_hi:[1,0,1] neg_lo:[0,1,0]
    v_pk_mul_f32 v[12:13], v[52:53], v[50:51] op_sel:[0,0] op_sel_hi:[0,1]
    v_pk_mul_f32 v[16:17], v[52:53], v[52:53] op_sel:[0,0] op_sel_hi:[0,1]
    v_pk_mul_f32 v[18:19], v[8:9], v[8:9] op_sel:[0,0] op_sel_hi:[0,1]
    v_pk_mul_f32 v[150:151], v[20:21], v[20:21] op_sel:[0,0] op_sel_hi:[0,1]
    v_pk_fma_f32 v[54:55], v[52:53], v[50:51], v[12:13] op_sel:[1,1,0] op_sel_hi:[1,0,1] neg_lo:[0,1,0]
    v_pk_fma_f32 v[56:57], v[52:53], v[52:53], v[16:17] op_sel:[1,1,0] op_sel_hi:[1,0,1] neg_lo:[0,1,0]
    v_pk_fma_f32 v[10:11], v[8:9], v[8:9], v[18:19] op_sel:[1,1,0] op_sel_hi:[1,0,1] neg_lo:[0,1,0]
    v_pk_fma_f32 v[22:23], v[20:21], v[20:21], v[150:151] op_sel:[1,1,0] op_sel_hi:[1,0,1] neg_lo:[0,1,0]
    v_pk_mul_f32 v[12:13], v[50:51], v[56:57] op_sel:[0,0] op_sel_hi:[0,1]
    v_pk_mul_f32 v[16:17], v[52:53], v[56:57] op_sel:[0,0] op_sel_hi:[0,1]
    v_pk_mul_f32 v[18:19], v[54:55], v[56:57] op_sel:[0,0] op_sel_hi:[0,1]
    v_pk_mul_f32 v[150:151], v[56:57], v[56:57] op_sel:[0,0] op_sel_hi:[0,1]
    v_pk_fma_f32 v[58:59], v[50:51], v[56:57], v[12:13] op_sel:[1,1,0] op_sel_hi:[1,0,1] neg_lo:[0,1,0]
    v_pk_fma_f32 v[60:61], v[52:53], v[56:57], v[16:17] op_sel:[1,1,0] op_sel_hi:[1,0,1] neg_lo:[0,1,0]
    v_pk_fma_f32 v[62:63], v[54:55], v[56:57], v[18:19] op_sel:[1,1,0] op_sel_hi:[1,0,1] neg_lo:[0,1,0]
    v_pk_fma_f32 v[64:65], v[56:57], v[56:57], v[150:151] op_sel:[1,1,0] op_sel_hi:[1,0,1] neg_lo:[0,1,0]
    v_pk_mul_f32 v[12:13], v[58:59], v[56:57] op_sel:[0,0] op_sel_hi:[0,1]
    v_pk_mul_f32 v[16:17], v[60:61], v[56:57] op_sel:[0,0] op_sel_hi:[0,1]
    v_pk_mul_f32 v[18:19], v[62:63], v[56:57] op_sel:[0,0] op_sel_hi:[0,1]
    v_pk_mul_f32 v[150:151], v[64:65], v[56:57] op_sel:[0,0] op_sel_hi:[0,1]
    v_pk_fma_f32 v[66:67], v[58:59], v[56:57], v[12:13] op_sel:[1,1,0] op_sel_hi:[1,0,1] neg_lo:[0,1,0]
    v_pk_fma_f32 v[68:69], v[60:61], v[56:57], v[16:17] op_sel:[1,1,0] op_sel_hi:[1,0,1] neg_lo:[0,1,0]
    v_pk_fma_f32 v[70:71], v[62:63], v[56:57], v[18:19] op_sel:[1,1,0] op_sel_hi:[1,0,1] neg_lo:[0,1,0]
    v_pk_fma_f32 v[72:73], v[64:65], v[56:57], v[150:151] op_sel:[1,1,0] op_sel_hi:[1,0,1] neg_lo:[0,1,0]
    v_cvt_pk_bf16_f32 v24, v48, v50
    v_cvt_pk_bf16_f32 v25, v52, v54
    v_cvt_pk_bf16_f32 v26, v56, v58
    v_cvt_pk_bf16_f32 v27, v60, v62
    ds_write_b128 v0, v[24:27] offset:0
    v_pk_mul_f32 v[12:13], v[66:67], v[56:57] op_sel:[0,0] op_sel_hi:[0,1]
    v_pk_mul_f32 v[16:17], v[68:69], v[56:57] op_sel:[0,0] op_sel_hi:[0,1]
    v_pk_mul_f32 v[18:19], v[70:71], v[56:57] op_sel:[0,0] op_sel_hi:[0,1]
    v_pk_mul_f32 v[150:151], v[72:73], v[56:57] op_sel:[0,0] op_sel_hi:[0,1]
    v_pk_fma_f32 v[74:75], v[66:67], v[56:57], v[12:13] op_sel:[1,1,0] op_sel_hi:[1,0,1] neg_lo:[0,1,0]
    v_pk_fma_f32 v[76:77], v[68:69], v[56:57], v[16:17] op_sel:[1,1,0] op_sel_hi:[1,0,1] neg_lo:[0,1,0]
    v_pk_fma_f32 v[78:79], v[70:71], v[56:57], v[18:19] op_sel:[1,1,0] op_sel_hi:[1,0,1] neg_lo:[0,1,0]
    v_pk_fma_f32 v[80:81], v[72:73], v[56:57], v[150:151] op_sel:[1,1,0] op_sel_hi:[1,0,1] neg_lo:[0,1,0]
    v_cvt_pk_bf16_f32 v28, v49, v51
    v_cvt_pk_bf16_f32 v29, v53, v55
    v_cvt_pk_bf16_f32 v30, v57, v59
    v_cvt_pk_bf16_f32 v31, v61, v63
    ds_write_b128 v0, v[28:31] offset:4096
    v_pk_mul_f32 v[12:13], v[74:75], v[56:57] op_sel:[0,0] op_sel_hi:[0,1]
    v_pk_mul_f32 v[16:17], v[76:77], v[56:57] op_sel:[0,0] op_sel_hi:[0,1]
    v_pk_mul_f32 v[18:19], v[78:79], v[56:57] op_sel:[0,0] op_sel_hi:[0,1]
    v_pk_mul_f32 v[150:151], v[80:81], v[56:57] op_sel:[0,0] op_sel_hi:[0,1]
    v_pk_fma_f32 v[82:83], v[74:75], v[56:57], v[12:13] op_sel:[1,1,0] op_sel_hi:[1,0,1] neg_lo:[0,1,0]
    v_pk_fma_f32 v[84:85], v[76:77], v[56:57], v[16:17] op_sel:[1,1,0] op_sel_hi:[1,0,1] neg_lo:[0,1,0]
    v_pk_fma_f32 v[86:87], v[78:79], v[56:57], v[18:19] op_sel:[1,1,0] op_sel_hi:[1,0,1] neg_lo:[0,1,0]
    v_pk_fma_f32 v[88:89], v[80:81], v[56:57], v[150:151] op_sel:[1,1,0] op_sel_hi:[1,0,1] neg_lo:[0,1,0]
    v_cvt_pk_bf16_f32 v24, v64, v66
    v_cvt_pk_bf16_f32 v25, v68, v70
    v_cvt_pk_bf16_f32 v26, v72, v74
    v_cvt_pk_bf16_f32 v27, v76, v78
    ds_write_b128 v1, v[24:27] offset:0
    v_pk_mul_f32 v[12:13], v[82:83], v[56:57] op_sel:[0,0] op_sel_hi:[0,1]
    v_pk_mul_f32 v[16:17], v[84:85], v[56:57] op_sel:[0,0] op_sel_hi:[0,1]
    v_pk_mul_f32 v[18:19], v[86:87], v[56:57] op_sel:[0,0] op_sel_hi:[0,1]
    v_pk_mul_f32 v[150:151], v[88:89], v[56:57] op_sel:[0,0] op_sel_hi:[0,1]
    v_pk_fma_f32 v[90:91], v[82:83], v[56:57], v[12:13] op_sel:[1,1,0] op_sel_hi:[1,0,1] neg_lo:[0,1,0]
    v_pk_fma_f32 v[92:93], v[84:85], v[56:57], v[16:17] op_sel:[1,1,0] op_sel_hi:[1,0,1] neg_lo:[0,1,0]
    v_pk_fma_f32 v[94:95], v[86:87], v[56:57], v[18:19] op_sel:[1,1,0] op_sel_hi:[1,0,1] neg_lo:[0,1,0]
    v_pk_fma_f32 v[96:97], v[88:89], v[56:57], v[150:151] op_sel:[1,1,0] op_sel_hi:[1,0,1] neg_lo:[0,1,0]
    v_cvt_pk_bf16_f32 v28, v65, v67
    v_cvt_pk_bf16_f32 v29, v69, v71
    v_cvt_pk_bf16_f32 v30, v73, v75
    v_cvt_pk_bf16_f32 v31, v77, v79
    ds_write_b128 v1, v[28:31] offset:4096
    v_pk_mul_f32 v[12:13], v[90:91], v[56:57] op_sel:[0,0] op_sel_hi:[0,1]
    v_pk_mul_f32 v[16:17], v[92:93], v[56:57] op_sel:[0,0] op_sel_hi:[0,1]
    v_pk_mul_f32 v[18:19], v[94:95], v[56:57] op_sel:[0,0] op_sel_hi:[0,1]
    v_pk_mul_f32 v[150:151], v[96:97], v[56:57] op_sel:[0,0] op_sel_hi:[0,1]
    v_pk_fma_f32 v[98:99], v[90:91], v[56:57], v[12:13] op_sel:[1,1,0] op_sel_hi:[1,0,1] neg_lo:[0,1,0]
    v_pk_fma_f32 v[100:101], v[92:93], v[56:57], v[16:17] op_sel:[1,1,0] op_sel_hi:[1,0,1] neg_lo:[0,1,0]
    v_pk_fma_f32 v[102:103], v[94:95], v[56:57], v[18:19] op_sel:[1,1,0] op_sel_hi:[1,0,1] neg_lo:[0,1,0]
    v_pk_fma_f32 v[104:105], v[96:97], v[56:57], v[150:151] op_sel:[1,1,0] op_sel_hi:[1,0,1] neg_lo:[0,1,0]
    v_cvt_pk_bf16_f32 v24, v80, v82
    v_cvt_pk_bf16_f32 v25, v84, v86
    v_cvt_pk_bf16_f32 v26, v88, v90
    v_cvt_pk_bf16_f32 v27, v92, v94
    ds_write_b128 v2, v[24:27] offset:0
    v_pk_mul_f32 v[12:13], v[98:99], v[56:57] op_sel:[0,0] op_sel_hi:[0,1]
    v_pk_mul_f32 v[16:17], v[100:101], v[56:57] op_sel:[0,0] op_sel_hi:[0,1]
    v_pk_mul_f32 v[18:19], v[102:103], v[56:57] op_sel:[0,0] op_sel_hi:[0,1]
    v_pk_mul_f32 v[150:151], v[158:159], v[154:155] op_sel:[0,0] op_sel_hi:[0,1]
    v_pk_fma_f32 v[106:107], v[98:99], v[56:57], v[12:13] op_sel:[1,1,0] op_sel_hi:[1,0,1] neg_lo:[0,1,0]
    v_pk_fma_f32 v[108:109], v[100:101], v[56:57], v[16:17] op_sel:[1,1,0] op_sel_hi:[1,0,1] neg_lo:[0,1,0]
    v_pk_fma_f32 v[110:111], v[102:103], v[56:57], v[18:19] op_sel:[1,1,0] op_sel_hi:[1,0,1] neg_lo:[0,1,0]
    v_pk_fma_f32 v[50:51], v[158:159], v[154:155], v[150:151] op_sel:[1,1,0] op_sel_hi:[1,0,1] neg_lo:[0,1,0]
    v_cvt_pk_bf16_f32 v28, v81, v83
    v_cvt_pk_bf16_f32 v29, v85, v87
    v_cvt_pk_bf16_f32 v30, v89, v91
    v_cvt_pk_bf16_f32 v31, v93, v95
    ds_write_b128 v2, v[28:31] offset:4096
    v_mov_b64 v[48:49], v[158:159]
    v_pk_mul_f32 v[12:13], v[158:159], v[8:9] op_sel:[0,0] op_sel_hi:[0,1]
    v_pk_mul_f32 v[16:17], v[50:51], v[8:9] op_sel:[0,0] op_sel_hi:[0,1]
    v_pk_mul_f32 v[18:19], v[158:159], v[10:11] op_sel:[0,0] op_sel_hi:[0,1]
    v_pk_mul_f32 v[150:151], v[50:51], v[10:11] op_sel:[0,0] op_sel_hi:[0,1]
    v_pk_fma_f32 v[52:53], v[158:159], v[8:9], v[12:13] op_sel:[1,1,0] op_sel_hi:[1,0,1] neg_lo:[0,1,0]
    v_pk_fma_f32 v[54:55], v[50:51], v[8:9], v[16:17] op_sel:[1,1,0] op_sel_hi:[1,0,1] neg_lo:[0,1,0]
    v_pk_fma_f32 v[56:57], v[158:159], v[10:11], v[18:19] op_sel:[1,1,0] op_sel_hi:[1,0,1] neg_lo:[0,1,0]
    v_pk_fma_f32 v[58:59], v[50:51], v[10:11], v[150:151] op_sel:[1,1,0] op_sel_hi:[1,0,1] neg_lo:[0,1,0]
    v_cvt_pk_bf16_f32 v24, v96, v98
    v_cvt_pk_bf16_f32 v25, v100, v102
    v_cvt_pk_bf16_f32 v26, v104, v106
    v_cvt_pk_bf16_f32 v27, v108, v110
    ds_write_b128 v3, v[24:27] offset:0
    v_pk_mul_f32 v[12:13], v[52:53], v[10:11] op_sel:[0,0] op_sel_hi:[0,1]
    v_pk_mul_f32 v[16:17], v[54:55], v[10:11] op_sel:[0,0] op_sel_hi:[0,1]
    v_pk_mul_f32 v[18:19], v[56:57], v[10:11] op_sel:[0,0] op_sel_hi:[0,1]
    v_pk_mul_f32 v[150:151], v[158:159], v[156:157] op_sel:[0,0] op_sel_hi:[0,1]
    v_pk_fma_f32 v[60:61], v[52:53], v[10:11], v[12:13] op_sel:[1,1,0] op_sel_hi:[1,0,1] neg_lo:[0,1,0]
    v_pk_fma_f32 v[62:63], v[54:55], v[10:11], v[16:17] op_sel:[1,1,0] op_sel_hi:[1,0,1] neg_lo:[0,1,0]
    v_pk_fma_f32 v[64:65], v[56:57], v[10:11], v[18:19] op_sel:[1,1,0] op_sel_hi:[1,0,1] neg_lo:[0,1,0]
    v_pk_fma_f32 v[66:67], v[158:159], v[156:157], v[150:151] op_sel:[1,1,0] op_sel_hi:[1,0,1] neg_lo:[0,1,0]
    v_cvt_pk_bf16_f32 v28, v97, v99
    v_cvt_pk_bf16_f32 v29, v101, v103
    v_cvt_pk_bf16_f32 v30, v105, v107
    v_cvt_pk_bf16_f32 v31, v109, v111
    ds_write_b128 v3, v[28:31] offset:4096
    ds_read_b64_tr_b16 v[112:113], v4 offset:0
    ds_read_b64_tr_b16 v[114:115], v5 offset:256
    ds_read_b64_tr_b16 v[116:117], v4 offset:1024
    ds_read_b64_tr_b16 v[118:119], v5 offset:1280
    ds_read_b64_tr_b16 v[120:121], v4 offset:2048
    ds_read_b64_tr_b16 v[122:123], v5 offset:2304
    ds_read_b64_tr_b16 v[124:125], v4 offset:3072
    ds_read_b64_tr_b16 v[126:127], v5 offset:3328
    v_pk_mul_f32 v[12:13], v[52:53], v[156:157] op_sel:[0,0] op_sel_hi:[0,1]
    v_pk_mul_f32 v[16:17], v[56:57], v[156:157] op_sel:[0,0] op_sel_hi:[0,1]
    v_pk_mul_f32 v[18:19], v[60:61], v[156:157] op_sel:[0,0] op_sel_hi:[0,1]
    v_pk_mul_f32 v[150:151], v[64:65], v[156:157] op_sel:[0,0] op_sel_hi:[0,1]
    v_pk_fma_f32 v[68:69], v[52:53], v[156:157], v[12:13] op_sel:[1,1,0] op_sel_hi:[1,0,1] neg_lo:[0,1,0]
    v_pk_fma_f32 v[70:71], v[56:57], v[156:157], v[16:17] op_sel:[1,1,0] op_sel_hi:[1,0,1] neg_lo:[0,1,0]
    v_pk_fma_f32 v[72:73], v[60:61], v[156:157], v[18:19] op_sel:[1,1,0] op_sel_hi:[1,0,1] neg_lo:[0,1,0]
    v_pk_fma_f32 v[74:75], v[64:65], v[156:157], v[150:151] op_sel:[1,1,0] op_sel_hi:[1,0,1] neg_lo:[0,1,0]
    ds_read_b64_tr_b16 v[128:129], v4 offset:4096
    ds_read_b64_tr_b16 v[130:131], v5 offset:4352
    ds_read_b64_tr_b16 v[132:133], v4 offset:5120
    ds_read_b64_tr_b16 v[134:135], v5 offset:5376
    ds_read_b64_tr_b16 v[136:137], v4 offset:6144
    ds_read_b64_tr_b16 v[138:139], v5 offset:6400
    ds_read_b64_tr_b16 v[140:141], v4 offset:7168
    ds_read_b64_tr_b16 v[142:143], v5 offset:7424
    v_cvt_pk_bf16_f32 v24, v48, v50
    v_cvt_pk_bf16_f32 v25, v52, v54
    v_cvt_pk_bf16_f32 v26, v66, v66
    v_cvt_pk_bf16_f32 v27, v68, v70
    ds_write_b128 v0, v[24:27] offset:0
    v_pk_mul_f32 v[12:13], v[158:159], v[20:21] op_sel:[0,0] op_sel_hi:[0,1]
    v_pk_mul_f32 v[16:17], v[56:57], v[20:21] op_sel:[0,0] op_sel_hi:[0,1]
    v_pk_mul_f32 v[18:19], v[64:65], v[20:21] op_sel:[0,0] op_sel_hi:[0,1]
    v_pk_mul_f32 v[150:151], v[66:67], v[20:21] op_sel:[0,0] op_sel_hi:[0,1]
    v_pk_fma_f32 v[76:77], v[158:159], v[20:21], v[12:13] op_sel:[1,1,0] op_sel_hi:[1,0,1] neg_lo:[0,1,0]
    v_pk_fma_f32 v[78:79], v[56:57], v[20:21], v[16:17] op_sel:[1,1,0] op_sel_hi:[1,0,1] neg_lo:[0,1,0]
    v_pk_fma_f32 v[80:81], v[64:65], v[20:21], v[18:19] op_sel:[1,1,0] op_sel_hi:[1,0,1] neg_lo:[0,1,0]
    v_pk_fma_f32 v[82:83], v[66:67], v[20:21], v[150:151] op_sel:[1,1,0] op_sel_hi:[1,0,1] neg_lo:[0,1,0]
    v_cvt_pk_bf16_f32 v28, v56, v58
    v_cvt_pk_bf16_f32 v29, v60, v62
    s_waitcnt vmcnt(0)
    ds_read_b64_tr_b16 v[176:177], v239 offset:0
    ds_read_b64_tr_b16 v[178:179], v239 offset:512
    ds_read_b64_tr_b16 v[180:181], v239 offset:1024
    ds_read_b64_tr_b16 v[182:183], v239 offset:1536
    ds_read_b64_tr_b16 v[184:185], v239 offset:2048
    ds_read_b64_tr_b16 v[186:187], v239 offset:2560
    s_waitcnt lgkmcnt(0)
    s_lshl_b32 s30, s90, 10
    s_add_u32 s30, s30, s95
    s_add_u32 s30, s30, 10747904
    buffer_store_dwordx4 v[176:179], v201, s[16:19], s30 offen sc1
    s_lshl_b32 s30, s91, 10
    s_add_u32 s30, s30, s95
    s_add_u32 s30, s30, 10747904
    buffer_store_dwordx4 v[180:183], v201, s[16:19], s30 offen sc1
    s_lshl_b32 s30, s92, 10
    s_add_u32 s30, s30, s95
    s_add_u32 s30, s30, 10747904
    buffer_store_dwordx4 v[184:187], v201, s[16:19], s30 offen sc1
    s_branch L_a_join
L_a_plain:
    s_mov_b32 s44, 1000000
    v_mov_b32 v240, 163756
L_lw_1:
    ds_read_b32 v241, v240
    s_waitcnt lgkmcnt(0)
    v_readfirstlane_b32 s45, v241
    s_cmp_ge_u32 s45, 8
    s_cbranch_scc1 L_ld_2
    s_sleep 2
    s_sub_u32 s44, s44, 1
    s_cmp_lg_u32 s44, 0
    s_cbranch_scc1 L_lw_1
L_ld_2:
    s_add_u32 m0, s94, 0
    s_lshl_b32 s30, s90, 7
    s_add_u32 s30, s30, s95
    buffer_load_dwordx4 v238, s[20:23], s30 offen lds
    s_add_u32 m0, s94, 1024
    s_lshl_b32 s30, s91, 7
    s_add_u32 s30, s30, s95
    buffer_load_dwordx4 v238, s[20:23], s30 offen lds
    s_add_u32 m0, s94, 2048
    s_lshl_b32 s30, s92, 7
    s_add_u32 s30, s30, s95
    buffer_load_dwordx4 v238, s[20:23], s30 offen lds
    global_load_dwordx2 v[246:247], v244, s[86:87] sc1
    s_waitcnt vmcnt(0)
    ds_read_b64_tr_b16 v[176:177], v239 offset:0
    ds_read_b64_tr_b16 v[178:179], v239 offset:512
    ds_read_b64_tr_b16 v[180:181], v239 offset:1024
    ds_read_b64_tr_b16 v[182:183], v239 offset:1536
    ds_read_b64_tr_b16 v[184:185], v239 offset:2048
    ds_read_b64_tr_b16 v[186:187], v239 offset:2560
    s_waitcnt lgkmcnt(0)
    s_lshl_b32 s30, s90, 10
    s_add_u32 s30, s30, s95
    s_add_u32 s30, s30, 10747904
    buffer_store_dwordx4 v[176:179], v201, s[16:19], s30 offen sc1
    s_lshl_b32 s30, s91, 10
    s_add_u32 s30, s30, s95
    s_add_u32 s30, s30, 10747904
    buffer_store_dwordx4 v[180:183], v201, s[16:19], s30 offen sc1
    s_lshl_b32 s30, s92, 10
    s_add_u32 s30, s30, s95
    s_add_u32 s30, s30, 10747904
    buffer_store_dwordx4 v[184:187], v201, s[16:19], s30 offen sc1
L_a_join:
    v_readfirstlane_b32 s42, v246
    v_readfirstlane_b32 s43, v247
    s_cmp_lg_u32 s43, 0
    s_cbranch_scc1 L_nf_a
    s_mov_b32 s44, 1000000
L_ng_3:
    global_load_dwordx2 v[246:247], v244, s[86:87] sc1
L_ng_3_w:
    s_waitcnt vmcnt(0)
    v_readfirstlane_b32 s42, v246
    v_readfirstlane_b32 s43, v247
    s_cmp_lg_u32 s43, 0
    s_cbranch_scc1 L_nd_4
    s_sleep 2
    s_sub_u32 s44, s44, 1
    s_cmp_lg_u32 s44, 0
    s_cbranch_scc1 L_ng_3
L_nd_4:
L_nf_a:
    s_setprio 0
    s_barrier
    s_mov_b32 m0, s3
    s_nop 0
    buffer_load_dwordx4 v220, s[8:11], s46 offen lds
    s_add_u32 m0, s3, 4160
    s_nop 0
    buffer_load_dwordx4 v221, s[8:11], s46 offen lds
    s_add_u32 m0, s3, 8320
    s_nop 0
    buffer_load_dwordx4 v222, s[8:11], s46 offen lds
    s_add_u32 m0, s3, 12480
    s_nop 0
    buffer_load_dwordx4 v223, s[8:11], s46 offen lds
    s_add_u32 m0, s3, s1
    s_nop 0
    buffer_load_dwordx4 v234, s[12:15], s47 offen lds
    s_add_u32 m0, m0, 4096
    s_nop 0
    buffer_load_dwordx4 v235, s[12:15], s47 offen lds
    s_add_u32 m0, m0, 4096
    s_nop 0
    buffer_load_dwordx4 v236, s[12:15], s47 offen lds
    s_add_u32 m0, m0, 4096
    s_nop 0
    buffer_load_dwordx4 v237, s[12:15], s47 offen lds
    s_add_u32 s46, s46, 128
    s_add_u32 s47, s47, 245760
    s_cmp_eq_u32 s46, 1280
    s_cselect_b32 s46, 0, s46
    s_cselect_b32 s47, 0, s47
    s_add_u32 s3, s3, 33024
    s_sub_u32 s30, s3, 99072
    s_cmp_ge_u32 s3, 99072
    s_cselect_b32 s3, s30, s3
    v_and_b32 v240, 3, v250
    v_lshrrev_b32 v241, 2, v250
    v_mul_u32_u24 v242, 8464, v240
    v_lshl_add_u32 v242, v241, 6, v242
    s_lshl_b32 s5, s41, 10
    s_add_u32 s5, s5, 92924
    v_add_u32 v206, s5, v242
    v_mul_u32_u24 v241, 40960, v241
    v_lshl_add_u32 v231, v240, 4, v241
    v_bfe_u32 v242, v250, 4, 1
    v_mul_u32_u24 v242, 4224, v242
    v_and_b32 v243, 15, v250
    v_lshl_add_u32 v242, v243, 2, v242
    s_mul_i32 s5, s41, 8464
    s_add_u32 s5, s5, 92864
    v_add_u32 v207, s5, v242
    s_mul_i32 s5, s37, 20
    s_add_u32 s5, s5, s38
    s_lshl_b32 s5, s5, 6
    s_mul_i32 s6, s41, 655360
    s_add_u32 s6, s6, s5
    s_add_u32 s6, s6, 10747904
    s_lshl_b32 s7, s41, 9
    s_add_u32 s7, s7, 4096
    v_lshlrev_b32 v211, 3, v250
    v_add_u32 v211, s7, v211
    v_lshrrev_b32 v240, 5, v211
    v_mul_u32_u24 v240, 4352, v240
    v_and_b32 v211, 31, v211
    v_add_u32 v211, v211, v240
    v_add_u32 v211, 16777216, v211
    v_and_b32 v243, 15, v250
    v_and_b32 v240, 1, v250
    v_mul_u32_u24 v204, 4640, v240
    v_bfe_u32 v241, v250, 1, 3
    v_lshlrev_b32 v241, 6, v241
    v_sub_u32 v204, v204, v241
    v_lshrrev_b32 v242, 4, v250
    v_lshl_add_u32 v204, v242, 4, v204
    s_add_u32 s56, s51, 768
    v_add_u32 v204, s56, v204
    v_mul_u32_u24 v240, 4220, v240
    v_lshlrev_b32 v241, 2, v243
    v_sub_u32 v240, v241, v240
    v_lshl_add_u32 v240, v242, 4, v240
    s_waitcnt vmcnt(8)
    s_barrier
    s_cmp_lg_u32 s41, 0
    s_cbranch_scc1 L_a_nf
    s_lshl_b32 s30, s2, 3
    s_add_u32 s30, s30, 4096
    s_lshr_b32 s31, s30, 5
    s_mul_i32 s31, s31, 4352
    s_and_b32 s30, s30, 31
    s_add_u32 s30, s30, s31
    s_add_u32 s30, s30, 16777216
    v_mov_b32 v246, s42
    v_mov_b32 v247, s43
    v_lshlrev_b32 v248, 3, v250
    s_mov_b64 exec, 0x1
    buffer_store_dwordx2 v[246:247], v248, s[16:19], s30 offen sc1
    s_mov_b64 exec, -1
L_a_nf:
    s_mov_b32 m0, s3
    s_nop 0
    buffer_load_dwordx4 v220, s[8:11], s46 offen lds
    s_add_u32 m0, s3, 4160
    s_nop 0
    buffer_load_dwordx4 v221, s[8:11], s46 offen lds
    s_add_u32 m0, s3, 8320
    s_nop 0
    buffer_load_dwordx4 v222, s[8:11], s46 offen lds
    s_add_u32 m0, s3, 12480
    s_nop 0
    buffer_load_dwordx4 v223, s[8:11], s46 offen lds
    s_add_u32 m0, s3, s1
    s_nop 0
    buffer_load_dwordx4 v234, s[12:15], s47 offen lds
    s_add_u32 m0, m0, 4096
    s_nop 0
    buffer_load_dwordx4 v235, s[12:15], s47 offen lds
    s_add_u32 m0, m0, 4096
    s_nop 0
    buffer_load_dwordx4 v236, s[12:15], s47 offen lds
    s_add_u32 m0, m0, 4096
    s_nop 0
    buffer_load_dwordx4 v237, s[12:15], s47 offen lds
    s_add_u32 s46, s46, 128
    s_add_u32 s47, s47, 245760
    s_cmp_eq_u32 s46, 1280
    s_cselect_b32 s46, 0, s46
    s_cselect_b32 s47, 0, s47
    s_add_u32 s3, s3, 33024
    s_sub_u32 s30, s3, 99072
    s_cmp_ge_u32 s3, 99072
    s_cselect_b32 s3, s30, s3
    s_add_u32 s56, s93, 4544
    v_add_u32 v205, s56, v240
    v_lshl_add_u32 v241, v242, 7, v241
    v_add_u32 v209, s51, v241
    v_lshlrev_b32 v242, 4, v250
    v_add_u32 v210, s51, v242
    s_and_b32 s41, s32, 3
    v_lshlrev_b32 v192, 4, v250
    s_mul_i32 s52, s39, 163840
    s_add_u32 s52, s52, 2621440
    s_mul_i32 s54, s39, 20
    v_bfe_u32 v240, v250, 4, 1
    v_mul_u32_u24 v240, 19, v240
    v_add_u32 v240, s54, v240
    v_and_b32 v240, 0xff80, v240
    v_lshrrev_b32 v241, 5, v250
    v_mul_u32_u24 v241, 640, v241
    v_and_b32 v242, 15, v250
    v_lshl_add_u32 v241, v242, 3, v241
    v_add_u32 v241, v241, v240
    v_add_u32 v194, 640, v241
    v_lshrrev_b32 v241, 5, v194
    v_mul_u32_u24 v241, 4352, v241
    v_and_b32 v194, 31, v194
    v_add_u32 v194, v194, v241
    v_add_u32 v194, 16777216, v194
    v_and_b32 v195, 3, v250
    v_lshlrev_b32 v195, 2, v195
    v_add_u32 v195, 163776, v195
    s_lshr_b32 s49, s38, 2
    s_mul_i32 s54, s49, 160
    v_add_u32 v243, 0, v250
    v_mul_u32_u24 v241, 52429, v243
    v_lshrrev_b32 v241, 19, v241
    v_mul_u32_u24 v242, 1120, v241
    v_lshl_add_u32 v242, v250, 4, v242
    v_add_u32 v202, s54, v242
    v_add_u32 v243, 64, v250
    v_mul_u32_u24 v241, 52429, v243
    v_lshrrev_b32 v241, 19, v241
    v_mul_u32_u24 v242, 1120, v241
    v_lshl_add_u32 v242, v250, 4, v242
    v_add_u32 v203, s54, v242
    v_add_u32 v243, 128, v250
    v_mul_u32_u24 v241, 52429, v243
    s_waitcnt vmcnt(8)
    s_barrier
    s_mov_b32 m0, s3
    s_nop 0
    buffer_load_dwordx4 v220, s[8:11], s46 offen lds
    s_add_u32 m0, s3, 4160
    s_nop 0
    buffer_load_dwordx4 v221, s[8:11], s46 offen lds
    s_add_u32 m0, s3, 8320
    s_nop 0
    buffer_load_dwordx4 v222, s[8:11], s46 offen lds
    s_add_u32 m0, s3, 12480
    s_nop 0
    buffer_load_dwordx4 v223, s[8:11], s46 offen lds
    s_add_u32 m0, s3, s1
    s_nop 0
    buffer_load_dwordx4 v234, s[12:15], s47 offen lds
    s_add_u32 m0, m0, 4096
    s_nop 0
    buffer_load_dwordx4 v235, s[12:15], s47 offen lds
    s_add_u32 m0, m0, 4096
    s_nop 0
    buffer_load_dwordx4 v236, s[12:15], s47 offen lds
    s_add_u32 m0, m0, 4096
    s_nop 0
    buffer_load_dwordx4 v237, s[12:15], s47 offen lds
    s_add_u32 s46, s46, 128
    s_add_u32 s47, s47, 245760
    s_cmp_eq_u32 s46, 1280
    s_cselect_b32 s46, 0, s46
    s_cselect_b32 s47, 0, s47
    s_add_u32 s3, s3, 33024
    s_sub_u32 s30, s3, 99072
    s_cmp_ge_u32 s3, 99072
    s_cselect_b32 s3, s30, s3
    v_lshrrev_b32 v241, 19, v241
    v_mul_u32_u24 v242, 1120, v241
    v_lshl_add_u32 v242, v250, 4, v242
    v_add_u32 v251, s54, v242
    v_add_u32 v243, 192, v250
    v_mul_u32_u24 v241, 52429, v243
    v_lshrrev_b32 v241, 19, v241
    v_mul_u32_u24 v242, 1120, v241
    v_lshl_add_u32 v242, v250, 4, v242
    v_add_u32 v252, s54, v242
    v_add_u32 v243, 256, v250
    v_mul_u32_u24 v241, 52429, v243
    v_lshrrev_b32 v241, 19, v241
    v_mul_u32_u24 v242, 1120, v241
    v_lshl_add_u32 v242, v250, 4, v242
    v_add_u32 v242, 4096, v242
    v_add_u32 v253, s54, v242
    v_bfe_u32 v241, v250, 2, 2
    v_and_b32 v242, 3, v250
    v_lshrrev_b32 v243, 5, v250
    v_mul_u32_u24 v196, 20, v243
    v_bfe_u32 v243, v250, 4, 1
    v_lshl_add_u32 v196, v243, 2, v196
    v_add_u32 v196, v196, v241
    v_mul_u32_u24 v196, 160, v196
    v_lshl_add_u32 v196, v242, 3, v196
    v_lshrrev_b32 v243, 4, v250
    v_mul_u32_u24 v197, 20, v243
    v_add_u32 v197, v197, v241
    v_mul_u32_u24 v197, 160, v197
    v_lshl_add_u32 v197, v242, 3, v197
    v_add_u32 v196, 20480, v196
    v_add_u32 v197, 20480, v197
    v_add_u32 v230, 51200, v196
    v_add_u32 v208, 51200, v197
    s_lshl_b32 s58, s39, 2
    s_add_u32 s58, s58, s41
    v_lshlrev_b32 v193, 3, v250
    v_and_b32 v199, 31, v250
    v_lshlrev_b32 v199, 3, v199
    s_lshl_b32 s54, s37, 8
    s_add_u32 s54, s54, 12288
    v_add_u32 v199, s54, v199
    v_lshrrev_b32 v241, 5, v199
    v_mul_u32_u24 v241, 4352, v241
    s_waitcnt vmcnt(8)
    s_barrier
    s_mov_b32 m0, s3
    s_nop 0
    buffer_load_dwordx4 v220, s[8:11], s46 offen lds
    s_add_u32 m0, s3, 4160
    s_nop 0
    buffer_load_dwordx4 v221, s[8:11], s46 offen lds
    s_add_u32 m0, s3, 8320
    s_nop 0
    buffer_load_dwordx4 v222, s[8:11], s46 offen lds
    s_add_u32 m0, s3, 12480
    s_nop 0
    buffer_load_dwordx4 v223, s[8:11], s46 offen lds
    s_add_u32 m0, s3, s1
    s_nop 0
    buffer_load_dwordx4 v234, s[12:15], s47 offen lds
    s_add_u32 m0, m0, 4096
    s_nop 0
    buffer_load_dwordx4 v235, s[12:15], s47 offen lds
    s_add_u32 m0, m0, 4096
    s_nop 0
    buffer_load_dwordx4 v236, s[12:15], s47 offen lds
    s_add_u32 m0, m0, 4096
    s_nop 0
    buffer_load_dwordx4 v237, s[12:15], s47 offen lds
    s_add_u32 s46, s46, 128
    s_add_u32 s47, s47, 245760
    s_cmp_eq_u32 s46, 1280
    s_cselect_b32 s46, 0, s46
    s_cselect_b32 s47, 0, s47
    s_add_u32 s3, s3, 33024
    s_sub_u32 s30, s3, 99072
    s_cmp_ge_u32 s3, 99072
    s_cselect_b32 s3, s30, s3
    v_and_b32 v199, 31, v199
    v_add_u32 v199, v199, v241
    v_add_u32 v199, 16777216, v199
    v_and_b32 v241, 15, v250
    v_mul_u32_u24 v241, 176, v241
    v_lshrrev_b32 v242, 4, v250
    v_lshl_add_u32 v241, v242, 3, v241
    s_mul_i32 s55, s41, 2816
    s_add_u32 s55, s55, 143360
    v_add_u32 v198, s55, v241
    v_add_u32 v242, 0, v250
    v_mul_u32_u24 v243, 52429, v242
    v_lshrrev_b32 v243, 19, v243
    v_mul_u32_u24 v224, 10, v243
    v_sub_u32 v242, v242, v224
    v_lshlrev_b32 v242, 4, v242
    v_mul_u32_u24 v224, 176, v243
    v_add3_u32 v224, v224, v242, s55
    v_mul_u32_u24 v227, 2560, v243
    v_add_u32 v227, v227, v242
    v_add_u32 v242, 64, v250
    v_mul_u32_u24 v243, 52429, v242
    v_lshrrev_b32 v243, 19, v243
    v_mul_u32_u24 v225, 10, v243
    v_sub_u32 v242, v242, v225
    v_lshlrev_b32 v242, 4, v242
    v_mul_u32_u24 v225, 176, v243
    v_add3_u32 v225, v225, v242, s55
    v_mul_u32_u24 v228, 2560, v243
    v_add_u32 v228, v228, v242
    v_add_u32 v242, 128, v250
    v_mul_u32_u24 v243, 52429, v242
    v_lshrrev_b32 v243, 19, v243
    v_mul_u32_u24 v226, 10, v243
    v_sub_u32 v242, v242, v226
    v_lshlrev_b32 v242, 4, v242
    v_mul_u32_u24 v226, 176, v243
    v_add3_u32 v226, v226, v242, s55
    v_mul_u32_u24 v229, 2560, v243
    v_add_u32 v229, v229, v242
    s_mul_i32 s53, s49, 160
    s_mul_i32 s54, s58, 40960
    s_add_u32 s53, s53, s54
    s_add_u32 s53, s53, 1280
    v_mov_b32 v200, 163824
    s_waitcnt vmcnt(8)
    s_barrier
    s_cmp_lt_u32 s38, 20
    s_cselect_b32 s7, 0, 33554432
    buffer_load_dwordx2 v[232:233], v211, s[16:19], s7 offen sc1
    s_mov_b32 m0, s3
    s_nop 0
    buffer_load_dwordx4 v220, s[8:11], s46 offen lds
    s_add_u32 m0, s3, 4160
    s_nop 0
    buffer_load_dwordx4 v221, s[8:11], s46 offen lds
    s_add_u32 m0, s3, 8320
    s_nop 0
    buffer_load_dwordx4 v222, s[8:11], s46 offen lds
    s_add_u32 m0, s3, 12480
    s_nop 0
    buffer_load_dwordx4 v223, s[8:11], s46 offen lds
    s_add_u32 m0, s3, s1
    s_nop 0
    buffer_load_dwordx4 v234, s[12:15], s47 offen lds
    s_add_u32 m0, m0, 4096
    s_nop 0
    buffer_load_dwordx4 v235, s[12:15], s47 offen lds
    s_add_u32 m0, m0, 4096
    s_nop 0
    buffer_load_dwordx4 v236, s[12:15], s47 offen lds
    s_add_u32 m0, m0, 4096
    s_nop 0
    buffer_load_dwordx4 v237, s[12:15], s47 offen lds
    s_add_u32 s46, s46, 128
    s_add_u32 s47, s47, 245760
    s_cmp_eq_u32 s46, 1280
    s_cselect_b32 s46, 0, s46
    s_cselect_b32 s47, 0, s47
    s_add_u32 s3, s3, 33024
    s_sub_u32 s30, s3, 99072
    s_cmp_ge_u32 s3, 99072
    s_cselect_b32 s3, s30, s3
    s_waitcnt vmcnt(9)
    s_barrier
    s_waitcnt vmcnt(0)
    s_barrier
    v_cmp_eq_u64 s[46:47], s[42:43], v[232:233]
    s_cmp_eq_u64 s[46:47], -1
    s_cselect_b32 s5, 1, 0
    s_cbranch_scc0 L_a_t0
    buffer_load_dwordx4 v[176:179], v231, s[16:19], s6 offen sc1
    s_add_u32 s6, s6, 10240
    buffer_load_dwordx4 v[180:183], v231, s[16:19], s6 offen sc1
    s_add_u32 s6, s6, 10240
    buffer_load_dwordx4 v[184:187], v231, s[16:19], s6 offen sc1
    s_add_u32 s6, s6, 10240
    buffer_load_dwordx4 v[188:191], v231, s[16:19], s6 offen sc1
    s_add_u32 s6, s6, 10240
L_a_t0:
    s_barrier
    s_setprio 1
    s_cmp_ge_u32 s38, 20
    s_cbranch_scc1 L_side
    s_cmp_eq_u32 s5, 1
    s_cbranch_scc1 L_a_fud2
    s_mov_b32 s44, 1000000
L_a_fu:
    buffer_load_dwordx2 v[232:233], v211, s[16:19], s7 offen sc1
    s_waitcnt vmcnt(0)
    v_cmp_eq_u64 s[46:47], s[42:43], v[232:233]
    s_cmp_eq_u64 s[46:47], -1
    s_cbranch_scc1 L_a_fud
    s_sleep 8
    s_sub_u32 s44, s44, 1
    s_cmp_lg_u32 s44, 0
    s_cbranch_scc1 L_a_fu
L_a_fud:
    buffer_load_dwordx4 v[176:179], v231, s[16:19], s6 offen sc1
    s_add_u32 s6, s6, 10240
    buffer_load_dwordx4 v[180:183], v231, s[16:19], s6 offen sc1
    s_add_u32 s6, s6, 10240
    buffer_load_dwordx4 v[184:187], v231, s[16:19], s6 offen sc1
    s_add_u32 s6, s6, 10240
    buffer_load_dwordx4 v[188:191], v231, s[16:19], s6 offen sc1
    s_add_u32 s6, s6, 10240
L_a_fud2:
    v_cvt_pk_bf16_f32 v30, v70, v70
    v_cvt_pk_bf16_f32 v31, v72, v74
    ds_write_b128 v1, v[28:31] offset:0
    v_pk_mul_f32 v[12:13], v[70:71], v[20:21] op_sel:[0,0] op_sel_hi:[0,1]
    v_pk_mul_f32 v[16:17], v[74:75], v[20:21] op_sel:[0,0] op_sel_hi:[0,1]
    v_pk_mul_f32 v[18:19], v[158:159], v[22:23] op_sel:[0,0] op_sel_hi:[0,1]
    v_pk_mul_f32 v[150:151], v[76:77], v[22:23] op_sel:[0,0] op_sel_hi:[0,1]
    v_pk_fma_f32 v[84:85], v[70:71], v[20:21], v[12:13] op_sel:[1,1,0] op_sel_hi:[1,0,1] neg_lo:[0,1,0]
    v_pk_fma_f32 v[86:87], v[74:75], v[20:21], v[16:17] op_sel:[1,1,0] op_sel_hi:[1,0,1] neg_lo:[0,1,0]
    v_pk_fma_f32 v[88:89], v[158:159], v[22:23], v[18:19] op_sel:[1,1,0] op_sel_hi:[1,0,1] neg_lo:[0,1,0]
    v_pk_fma_f32 v[96:97], v[76:77], v[22:23], v[150:151] op_sel:[1,1,0] op_sel_hi:[1,0,1] neg_lo:[0,1,0]
    v_cvt_pk_bf16_f32 v24, -v49, -v51
    v_cvt_pk_bf16_f32 v25, -v53, -v55
    v_cvt_pk_bf16_f32 v26, -v67, -v67
    v_cvt_pk_bf16_f32 v27, -v69, -v71
    ds_write_b128 v0, v[24:27] offset:4096
    v_pk_mul_f32 v[12:13], v[64:65], v[22:23] op_sel:[0,0] op_sel_hi:[0,1]
    v_pk_mul_f32 v[16:17], v[66:67], v[22:23] op_sel:[0,0] op_sel_hi:[0,1]
    v_pk_mul_f32 v[18:19], v[74:75], v[22:23] op_sel:[0,0] op_sel_hi:[0,1]
    v_pk_fma_f32 v[90:91], v[64:65], v[22:23], v[12:13] op_sel:[1,1,0] op_sel_hi:[1,0,1] neg_lo:[0,1,0]
    v_pk_fma_f32 v[92:93], v[66:67], v[22:23], v[16:17] op_sel:[1,1,0] op_sel_hi:[1,0,1] neg_lo:[0,1,0]
    v_pk_fma_f32 v[94:95], v[74:75], v[22:23], v[18:19] op_sel:[1,1,0] op_sel_hi:[1,0,1] neg_lo:[0,1,0]
    v_cvt_pk_bf16_f32 v28, v76, v78
    v_cvt_pk_bf16_f32 v29, v80, v88
    v_cvt_pk_bf16_f32 v30, v82, v84
    v_cvt_pk_bf16_f32 v31, v86, v96
    ds_write_b128 v2, v[28:31] offset:0
    v_pk_mul_f32 v[12:13], v[80:81], v[22:23] op_sel:[0,0] op_sel_hi:[0,1]
    v_pk_mul_f32 v[16:17], v[82:83], v[22:23] op_sel:[0,0] op_sel_hi:[0,1]
    v_pk_mul_f32 v[18:19], v[86:87], v[22:23] op_sel:[0,0] op_sel_hi:[0,1]
    v_pk_fma_f32 v[98:99], v[80:81], v[22:23], v[12:13] op_sel:[1,1,0] op_sel_hi:[1,0,1] neg_lo:[0,1,0]
    v_pk_fma_f32 v[100:101], v[82:83], v[22:23], v[16:17] op_sel:[1,1,0] op_sel_hi:[1,0,1] neg_lo:[0,1,0]
    v_pk_fma_f32 v[102:103], v[86:87], v[22:23], v[18:19] op_sel:[1,1,0] op_sel_hi:[1,0,1] neg_lo:[0,1,0]
    v_cvt_pk_bf16_f32 v24, -v57, -v59
    v_cvt_pk_bf16_f32 v25, -v61, -v63
    v_cvt_pk_bf16_f32 v26, -v71, -v71
    v_cvt_pk_bf16_f32 v27, -v73, -v75
    ds_write_b128 v1, v[24:27] offset:4096
    v_cvt_pk_bf16_f32 v28, v90, v92
    v_cvt_pk_bf16_f32 v29, v94, v94
    v_cvt_pk_bf16_f32 v30, v98, v100
    v_cvt_pk_bf16_f32 v31, v102, v102
    ds_write_b128 v3, v[28:31] offset:0
    ds_read_b64_tr_b16 v[160:161], v4 offset:0
    ds_read_b64_tr_b16 v[162:163], v5 offset:256
    ds_read_b64_tr_b16 v[164:165], v4 offset:1024
    ds_read_b64_tr_b16 v[166:167], v5 offset:1280
    ds_read_b64_tr_b16 v[168:169], v4 offset:2048
    ds_read_b64_tr_b16 v[170:171], v5 offset:2304
    ds_read_b64_tr_b16 v[172:173], v4 offset:3072
    ds_read_b64_tr_b16 v[174:175], v5 offset:3328
    v_cvt_pk_bf16_f32 v24, -v77, -v79
    v_cvt_pk_bf16_f32 v25, -v81, -v89
    v_cvt_pk_bf16_f32 v26, -v83, -v85
    v_cvt_pk_bf16_f32 v27, -v87, -v97
    ds_write_b128 v2, v[24:27] offset:4096
    s_waitcnt lgkmcnt(7)
    v_mfma_f32_32x32x16_bf16 v[32:47], v[160:163], v[112:115], v[32:47]
    v_cvt_pk_bf16_f32 v28, -v91, -v93
    v_cvt_pk_bf16_f32 v29, -v95, -v95
    v_cvt_pk_bf16_f32 v30, -v99, -v101
    v_cvt_pk_bf16_f32 v31, -v103, -v103
    ds_write_b128 v3, v[28:31] offset:4096
    s_waitcnt lgkmcnt(6)
    v_mfma_f32_32x32x16_bf16 v[32:47], v[164:167], v[116:119], v[32:47]
    ds_read_b64_tr_b16 v[48:49], v4 offset:4096
    ds_read_b64_tr_b16 v[50:51], v5 offset:4352
    ds_read_b64_tr_b16 v[52:53], v4 offset:5120
    ds_read_b64_tr_b16 v[54:55], v5 offset:5376
    s_waitcnt lgkmcnt(8)
    v_mfma_f32_32x32x16_bf16 v[32:47], v[168:171], v[120:123], v[32:47]
    ds_read_b64_tr_b16 v[56:57], v4 offset:6144
    ds_read_b64_tr_b16 v[58:59], v5 offset:6400
    ds_read_b64_tr_b16 v[60:61], v4 offset:7168
    ds_read_b64_tr_b16 v[62:63], v5 offset:7424
    s_waitcnt lgkmcnt(10)
    v_mfma_f32_32x32x16_bf16 v[32:47], v[172:175], v[124:127], v[32:47]
    s_waitcnt lgkmcnt(6)
    v_mfma_f32_32x32x16_bf16 v[32:47], v[48:51], v[128:131], v[32:47]
    s_waitcnt lgkmcnt(4)
    v_mfma_f32_32x32x16_bf16 v[32:47], v[52:55], v[132:135], v[32:47]
    s_waitcnt lgkmcnt(2)
    v_mfma_f32_32x32x16_bf16 v[32:47], v[56:59], v[136:139], v[32:47]
    s_waitcnt lgkmcnt(0)
    v_mfma_f32_32x32x16_bf16 v[32:47], v[60:63], v[140:143], v[32:47]
    v_lshrrev_b32 v13, 5, v250
    v_and_b32 v14, 31, v250
    v_mov_b32 v16, 0
    v_mov_b32 v17, 0
    v_mov_b32 v18, 0
    v_mov_b32 v19, 0
    v_cmp_eq_u32 vcc, 0, v250
    v_mul_u32_u24 v9, 4640, v13
    v_min_u32 v10, 28, v14
    v_lshlrev_b32 v11, 16, v149
    v_cndmask_b32 v11, 0, v11, vcc
    v_lshl_add_u32 v9, v10, 4, v9
    v_add_u32 v9, s51, v9
    ds_write_b128 v9, v[16:19] offset:4080
    v_add_f32 v32, v32, v11
    v_lshlrev_b32 v10, 4, v250
    v_sub_u32 v10, 3056, v10
    v_add_u32 v8, s51, v10
    v_lshlrev_b32 v10, 10, v13
    v_lshl_add_u32 v10, v14, 4, v10
    v_sub_u32 v10, 1520, v10
    v_add_u32 v9, s51, v10
    v_and_b32 v10, 1, v250
    v_cmp_eq_u32 vcc, 1, v10
    v_cvt_pk_bf16_f32 v64, v39, v38
    v_cvt_pk_bf16_f32 v65, v37, v36
    v_cvt_pk_bf16_f32 v66, v35, v34
    v_cvt_pk_bf16_f32 v67, v33, v32
    v_cndmask_b32 v96, v43, v44, vcc
    v_cndmask_b32 v97, v45, v46, vcc
    ds_write_b128 v8, v[64:67] offset:5664
    v_cvt_pk_bf16_f32 v68, v38, v37
    v_cvt_pk_bf16_f32 v69, v36, v35
    v_cvt_pk_bf16_f32 v70, v34, v33
    ds_write_b96 v8, v[68:70] offset:1024
    ds_write_b16_d16_hi v8, v67 offset:1036
    v_cvt_pk_bf16_f32 v72, v42, v42
    v_cvt_pk_bf16_f32 v73, v41, v41
    v_cvt_pk_bf16_f32 v74, v41, v40
    v_cvt_pk_bf16_f32 v75, v40, v40
    ds_write_b128 v8, v[72:75] offset:4640
    v_cvt_pk_bf16_f32 v76, v42, v41
    v_mov_b32 v77, v73
    v_mov_b32 v78, v75
    v_mov_b32 v79, v75
    ds_write_b128 v8, v[76:79]
    ds_write_b16 v8, v64 offset:1022
    v_cvt_pk_bf16_f32 v80, v44, v44
    v_cvt_pk_bf16_f32 v81, v44, v96
    v_cvt_pk_bf16_f32 v82, v43, v43
    v_mov_b32 v83, v82
    ds_write_b128 v9, v[80:83] offset:5152
    v_mov_b32 v84, v80
    v_cvt_pk_bf16_f32 v85, v96, v43
    v_mov_b32 v86, v82
    v_mov_b32 v87, v82
    ds_write_b128 v9, v[84:87] offset:512
    v_cvt_pk_bf16_f32 v88, v46, v46
    v_cvt_pk_bf16_f32 v89, v46, v97
    v_cvt_pk_bf16_f32 v90, v45, v45
    v_mov_b32 v91, v90
    ds_write_b128 v9, v[88:91] offset:4640
    v_mov_b32 v92, v88
    v_cvt_pk_bf16_f32 v93, v97, v45
    v_mov_b32 v94, v90
    v_mov_b32 v95, v90
    ds_write_b128 v9, v[92:95] offset:0
    v_mov_b64 v[32:33], 0
    v_mov_b64 v[34:35], 0
    v_mov_b64 v[36:37], 0
    v_mov_b64 v[38:39], 0
    v_mov_b64 v[40:41], 0
    v_mov_b64 v[42:43], 0
    v_mov_b64 v[44:45], 0
    v_mov_b64 v[46:47], 0
    v_mov_b64 v[48:49], 0
    v_mov_b64 v[50:51], 0
    v_mov_b64 v[52:53], 0
    v_mov_b64 v[54:55], 0
    v_mov_b64 v[56:57], 0
    v_mov_b64 v[58:59], 0
    v_mov_b64 v[60:61], 0
    v_mov_b64 v[62:63], 0
    v_mov_b32 v12, 0
    v_mov_b32 v13, 0
    v_mov_b32 v14, 0
    v_mov_b32 v15, 0
    v_mov_b32 v16, 0
    v_mov_b32 v17, 0
    v_mov_b32 v18, 0
    v_mov_b32 v19, 0
    v_mov_b32 v20, 0
    v_mov_b32 v21, 0
    v_mov_b32 v22, 0
    v_mov_b32 v23, 0
    v_mov_b32 v24, 0
    v_mov_b32 v25, 0
    v_mov_b32 v26, 0
    v_mov_b32 v27, 0
    v_mov_b32 v28, 0
    v_mov_b32 v29, 0
    v_mov_b32 v30, 0
    v_mov_b32 v31, 0
    s_movk_i32 s62, 999
    v_mov_b32 v247, 163712
    v_mov_b32 v246, 1
    v_add_u32 v211, 64, v209
    v_mov_b32 v245, 0
    v_mov_b32 v248, 0
    v_mov_b32 v249, 0
    s_mov_b32 exec_hi, 0
    s_mov_b32 exec_lo, 0x7fffffff
    ds_write_b32 v207, v244
    s_mov_b64 exec, -1
    s_waitcnt vmcnt(0)
    ds_write_b128 v206, v[176:179] offset:4
    ds_write_b128 v206, v[180:183] offset:20
    ds_write_b128 v206, v[184:187] offset:36
    ds_write_b128 v206, v[188:191] offset:52
    v_pk_mov_b32 v[160:161], v[176:177], v[178:179] op_sel:[1,0]
    v_pk_mov_b32 v[162:163], v[178:179], v[180:181] op_sel:[1,0]
    v_pk_mov_b32 v[164:165], v[180:181], v[182:183] op_sel:[1,0]
    v_pk_mov_b32 v[166:167], v[182:183], v[184:185] op_sel:[1,0]
    v_pk_mov_b32 v[168:169], v[184:185], v[186:187] op_sel:[1,0]
    v_pk_mov_b32 v[170:171], v[186:187], v[188:189] op_sel:[1,0]
    v_pk_mov_b32 v[172:173], v[188:189], v[190:191] op_sel:[1,0]
    v_mov_b32 v174, v191
    ds_write_b32 v206, v176 offset:4224
    ds_write_b128 v206, v[160:163] offset:4228
    ds_write_b128 v206, v[164:167] offset:4244
    ds_write_b128 v206, v[168:171] offset:4260
    ds_write_b96 v206, v[172:174] offset:4276
    v_mov_b32 v240, 163760
    v_mov_b32 v241, 1
    s_mov_b64 exec, 1
    ds_add_u32 v240, v241
    s_mov_b64 exec, -1
    ds_read_b128 v[64:67], v204 offset:3712
    ds_read_b128 v[68:71], v204 offset:3200
    ds_read_b128 v[72:75], v204 offset:2688
    ds_read_b128 v[76:79], v204 offset:2176
    ds_read_b128 v[80:83], v204 offset:1664
    ds_read_b128 v[84:87], v204 offset:1152
    ds_read_b128 v[88:91], v204 offset:640
    ds_read_b128 v[92:95], v204 offset:128
    s_mov_b32 s44, 1000000
    v_mov_b32 v6, 163760
L_lw_5:
    ds_read_b32 v7, v6
    s_waitcnt lgkmcnt(0)
    v_readfirstlane_b32 s45, v7
    s_cmp_ge_u32 s45, 4
    s_cbranch_scc1 L_ld_6
    s_sleep 2
    s_sub_u32 s44, s44, 1
    s_cmp_lg_u32 s44, 0
    s_cbranch_scc1 L_lw_5
L_ld_6:
    s_setprio 1
    ds_read_b64 v[96:97], v205 offset:128
    ds_read_b64 v[98:99], v205 offset:136
    ds_read_b64 v[100:101], v205 offset:640
    ds_read_b64 v[102:103], v205 offset:648
    ds_read_b64 v[104:105], v205 offset:1152
    ds_read_b64 v[106:107], v205 offset:1160
    ds_read_b64 v[108:109], v205 offset:1664
    ds_read_b64 v[110:111], v205 offset:1672
    ds_read_b64 v[112:113], v205 offset:2176
    ds_read_b64 v[114:115], v205 offset:2184
    ds_read_b64 v[116:117], v205 offset:2688
    ds_read_b64 v[118:119], v205 offset:2696
    ds_read_b64 v[120:121], v205 offset:3200
    ds_read_b64 v[122:123], v205 offset:3208
    ds_read_b64 v[124:125], v205 offset:3712
    ds_read_b64 v[126:127], v205 offset:3720
    s_mov_b32 s3, 0
L_ssm_conv:
    s_waitcnt lgkmcnt(0)
    v_mfma_f32_16x16x32_bf16 v[32:35], v[64:67], v[96:99], v[32:35]
    ds_read_b128 v[128:131], v204 offset:3648
    v_mfma_f32_16x16x32_bf16 v[36:39], v[64:67], v[100:103], v[36:39]
    ds_read_b64 v[160:161], v205 offset:64
    v_mfma_f32_16x16x32_bf16 v[40:43], v[64:67], v[104:107], v[40:43]
    ds_read_b64 v[162:163], v205 offset:72
    v_mfma_f32_16x16x32_bf16 v[44:47], v[64:67], v[108:111], v[44:47]
    ds_read_b128 v[132:135], v204 offset:3136
    v_mfma_f32_16x16x32_bf16 v[48:51], v[64:67], v[112:115], v[48:51]
    ds_read_b64 v[164:165], v205 offset:576
    v_mfma_f32_16x16x32_bf16 v[52:55], v[64:67], v[116:119], v[52:55]
    ds_read_b64 v[166:167], v205 offset:584
    v_mfma_f32_16x16x32_bf16 v[56:59], v[64:67], v[120:123], v[56:59]
    ds_read_b128 v[136:139], v204 offset:2624
    v_mfma_f32_16x16x32_bf16 v[60:63], v[64:67], v[124:127], v[60:63]
    ds_read_b64 v[168:169], v205 offset:1088
    v_mfma_f32_16x16x32_bf16 v[36:39], v[68:71], v[96:99], v[36:39]
    ds_read_b64 v[170:171], v205 offset:1096
    v_mfma_f32_16x16x32_bf16 v[40:43], v[68:71], v[100:103], v[40:43]
    ds_read_b128 v[140:143], v204 offset:2112
    v_mfma_f32_16x16x32_bf16 v[44:47], v[68:71], v[104:107], v[44:47]
    ds_read_b64 v[172:173], v205 offset:1600
    v_mfma_f32_16x16x32_bf16 v[48:51], v[68:71], v[108:111], v[48:51]
    ds_read_b64 v[174:175], v205 offset:1608
    v_mfma_f32_16x16x32_bf16 v[52:55], v[68:71], v[112:115], v[52:55]
    ds_read_b128 v[144:147], v204 offset:1600
    v_mfma_f32_16x16x32_bf16 v[56:59], v[68:71], v[116:119], v[56:59]
    ds_read_b64 v[176:177], v205 offset:2112
    v_mfma_f32_16x16x32_bf16 v[60:63], v[68:71], v[120:123], v[60:63]
    ds_read_b64 v[178:179], v205 offset:2120
    v_mfma_f32_16x16x32_bf16 v[40:43], v[72:75], v[96:99], v[40:43]
    ds_read_b128 v[148:151], v204 offset:1088
    v_mfma_f32_16x16x32_bf16 v[44:47], v[72:75], v[100:103], v[44:47]
    ds_read_b64 v[180:181], v205 offset:2624
    v_mfma_f32_16x16x32_bf16 v[48:51], v[72:75], v[104:107], v[48:51]
    ds_read_b64 v[182:183], v205 offset:2632
    v_mfma_f32_16x16x32_bf16 v[52:55], v[72:75], v[108:111], v[52:55]
    ds_read_b128 v[152:155], v204 offset:576
    v_mfma_f32_16x16x32_bf16 v[56:59], v[72:75], v[112:115], v[56:59]
    ds_read_b64 v[184:185], v205 offset:3136
    v_mfma_f32_16x16x32_bf16 v[60:63], v[72:75], v[116:119], v[60:63]
    ds_read_b64 v[186:187], v205 offset:3144
    v_mfma_f32_16x16x32_bf16 v[44:47], v[76:79], v[96:99], v[44:47]
    ds_read_b128 v[156:159], v204 offset:64
    v_mfma_f32_16x16x32_bf16 v[48:51], v[76:79], v[100:103], v[48:51]
    ds_read_b64 v[188:189], v205 offset:3648
    v_mfma_f32_16x16x32_bf16 v[52:55], v[76:79], v[104:107], v[52:55]
    ds_read_b64 v[190:191], v205 offset:3656
    v_mfma_f32_16x16x32_bf16 v[56:59], v[76:79], v[108:111], v[56:59]
    v_mfma_f32_16x16x32_bf16 v[60:63], v[76:79], v[112:115], v[60:63]
    v_mfma_f32_16x16x32_bf16 v[48:51], v[80:83], v[96:99], v[48:51]
    v_mfma_f32_16x16x32_bf16 v[52:55], v[80:83], v[100:103], v[52:55]
    v_mfma_f32_16x16x32_bf16 v[56:59], v[80:83], v[104:107], v[56:59]
    v_mfma_f32_16x16x32_bf16 v[60:63], v[80:83], v[108:111], v[60:63]
    v_mfma_f32_16x16x32_bf16 v[52:55], v[84:87], v[96:99], v[52:55]
    v_mfma_f32_16x16x32_bf16 v[56:59], v[84:87], v[100:103], v[56:59]
    v_mfma_f32_16x16x32_bf16 v[60:63], v[84:87], v[104:107], v[60:63]
    v_mfma_f32_16x16x32_bf16 v[56:59], v[88:91], v[96:99], v[56:59]
    v_mfma_f32_16x16x32_bf16 v[60:63], v[88:91], v[100:103], v[60:63]
    v_mfma_f32_16x16x32_bf16 v[60:63], v[92:95], v[96:99], v[60:63]
    s_waitcnt lgkmcnt(0)
    v_mfma_f32_16x16x32_bf16 v[32:35], v[128:131], v[160:163], v[32:35]
    ds_read_b128 v[64:67], v204 offset:3584
    v_mfma_f32_16x16x32_bf16 v[36:39], v[128:131], v[164:167], v[36:39]
    ds_read_b64 v[96:97], v205 offset:0
    v_mfma_f32_16x16x32_bf16 v[40:43], v[128:131], v[168:171], v[40:43]
    ds_read_b64 v[98:99], v205 offset:8
    v_mfma_f32_16x16x32_bf16 v[44:47], v[128:131], v[172:175], v[44:47]
    ds_read_b128 v[68:71], v204 offset:3072
    v_mfma_f32_16x16x32_bf16 v[48:51], v[128:131], v[176:179], v[48:51]
    ds_read_b64 v[100:101], v205 offset:512
    v_mfma_f32_16x16x32_bf16 v[52:55], v[128:131], v[180:183], v[52:55]
    ds_read_b64 v[102:103], v205 offset:520
    v_mfma_f32_16x16x32_bf16 v[56:59], v[128:131], v[184:187], v[56:59]
    ds_read_b128 v[72:75], v204 offset:2560
    v_mfma_f32_16x16x32_bf16 v[60:63], v[128:131], v[188:191], v[60:63]
    ds_read_b64 v[104:105], v205 offset:1024
    v_mfma_f32_16x16x32_bf16 v[36:39], v[132:135], v[160:163], v[36:39]
    ds_read_b64 v[106:107], v205 offset:1032
    v_mfma_f32_16x16x32_bf16 v[40:43], v[132:135], v[164:167], v[40:43]
    ds_read_b128 v[76:79], v204 offset:2048
    v_mfma_f32_16x16x32_bf16 v[44:47], v[132:135], v[168:171], v[44:47]
    ds_read_b64 v[108:109], v205 offset:1536
    v_mfma_f32_16x16x32_bf16 v[48:51], v[132:135], v[172:175], v[48:51]
    ds_read_b64 v[110:111], v205 offset:1544
    v_mfma_f32_16x16x32_bf16 v[52:55], v[132:135], v[176:179], v[52:55]
    ds_read_b128 v[80:83], v204 offset:1536
    v_mfma_f32_16x16x32_bf16 v[56:59], v[132:135], v[180:183], v[56:59]
    ds_read_b64 v[112:113], v205 offset:2048
    v_mfma_f32_16x16x32_bf16 v[60:63], v[132:135], v[184:187], v[60:63]
    ds_read_b64 v[114:115], v205 offset:2056
    v_mfma_f32_16x16x32_bf16 v[40:43], v[136:139], v[160:163], v[40:43]
    ds_read_b128 v[84:87], v204 offset:1024
    v_mfma_f32_16x16x32_bf16 v[44:47], v[136:139], v[164:167], v[44:47]
    ds_read_b64 v[116:117], v205 offset:2560
    v_mfma_f32_16x16x32_bf16 v[48:51], v[136:139], v[168:171], v[48:51]
    ds_read_b64 v[118:119], v205 offset:2568
    v_mfma_f32_16x16x32_bf16 v[52:55], v[136:139], v[172:175], v[52:55]
    ds_read_b128 v[88:91], v204 offset:512
    v_mfma_f32_16x16x32_bf16 v[56:59], v[136:139], v[176:179], v[56:59]
    ds_read_b64 v[120:121], v205 offset:3072
    v_mfma_f32_16x16x32_bf16 v[60:63], v[136:139], v[180:183], v[60:63]
    ds_read_b64 v[122:123], v205 offset:3080
    v_mfma_f32_16x16x32_bf16 v[44:47], v[140:143], v[160:163], v[44:47]
    ds_read_b128 v[92:95], v204 offset:0
    v_mfma_f32_16x16x32_bf16 v[48:51], v[140:143], v[164:167], v[48:51]
    ds_read_b64 v[124:125], v205 offset:3584
    v_mfma_f32_16x16x32_bf16 v[52:55], v[140:143], v[168:171], v[52:55]
    ds_read_b64 v[126:127], v205 offset:3592
    v_mfma_f32_16x16x32_bf16 v[56:59], v[140:143], v[172:175], v[56:59]
    v_mfma_f32_16x16x32_bf16 v[60:63], v[140:143], v[176:179], v[60:63]
    v_mfma_f32_16x16x32_bf16 v[48:51], v[144:147], v[160:163], v[48:51]
    v_mfma_f32_16x16x32_bf16 v[52:55], v[144:147], v[164:167], v[52:55]
    v_mfma_f32_16x16x32_bf16 v[56:59], v[144:147], v[168:171], v[56:59]
    v_mfma_f32_16x16x32_bf16 v[60:63], v[144:147], v[172:175], v[60:63]
    v_mfma_f32_16x16x32_bf16 v[52:55], v[148:151], v[160:163], v[52:55]
    v_mfma_f32_16x16x32_bf16 v[56:59], v[148:151], v[164:167], v[56:59]
    v_mfma_f32_16x16x32_bf16 v[60:63], v[148:151], v[168:171], v[60:63]
    v_mfma_f32_16x16x32_bf16 v[56:59], v[152:155], v[160:163], v[56:59]
    v_mfma_f32_16x16x32_bf16 v[60:63], v[152:155], v[164:167], v[60:63]
    v_mfma_f32_16x16x32_bf16 v[60:63], v[156:159], v[160:163], v[60:63]
    v_subrev_u32 v204, 128, v204
    v_subrev_u32 v205, 128, v205
    s_add_u32 s3, s3, 1
    s_cmp_lt_u32 s3, 4
    s_cbranch_scc1 L_ssm_conv
    s_mov_b64 exec, 1
    ds_add_u32 v247, v246 offset:48
    s_mov_b64 exec, -1
    s_branch L_side2
L_side:
    v_mov_b32 v12, 0
    v_mov_b32 v13, 0
    v_mov_b32 v14, 0
    v_mov_b32 v15, 0
    v_mov_b32 v16, 0
    v_mov_b32 v17, 0
    v_mov_b32 v18, 0
    v_mov_b32 v19, 0
    v_mov_b32 v20, 0
    v_mov_b32 v21, 0
    v_mov_b32 v22, 0
    v_mov_b32 v23, 0
    v_mov_b32 v24, 0
    v_mov_b32 v25, 0
    v_mov_b32 v26, 0
    v_mov_b32 v27, 0
    v_mov_b32 v28, 0
    v_mov_b32 v29, 0
    v_mov_b32 v30, 0
    v_mov_b32 v31, 0
    s_mul_i32 s62, s37, 12
    s_add_u32 s62, s62, s38
    s_sub_u32 s62, s62, 21
    s_lshl_b32 s62, s62, 2
    s_add_u32 s62, s62, s32
    v_and_b32 v248, 15, v250
    v_lshlrev_b32 v248, 3, v248
    s_lshr_b32 s57, s62, 5
    s_and_b32 s63, s62, 31
    s_lshl_b32 s54, s57, 7
    s_add_u32 s54, s54, 8192
    v_add_u32 v248, s54, v248
    v_lshrrev_b32 v9, 5, v248
    v_mul_u32_u24 v9, 4352, v9
    v_and_b32 v248, 31, v248
    v_add_u32 v248, v248, v9
    v_add_u32 v248, 16777216, v248
    v_lshrrev_b32 v9, 3, v250
    v_and_b32 v8, 7, v250
    v_lshlrev_b32 v249, 15, v8
    v_lshl_add_u32 v249, v9, 4, v249
    v_mul_u32_u24 v245, 20480, v9
    v_lshl_add_u32 v245, v8, 4, v245
    v_mov_b32 v247, 163712
    v_mov_b32 v246, 1
L_side2:
    s_setprio 0
    s_mov_b32 s8, s82
    s_and_b32 s9, s83, 0xffff
    s_mov_b32 s10, 819200
    s_mov_b32 s11, 0x00020000
    s_mov_b32 s12, s84
    s_and_b32 s13, s85, 0xffff
    s_mov_b32 s14, 5242880
    s_mov_b32 s15, 0x00020000
    s_setprio 3
    s_mov_b32 s44, 1000000
L_wp_7:
    ds_read_b32 v8, v195
    s_waitcnt lgkmcnt(0)
    v_cmp_le_u32 vcc, 2, v8
    s_cmp_eq_u64 vcc, -1
    s_cbranch_scc1 L_wp_7_d
    s_sleep 12
    s_sub_u32 s44, s44, 1
    s_cmp_lg_u32 s44, 0
    s_cbranch_scc1 L_wp_7
L_wp_7_d:
    s_mov_b32 s44, 1000000
L_pl_8:
    buffer_load_dwordx2 v[4:5], v194, s[16:19], 0 offen sc1
    s_waitcnt vmcnt(0)
    v_cmp_eq_u64 s[46:47], s[42:43], v[4:5]
    s_cmp_eq_u64 s[46:47], -1
    s_cbranch_scc1 L_pd_9
    s_sleep 6
    s_sub_u32 s44, s44, 1
    s_cmp_lg_u32 s44, 0
    s_cbranch_scc1 L_pl_8
L_pd_9:
    s_cmp_ge_u32 s38, 20
    s_cbranch_scc1 L_cv_10_d
    s_mov_b32 s44, 1000000
L_cv_10:
    ds_read_b32 v8, v247 offset:48
    s_waitcnt lgkmcnt(0)
    v_readfirstlane_b32 s45, v8
    s_cmp_ge_u32 s45, 8
    s_cbranch_scc1 L_cv_10_d
    s_sleep 4
    s_sub_u32 s44, s44, 1
    s_cmp_lg_u32 s44, 0
    s_cbranch_scc1 L_cv_10
L_cv_10_d:
    s_setprio 0
    s_add_u32 s54, s41, 17
    s_min_u32 s54, s54, 31
    s_mul_i32 s56, s54, 5120
    s_add_u32 s60, s56, s52
    s_sub_u32 s55, s56, 143360
    s_cmp_ge_u32 s54, 28
    s_cselect_b32 s56, s55, s56
    s_mov_b32 m0, s56
    s_add_u32 s59, s60, 4096
    buffer_load_dwordx4 v192, s[16:19], s60 offen offset:0 sc1 lds
    buffer_load_dwordx4 v192, s[16:19], s60 offen offset:1024 sc1 lds
    buffer_load_dwordx4 v192, s[16:19], s60 offen offset:2048 sc1 lds
    buffer_load_dwordx4 v192, s[16:19], s60 offen offset:3072 sc1 lds
    s_add_u32 m0, m0, 4096
    s_nop 0
    buffer_load_dwordx4 v192, s[16:19], s59 offen sc1 lds
    s_mov_b64 exec, 1
    s_waitcnt vmcnt(0)
    ds_add_u32 v247, v246 offset:16
    s_mov_b64 exec, -1
    s_sleep 8
    s_add_u32 s54, s41, 21
    s_min_u32 s54, s54, 31
    s_mul_i32 s56, s54, 5120
    s_add_u32 s60, s56, s52
    s_sub_u32 s55, s56, 143360
    s_cmp_ge_u32 s54, 28
    s_cselect_b32 s56, s55, s56
    s_mov_b32 m0, s56
    s_add_u32 s59, s60, 4096
    buffer_load_dwordx4 v192, s[16:19], s60 offen offset:0 sc1 lds
    buffer_load_dwordx4 v192, s[16:19], s60 offen offset:1024 sc1 lds
    buffer_load_dwordx4 v192, s[16:19], s60 offen offset:2048 sc1 lds
    buffer_load_dwordx4 v192, s[16:19], s60 offen offset:3072 sc1 lds
    s_add_u32 m0, m0, 4096
    s_nop 0
    buffer_load_dwordx4 v192, s[16:19], s59 offen sc1 lds
    s_mov_b64 exec, 1
    s_waitcnt vmcnt(0)
    ds_add_u32 v247, v246 offset:20
    s_mov_b64 exec, -1
    s_cmp_ge_u32 s38, 20
    s_cbranch_scc1 L_s_ny
    s_setprio 0
    s_waitcnt lgkmcnt(0)
    v_cvt_pk_bf16_f32 v64, v32, v33
    v_cvt_pk_bf16_f32 v65, v34, v35
    v_cvt_pk_bf16_f32 v66, v36, v37
    v_cvt_pk_bf16_f32 v67, v38, v39
    v_cvt_pk_bf16_f32 v68, v40, v41
    v_cvt_pk_bf16_f32 v69, v42, v43
    v_cvt_pk_bf16_f32 v70, v44, v45
    v_cvt_pk_bf16_f32 v71, v46, v47
    v_cvt_pk_bf16_f32 v72, v48, v49
    v_cvt_pk_bf16_f32 v73, v50, v51
    v_cvt_pk_bf16_f32 v74, v52, v53
    v_cvt_pk_bf16_f32 v75, v54, v55
    v_cvt_pk_bf16_f32 v76, v56, v57
    v_cvt_pk_bf16_f32 v77, v58, v59
    v_cvt_pk_bf16_f32 v78, v60, v61
    v_cvt_pk_bf16_f32 v79, v62, v63
    ds_write2st64_b32 v209, v64, v66 offset0:20 offset1:22
    ds_write2st64_b32 v211, v65, v67 offset0:20 offset1:22
    ds_write2st64_b32 v209, v68, v70 offset0:24 offset1:26
    ds_write2st64_b32 v211, v69, v71 offset0:24 offset1:26
    ds_write2st64_b32 v209, v72, v74 offset0:28 offset1:30
    ds_write2st64_b32 v211, v73, v75 offset0:28 offset1:30
    ds_write2st64_b32 v209, v76, v78 offset0:32 offset1:34
    ds_write2st64_b32 v211, v77, v79 offset0:32 offset1:34
    ds_read_b128 v[176:179], v210 offset:5120
    ds_read_b128 v[180:183], v210 offset:6144
    ds_read_b128 v[184:187], v210 offset:7168
    ds_read_b128 v[188:191], v210 offset:8192
    s_mov_b64 exec, 1
    ds_add_u32 v247, v246 offset:48
    s_mov_b64 exec, -1
    s_lshl_b32 s54, s50, 12
    s_add_u32 s54, s54, 13434880
    s_waitcnt lgkmcnt(0)
    buffer_store_dwordx4 v[176:179], v192, s[16:19], s54 offen offset:0 sc1
    buffer_store_dwordx4 v[180:183], v192, s[16:19], s54 offen offset:1024 sc1
    buffer_store_dwordx4 v[184:187], v192, s[16:19], s54 offen offset:2048 sc1
    buffer_store_dwordx4 v[188:191], v192, s[16:19], s54 offen offset:3072 sc1
    s_waitcnt vmcnt(0)
    s_setprio 3
    v_mov_b32 v8, 163764
    v_mov_b32 v9, 1
    s_mov_b64 exec, 1
    ds_add_rtn_u32 v9, v8, v9
    s_waitcnt lgkmcnt(0)
    v_readfirstlane_b32 s54, v9
    s_mov_b64 exec, -1
    s_cmp_lg_u32 s54, 7
    s_cbranch_scc1 L_s_ny
    s_lshr_b32 s54, s50, 2
    s_lshl_b32 s54, s54, 3
    s_add_u32 s54, s54, 8192
    s_lshr_b32 s31, s54, 5
    s_mul_i32 s31, s31, 4352
    s_and_b32 s54, s54, 31
    s_add_u32 s54, s54, s31
    s_add_u32 s54, s54, 16777216
    v_mov_b32 v8, s42
    v_mov_b32 v9, s43
    v_lshlrev_b32 v10, 3, v250
    s_mov_b64 exec, 0x1
    buffer_store_dwordx2 v[8:9], v10, s[16:19], s54 offen sc1
    s_mov_b64 exec, -1
L_s_ny:
    s_cmp_ge_u32 s38, 20
    s_cbranch_scc1 L_cv_11_d
    s_mov_b32 s44, 1000000
L_cv_11:
    ds_read_b32 v8, v247 offset:48
    s_waitcnt lgkmcnt(0)
    v_readfirstlane_b32 s45, v8
    s_cmp_ge_u32 s45, 12
    s_cbranch_scc1 L_cv_11_d
    s_sleep 4
    s_sub_u32 s44, s44, 1
    s_cmp_lg_u32 s44, 0
    s_cbranch_scc1 L_cv_11
L_cv_11_d:
    s_setprio 0
    s_add_u32 s54, s41, 25
    s_min_u32 s54, s54, 31
    s_mul_i32 s56, s54, 5120
    s_add_u32 s60, s56, s52
    s_sub_u32 s55, s56, 143360
    s_cmp_ge_u32 s54, 28
    s_cselect_b32 s56, s55, s56
    s_mov_b32 m0, s56
    s_add_u32 s59, s60, 4096
    buffer_load_dwordx4 v192, s[16:19], s60 offen offset:0 sc1 lds
    buffer_load_dwordx4 v192, s[16:19], s60 offen offset:1024 sc1 lds
    buffer_load_dwordx4 v192, s[16:19], s60 offen offset:2048 sc1 lds
    buffer_load_dwordx4 v192, s[16:19], s60 offen offset:3072 sc1 lds
    s_add_u32 m0, m0, 4096
    s_nop 0
    buffer_load_dwordx4 v192, s[16:19], s59 offen sc1 lds
    s_mov_b64 exec, 1
    s_waitcnt vmcnt(0)
    ds_add_u32 v247, v246 offset:24
    s_mov_b64 exec, -1
    s_sleep 8
    s_add_u32 s54, s41, 29
    s_min_u32 s54, s54, 31
    s_mul_i32 s56, s54, 5120
    s_add_u32 s60, s56, s52
    s_sub_u32 s55, s56, 143360
    s_cmp_ge_u32 s54, 28
    s_cselect_b32 s56, s55, s56
    s_mov_b32 m0, s56
    s_add_u32 s59, s60, 4096
    buffer_load_dwordx4 v192, s[16:19], s60 offen offset:0 sc1 lds
    buffer_load_dwordx4 v192, s[16:19], s60 offen offset:1024 sc1 lds
    buffer_load_dwordx4 v192, s[16:19], s60 offen offset:2048 sc1 lds
    buffer_load_dwordx4 v192, s[16:19], s60 offen offset:3072 sc1 lds
    s_add_u32 m0, m0, 4096
    s_nop 0
    buffer_load_dwordx4 v192, s[16:19], s59 offen sc1 lds
    s_mov_b64 exec, 1
    s_waitcnt vmcnt(0)
    ds_add_u32 v247, v246 offset:28
    s_mov_b64 exec, -1
    s_add_u32 s54, s41, 0
    s_mul_i32 s60, s54, 40960
    s_mul_i32 s54, s54, 5120
    s_add_u32 m0, s54, 20480
    s_nop 0
    buffer_load_dwordx4 v202, s[8:11], s60 offen offset:0 lds
    buffer_load_dwordx4 v203, s[8:11], s60 offen offset:1024 lds
    buffer_load_dwordx4 v251, s[8:11], s60 offen offset:2048 lds
    buffer_load_dwordx4 v252, s[8:11], s60 offen offset:3072 lds
    s_add_u32 m0, m0, 4096
    s_nop 0
    buffer_load_dwordx4 v253, s[8:11], s60 offen offset:0 lds
    s_mov_b32 s44, 1000000
L_wp_12:
    ds_read_b32 v8, v195
    s_waitcnt lgkmcnt(0)
    v_cmp_le_u32 vcc, 3, v8
    s_cmp_eq_u64 vcc, -1
    s_cbranch_scc1 L_wp_12_d
    s_sleep 8
    s_sub_u32 s44, s44, 1
    s_cmp_lg_u32 s44, 0
    s_cbranch_scc1 L_wp_12
L_wp_12_d:
    s_add_u32 s54, s41, 4
    s_mul_i32 s60, s54, 40960
    s_mul_i32 s54, s54, 5120
    s_add_u32 m0, s54, 20480
    s_nop 0
    buffer_load_dwordx4 v202, s[8:11], s60 offen offset:0 lds
    buffer_load_dwordx4 v203, s[8:11], s60 offen offset:1024 lds
    buffer_load_dwordx4 v251, s[8:11], s60 offen offset:2048 lds
    buffer_load_dwordx4 v252, s[8:11], s60 offen offset:3072 lds
    s_add_u32 m0, m0, 4096
    s_nop 0
    buffer_load_dwordx4 v253, s[8:11], s60 offen offset:0 lds
    s_mov_b32 s44, 1000000
L_wp_13:
    ds_read_b32 v8, v195
    s_waitcnt lgkmcnt(0)
    v_cmp_le_u32 vcc, 4, v8
    s_cmp_eq_u64 vcc, -1
    s_cbranch_scc1 L_wp_13_d
    s_sleep 8
    s_sub_u32 s44, s44, 1
    s_cmp_lg_u32 s44, 0
    s_cbranch_scc1 L_wp_13
L_wp_13_d:
    s_add_u32 s54, s41, 8
    s_mul_i32 s60, s54, 40960
    s_mul_i32 s54, s54, 5120
    s_add_u32 m0, s54, 20480
    s_nop 0
    buffer_load_dwordx4 v202, s[8:11], s60 offen offset:0 lds
    buffer_load_dwordx4 v203, s[8:11], s60 offen offset:1024 lds
    buffer_load_dwordx4 v251, s[8:11], s60 offen offset:2048 lds
    buffer_load_dwordx4 v252, s[8:11], s60 offen offset:3072 lds
    s_add_u32 m0, m0, 4096
    s_nop 0
    buffer_load_dwordx4 v253, s[8:11], s60 offen offset:0 lds
    s_cmp_ge_u32 s62, 320
    s_cbranch_scc1 L_s_nt
    s_mov_b32 s44, 1000000
L_pl_14:
    buffer_load_dwordx2 v[4:5], v248, s[16:19], 0 offen sc1
    s_waitcnt vmcnt(0)
    v_cmp_eq_u64 s[46:47], s[42:43], v[4:5]
    s_cmp_eq_u64 s[46:47], -1
    s_cbranch_scc1 L_pd_15
    s_sleep 16
    s_sub_u32 s44, s44, 1
    s_cmp_lg_u32 s44, 0
    s_cbranch_scc1 L_pl_14
L_pd_15:
    s_lshl_b32 s54, s57, 18
    s_lshl_b32 s55, s63, 7
    s_add_u32 s54, s54, s55
    s_add_u32 s59, s54, 13434880
    buffer_load_dwordx4 v[64:67], v249, s[16:19], s59 offen sc1
    s_add_u32 s59, s59, 4096
    buffer_load_dwordx4 v[68:71], v249, s[16:19], s59 offen sc1
    s_add_u32 s59, s59, 4096
    buffer_load_dwordx4 v[72:75], v249, s[16:19], s59 offen sc1
    s_add_u32 s59, s59, 4096
    buffer_load_dwordx4 v[76:79], v249, s[16:19], s59 offen sc1
    s_add_u32 s59, s59, 4096
    buffer_load_dwordx4 v[80:83], v249, s[16:19], s59 offen sc1
    s_add_u32 s59, s59, 4096
    buffer_load_dwordx4 v[84:87], v249, s[16:19], s59 offen sc1
    s_add_u32 s59, s59, 4096
    buffer_load_dwordx4 v[88:91], v249, s[16:19], s59 offen sc1
    s_add_u32 s59, s59, 4096
    buffer_load_dwordx4 v[92:95], v249, s[16:19], s59 offen sc1
    s_add_u32 s59, s59, 4096
    s_mul_i32 s59, s63, 163840
    s_lshl_b32 s57, s57, 7
    s_add_u32 s59, s59, s57
    s_mov_b32 s54, 0x05040100
    s_mov_b32 s55, 0x07060302
    s_waitcnt vmcnt(0)
    s_setprio 3
    v_perm_b32 v96, v68, v64, s54
    v_perm_b32 v97, v76, v72, s54
    v_perm_b32 v98, v84, v80, s54
    v_perm_b32 v99, v92, v88, s54
    v_perm_b32 v100, v68, v64, s55
    v_perm_b32 v101, v76, v72, s55
    v_perm_b32 v102, v84, v80, s55
    v_perm_b32 v103, v92, v88, s55
    v_perm_b32 v104, v69, v65, s54
    v_perm_b32 v105, v77, v73, s54
    v_perm_b32 v106, v85, v81, s54
    v_perm_b32 v107, v93, v89, s54
    v_perm_b32 v108, v69, v65, s55
    v_perm_b32 v109, v77, v73, s55
    v_perm_b32 v110, v85, v81, s55
    v_perm_b32 v111, v93, v89, s55
    v_perm_b32 v112, v70, v66, s54
    v_perm_b32 v113, v78, v74, s54
    v_perm_b32 v114, v86, v82, s54
    v_perm_b32 v115, v94, v90, s54
    v_perm_b32 v116, v70, v66, s55
    v_perm_b32 v117, v78, v74, s55
    v_perm_b32 v118, v86, v82, s55
    v_perm_b32 v119, v94, v90, s55
    v_perm_b32 v120, v71, v67, s54
    v_perm_b32 v121, v79, v75, s54
    v_perm_b32 v122, v87, v83, s54
    v_perm_b32 v123, v95, v91, s54
    v_perm_b32 v124, v71, v67, s55
    v_perm_b32 v125, v79, v75, s55
    v_perm_b32 v126, v87, v83, s55
    v_perm_b32 v127, v95, v91, s55
    s_setprio 0
    buffer_store_dwordx4 v[96:99], v245, s[12:15], s59 offen sc1
    s_add_u32 s59, s59, 2560
    buffer_store_dwordx4 v[100:103], v245, s[12:15], s59 offen sc1
    s_add_u32 s59, s59, 2560
    buffer_store_dwordx4 v[104:107], v245, s[12:15], s59 offen sc1
    s_add_u32 s59, s59, 2560
    buffer_store_dwordx4 v[108:111], v245, s[12:15], s59 offen sc1
    s_add_u32 s59, s59, 2560
    buffer_store_dwordx4 v[112:115], v245, s[12:15], s59 offen sc1
    s_add_u32 s59, s59, 2560
    buffer_store_dwordx4 v[116:119], v245, s[12:15], s59 offen sc1
    s_add_u32 s59, s59, 2560
    buffer_store_dwordx4 v[120:123], v245, s[12:15], s59 offen sc1
    s_add_u32 s59, s59, 2560
    buffer_store_dwordx4 v[124:127], v245, s[12:15], s59 offen sc1
    s_add_u32 s59, s59, 2560
L_s_nt:
    s_mov_b32 s44, 1000000
L_wp_16:
    ds_read_b32 v8, v195
    s_waitcnt lgkmcnt(0)
    v_cmp_le_u32 vcc, 5, v8
    s_cmp_eq_u64 vcc, -1
    s_cbranch_scc1 L_wp_16_d
    s_sleep 8
    s_sub_u32 s44, s44, 1
    s_cmp_lg_u32 s44, 0
    s_cbranch_scc1 L_wp_16
L_wp_16_d:
    s_add_u32 s54, s41, 12
    s_mul_i32 s60, s54, 40960
    s_mul_i32 s54, s54, 5120
    s_add_u32 m0, s54, 20480
    s_nop 0
    buffer_load_dwordx4 v202, s[8:11], s60 offen offset:0 lds
    buffer_load_dwordx4 v203, s[8:11], s60 offen offset:1024 lds
    buffer_load_dwordx4 v251, s[8:11], s60 offen offset:2048 lds
    buffer_load_dwordx4 v252, s[8:11], s60 offen offset:3072 lds
    s_add_u32 m0, m0, 4096
    s_nop 0
    buffer_load_dwordx4 v253, s[8:11], s60 offen offset:0 lds
    s_mul_i32 s90, s58, 20480
    s_add_u32 s90, s90, 8060928
    s_add_u32 s91, s90, 4096
    s_add_u32 s92, s90, 8192
    s_add_u32 s93, s90, 12288
    s_add_u32 s94, s90, 16384
    s_mov_b32 s44, 1000000
L_wp_17:
    ds_read_b32 v8, v195
    s_waitcnt lgkmcnt(0)
    v_cmp_le_u32 vcc, 6, v8
    s_cmp_eq_u64 vcc, -1
    s_cbranch_scc1 L_wp_17_d
    s_sleep 8
    s_sub_u32 s44, s44, 1
    s_cmp_lg_u32 s44, 0
    s_cbranch_scc1 L_wp_17
L_wp_17_d:
    s_add_u32 s54, s41, 16
    s_mul_i32 s60, s54, 40960
    s_mul_i32 s54, s54, 5120
    s_add_u32 m0, s54, 20480
    s_nop 0
    buffer_load_dwordx4 v202, s[8:11], s60 offen offset:0 lds
    buffer_load_dwordx4 v203, s[8:11], s60 offen offset:1024 lds
    buffer_load_dwordx4 v251, s[8:11], s60 offen offset:2048 lds
    buffer_load_dwordx4 v252, s[8:11], s60 offen offset:3072 lds
    s_add_u32 m0, m0, 4096
    s_nop 0
    buffer_load_dwordx4 v253, s[8:11], s60 offen offset:0 lds
    s_waitcnt vmcnt(0)
    v_mov_b32 v8, 163752
    v_mov_b32 v9, 1
    s_mov_b64 exec, 1
    ds_add_u32 v8, v9
    s_mov_b64 exec, -1
    s_mov_b32 s44, 1000000
    v_mov_b32 v8, 163752
L_lw_18:
    ds_read_b32 v9, v8
    s_waitcnt lgkmcnt(0)
    v_readfirstlane_b32 s45, v9
    s_cmp_ge_u32 s45, 4
    s_cbranch_scc1 L_ld_19
    s_sleep 8
    s_sub_u32 s44, s44, 1
    s_cmp_lg_u32 s44, 0
    s_cbranch_scc1 L_lw_18
L_ld_19:
    v_mov_b32 v231, v208
    ds_read_b64_tr_b16 v[112:113], v196 offset:0
    ds_read_b64_tr_b16 v[114:115], v196 offset:1280
    ds_read_b64_tr_b16 v[116:117], v196 offset:32
    ds_read_b64_tr_b16 v[118:119], v196 offset:1312
    ds_read_b64_tr_b16 v[120:121], v196 offset:64
    ds_read_b64_tr_b16 v[122:123], v196 offset:1344
    ds_read_b64_tr_b16 v[124:125], v196 offset:96
    ds_read_b64_tr_b16 v[126:127], v196 offset:1376
    ds_read_b64_tr_b16 v[128:129], v196 offset:128
    ds_read_b64_tr_b16 v[130:131], v196 offset:1408
    ds_read_b64_tr_b16 v[132:133], v196 offset:6400
    ds_read_b64_tr_b16 v[134:135], v196 offset:7680
    ds_read_b64_tr_b16 v[136:137], v196 offset:6432
    ds_read_b64_tr_b16 v[138:139], v196 offset:7712
    ds_read_b64_tr_b16 v[140:141], v196 offset:6464
    ds_read_b64_tr_b16 v[142:143], v196 offset:7744
    ds_read_b64_tr_b16 v[144:145], v196 offset:6496
    ds_read_b64_tr_b16 v[146:147], v196 offset:7776
    ds_read_b64_tr_b16 v[148:149], v196 offset:6528
    ds_read_b64_tr_b16 v[150:151], v196 offset:7808
    ds_read_b64_tr_b16 v[152:153], v196 offset:12800
    ds_read_b64_tr_b16 v[154:155], v196 offset:14080
    ds_read_b64_tr_b16 v[156:157], v196 offset:12832
    ds_read_b64_tr_b16 v[158:159], v196 offset:14112
    ds_read_b64_tr_b16 v[160:161], v196 offset:12864
    ds_read_b64_tr_b16 v[162:163], v196 offset:14144
    ds_read_b64_tr_b16 v[164:165], v196 offset:12896
    ds_read_b64_tr_b16 v[166:167], v196 offset:14176
    ds_read_b64_tr_b16 v[168:169], v196 offset:12928
    ds_read_b64_tr_b16 v[170:171], v196 offset:14208
    ds_read_b64_tr_b16 v[172:173], v196 offset:19200
    ds_read_b64_tr_b16 v[174:175], v196 offset:20480
    ds_read_b64_tr_b16 v[176:177], v196 offset:19232
    ds_read_b64_tr_b16 v[178:179], v196 offset:20512
    ds_read_b64_tr_b16 v[180:181], v196 offset:19264
    ds_read_b64_tr_b16 v[182:183], v196 offset:20544
    ds_read_b64_tr_b16 v[184:185], v196 offset:19296
    ds_read_b64_tr_b16 v[186:187], v196 offset:20576
    ds_read_b64_tr_b16 v[188:189], v196 offset:19328
    ds_read_b64_tr_b16 v[190:191], v196 offset:20608
    ds_read_b64_tr_b16 v[204:205], v197 offset:2560
    ds_read_b64_tr_b16 v[206:207], v197 offset:15360
    ds_read_b64_tr_b16 v[208:209], v197 offset:2592
    ds_read_b64_tr_b16 v[210:211], v197 offset:15392
    ds_read_b64_tr_b16 v[212:213], v197 offset:2624
    ds_read_b64_tr_b16 v[214:215], v197 offset:15424
    ds_read_b64_tr_b16 v[216:217], v197 offset:2656
    ds_read_b64_tr_b16 v[218:219], v197 offset:15456
    ds_read_b64_tr_b16 v[220:221], v197 offset:2688
    ds_read_b64_tr_b16 v[222:223], v197 offset:15488
    s_mov_b32 s44, 1000000
L_wp_20:
    ds_read_b32 v8, v195
    s_waitcnt lgkmcnt(0)
    v_cmp_le_u32 vcc, 8, v8
    s_cmp_eq_u64 vcc, -1
    s_cbranch_scc1 L_wp_20_d
    s_sleep 4
    s_sub_u32 s44, s44, 1
    s_cmp_lg_u32 s44, 0
    s_cbranch_scc1 L_wp_20
L_wp_20_d:
    s_mov_b32 s44, 1000000
    v_mov_b32 v8, 163824
L_lw_21:
    ds_read_b32 v9, v8
    s_waitcnt lgkmcnt(0)
    v_readfirstlane_b32 s45, v9
    s_cmp_ge_u32 s45, 1
    s_cbranch_scc1 L_ld_22
    s_sleep 1
    s_sub_u32 s44, s44, 1
    s_cmp_lg_u32 s44, 0
    s_cbranch_scc1 L_lw_21
L_ld_22:
    buffer_load_dwordx4 v[32:35], v192, s[16:19], s90 offen offset:0 sc1
    buffer_load_dwordx4 v[36:39], v192, s[16:19], s90 offen offset:1024 sc1
    buffer_load_dwordx4 v[40:43], v192, s[16:19], s90 offen offset:2048 sc1
    buffer_load_dwordx4 v[44:47], v192, s[16:19], s90 offen offset:3072 sc1
    buffer_load_dwordx2 v[48:49], v193, s[16:19], s94 offen offset:0 sc1
    buffer_load_dwordx2 v[50:51], v193, s[16:19], s94 offen offset:512 sc1
    buffer_load_dwordx4 v[52:55], v192, s[16:19], s91 offen offset:0 sc1
    buffer_load_dwordx4 v[56:59], v192, s[16:19], s91 offen offset:1024 sc1
    buffer_load_dwordx4 v[60:63], v192, s[16:19], s91 offen offset:2048 sc1
    buffer_load_dwordx4 v[64:67], v192, s[16:19], s91 offen offset:3072 sc1
    s_waitcnt vmcnt(9)
    v_mfma_f32_16x16x32_bf16 v[12:15], v[112:115], v[32:35], v[12:15]
    v_mfma_f32_16x16x32_bf16 v[16:19], v[116:119], v[32:35], v[16:19]
    v_mfma_f32_16x16x32_bf16 v[20:23], v[120:123], v[32:35], v[20:23]
    v_mfma_f32_16x16x32_bf16 v[24:27], v[124:127], v[32:35], v[24:27]
    v_mfma_f32_16x16x32_bf16 v[28:31], v[128:131], v[32:35], v[28:31]
    buffer_load_dwordx2 v[68:69], v193, s[16:19], s94 offen offset:1024 sc1
    s_waitcnt vmcnt(9)
    v_mfma_f32_16x16x32_bf16 v[12:15], v[132:135], v[36:39], v[12:15]
    ds_read_b64_tr_b16 v[112:113], v196 offset:25600
    ds_read_b64_tr_b16 v[114:115], v196 offset:26880
    v_mfma_f32_16x16x32_bf16 v[16:19], v[136:139], v[36:39], v[16:19]
    ds_read_b64_tr_b16 v[116:117], v196 offset:25632
    ds_read_b64_tr_b16 v[118:119], v196 offset:26912
    v_mfma_f32_16x16x32_bf16 v[20:23], v[140:143], v[36:39], v[20:23]
    ds_read_b64_tr_b16 v[120:121], v196 offset:25664
    ds_read_b64_tr_b16 v[122:123], v196 offset:26944
    v_mfma_f32_16x16x32_bf16 v[24:27], v[144:147], v[36:39], v[24:27]
    ds_read_b64_tr_b16 v[124:125], v196 offset:25696
    ds_read_b64_tr_b16 v[126:127], v196 offset:26976
    v_mfma_f32_16x16x32_bf16 v[28:31], v[148:151], v[36:39], v[28:31]
    ds_read_b64_tr_b16 v[128:129], v196 offset:25728
    ds_read_b64_tr_b16 v[130:131], v196 offset:27008
    buffer_load_dwordx2 v[70:71], v193, s[16:19], s94 offen offset:1536 sc1
    s_waitcnt vmcnt(9)
    v_mfma_f32_16x16x32_bf16 v[12:15], v[152:155], v[40:43], v[12:15]
    ds_read_b64_tr_b16 v[132:133], v196 offset:32000
    ds_read_b64_tr_b16 v[134:135], v196 offset:33280
    v_mfma_f32_16x16x32_bf16 v[16:19], v[156:159], v[40:43], v[16:19]
    ds_read_b64_tr_b16 v[136:137], v196 offset:32032
    ds_read_b64_tr_b16 v[138:139], v196 offset:33312
    v_mfma_f32_16x16x32_bf16 v[20:23], v[160:163], v[40:43], v[20:23]
    ds_read_b64_tr_b16 v[140:141], v196 offset:32064
    ds_read_b64_tr_b16 v[142:143], v196 offset:33344
    v_mfma_f32_16x16x32_bf16 v[24:27], v[164:167], v[40:43], v[24:27]
    ds_read_b64_tr_b16 v[144:145], v196 offset:32096
    ds_read_b64_tr_b16 v[146:147], v196 offset:33376
    v_mfma_f32_16x16x32_bf16 v[28:31], v[168:171], v[40:43], v[28:31]
    ds_read_b64_tr_b16 v[148:149], v196 offset:32128
    ds_read_b64_tr_b16 v[150:151], v196 offset:33408
    buffer_load_dwordx4 v[72:75], v192, s[16:19], s92 offen offset:0 sc1
    s_waitcnt vmcnt(9)
    v_mfma_f32_16x16x32_bf16 v[12:15], v[172:175], v[44:47], v[12:15]
    ds_read_b64_tr_b16 v[152:153], v196 offset:38400
    ds_read_b64_tr_b16 v[154:155], v196 offset:39680
    v_mfma_f32_16x16x32_bf16 v[16:19], v[176:179], v[44:47], v[16:19]
    ds_read_b64_tr_b16 v[156:157], v196 offset:38432
    ds_read_b64_tr_b16 v[158:159], v196 offset:39712
    v_mfma_f32_16x16x32_bf16 v[20:23], v[180:183], v[44:47], v[20:23]
    ds_read_b64_tr_b16 v[160:161], v196 offset:38464
    ds_read_b64_tr_b16 v[162:163], v196 offset:39744
    v_mfma_f32_16x16x32_bf16 v[24:27], v[184:187], v[44:47], v[24:27]
    ds_read_b64_tr_b16 v[164:165], v196 offset:38496
    ds_read_b64_tr_b16 v[166:167], v196 offset:39776
    v_mfma_f32_16x16x32_bf16 v[28:31], v[188:191], v[44:47], v[28:31]
    ds_read_b64_tr_b16 v[168:169], v196 offset:38528
    ds_read_b64_tr_b16 v[170:171], v196 offset:39808
    buffer_load_dwordx4 v[76:79], v192, s[16:19], s92 offen offset:1024 sc1
    buffer_load_dwordx4 v[80:83], v192, s[16:19], s92 offen offset:2048 sc1
    s_waitcnt vmcnt(9)
    v_mfma_f32_16x16x32_bf16 v[12:15], v[204:207], v[48:51], v[12:15]
    ds_read_b64_tr_b16 v[172:173], v196 offset:44800
    ds_read_b64_tr_b16 v[174:175], v196 offset:46080
    v_mfma_f32_16x16x32_bf16 v[16:19], v[208:211], v[48:51], v[16:19]
    ds_read_b64_tr_b16 v[176:177], v196 offset:44832
    ds_read_b64_tr_b16 v[178:179], v196 offset:46112
    v_mfma_f32_16x16x32_bf16 v[20:23], v[212:215], v[48:51], v[20:23]
    ds_read_b64_tr_b16 v[180:181], v196 offset:44864
    ds_read_b64_tr_b16 v[182:183], v196 offset:46144
    v_mfma_f32_16x16x32_bf16 v[24:27], v[216:219], v[48:51], v[24:27]
    ds_read_b64_tr_b16 v[184:185], v196 offset:44896
    ds_read_b64_tr_b16 v[186:187], v196 offset:46176
    v_mfma_f32_16x16x32_bf16 v[28:31], v[220:223], v[48:51], v[28:31]
    ds_read_b64_tr_b16 v[188:189], v196 offset:44928
    ds_read_b64_tr_b16 v[190:191], v196 offset:46208
    buffer_load_dwordx4 v[84:87], v192, s[16:19], s92 offen offset:3072 sc1
    s_waitcnt vmcnt(9) lgkmcnt(15)
    v_mfma_f32_16x16x32_bf16 v[12:15], v[112:115], v[52:55], v[12:15]
    ds_read_b64_tr_b16 v[204:205], v197 offset:28160
    ds_read_b64_tr_b16 v[206:207], v197 offset:40960
    v_mfma_f32_16x16x32_bf16 v[16:19], v[116:119], v[52:55], v[16:19]
    ds_read_b64_tr_b16 v[208:209], v197 offset:28192
    ds_read_b64_tr_b16 v[210:211], v197 offset:40992
    v_mfma_f32_16x16x32_bf16 v[20:23], v[120:123], v[52:55], v[20:23]
    ds_read_b64_tr_b16 v[212:213], v197 offset:28224
    ds_read_b64_tr_b16 v[214:215], v197 offset:41024
    v_mfma_f32_16x16x32_bf16 v[24:27], v[124:127], v[52:55], v[24:27]
    ds_read_b64_tr_b16 v[216:217], v197 offset:28256
    ds_read_b64_tr_b16 v[218:219], v197 offset:41056
    v_mfma_f32_16x16x32_bf16 v[28:31], v[128:131], v[52:55], v[28:31]
    ds_read_b64_tr_b16 v[220:221], v197 offset:28288
    ds_read_b64_tr_b16 v[222:223], v197 offset:41088
    buffer_load_dwordx2 v[88:89], v193, s[16:19], s94 offen offset:2048 sc1
    s_waitcnt vmcnt(9) lgkmcnt(15)
    v_mfma_f32_16x16x32_bf16 v[12:15], v[132:135], v[56:59], v[12:15]
    ds_read_b64_tr_b16 v[112:113], v230 offset:0
    ds_read_b64_tr_b16 v[114:115], v230 offset:1280
    v_mfma_f32_16x16x32_bf16 v[16:19], v[136:139], v[56:59], v[16:19]
    ds_read_b64_tr_b16 v[116:117], v230 offset:32
    ds_read_b64_tr_b16 v[118:119], v230 offset:1312
    v_mfma_f32_16x16x32_bf16 v[20:23], v[140:143], v[56:59], v[20:23]
    ds_read_b64_tr_b16 v[120:121], v230 offset:64
    ds_read_b64_tr_b16 v[122:123], v230 offset:1344
    v_mfma_f32_16x16x32_bf16 v[24:27], v[144:147], v[56:59], v[24:27]
    ds_read_b64_tr_b16 v[124:125], v230 offset:96
    ds_read_b64_tr_b16 v[126:127], v230 offset:1376
    v_mfma_f32_16x16x32_bf16 v[28:31], v[148:151], v[56:59], v[28:31]
    ds_read_b64_tr_b16 v[128:129], v230 offset:128
    ds_read_b64_tr_b16 v[130:131], v230 offset:1408
    buffer_load_dwordx2 v[90:91], v193, s[16:19], s94 offen offset:2560 sc1
    s_waitcnt vmcnt(9) lgkmcnt(15)
    v_mfma_f32_16x16x32_bf16 v[12:15], v[152:155], v[60:63], v[12:15]
    ds_read_b64_tr_b16 v[132:133], v230 offset:6400
    ds_read_b64_tr_b16 v[134:135], v230 offset:7680
    v_mfma_f32_16x16x32_bf16 v[16:19], v[156:159], v[60:63], v[16:19]
    ds_read_b64_tr_b16 v[136:137], v230 offset:6432
    ds_read_b64_tr_b16 v[138:139], v230 offset:7712
    v_mfma_f32_16x16x32_bf16 v[20:23], v[160:163], v[60:63], v[20:23]
    ds_read_b64_tr_b16 v[140:141], v230 offset:6464
    ds_read_b64_tr_b16 v[142:143], v230 offset:7744
    v_mfma_f32_16x16x32_bf16 v[24:27], v[164:167], v[60:63], v[24:27]
    ds_read_b64_tr_b16 v[144:145], v230 offset:6496
    ds_read_b64_tr_b16 v[146:147], v230 offset:7776
    v_mfma_f32_16x16x32_bf16 v[28:31], v[168:171], v[60:63], v[28:31]
    ds_read_b64_tr_b16 v[148:149], v230 offset:6528
    ds_read_b64_tr_b16 v[150:151], v230 offset:7808
    buffer_load_dwordx4 v[92:95], v192, s[16:19], s93 offen offset:0 sc1
    s_waitcnt vmcnt(9) lgkmcnt(15)
    v_mfma_f32_16x16x32_bf16 v[12:15], v[172:175], v[64:67], v[12:15]
    ds_read_b64_tr_b16 v[152:153], v230 offset:12800
    ds_read_b64_tr_b16 v[154:155], v230 offset:14080
    v_mfma_f32_16x16x32_bf16 v[16:19], v[176:179], v[64:67], v[16:19]
    ds_read_b64_tr_b16 v[156:157], v230 offset:12832
    ds_read_b64_tr_b16 v[158:159], v230 offset:14112
    v_mfma_f32_16x16x32_bf16 v[20:23], v[180:183], v[64:67], v[20:23]
    ds_read_b64_tr_b16 v[160:161], v230 offset:12864
    ds_read_b64_tr_b16 v[162:163], v230 offset:14144
    v_mfma_f32_16x16x32_bf16 v[24:27], v[184:187], v[64:67], v[24:27]
    ds_read_b64_tr_b16 v[164:165], v230 offset:12896
    ds_read_b64_tr_b16 v[166:167], v230 offset:14176
    v_mfma_f32_16x16x32_bf16 v[28:31], v[188:191], v[64:67], v[28:31]
    ds_read_b64_tr_b16 v[168:169], v230 offset:12928
    ds_read_b64_tr_b16 v[170:171], v230 offset:14208
    buffer_load_dwordx4 v[96:99], v192, s[16:19], s93 offen offset:1024 sc1
    buffer_load_dwordx4 v[100:103], v192, s[16:19], s93 offen offset:2048 sc1
    s_waitcnt vmcnt(9) lgkmcnt(15)
    v_mfma_f32_16x16x32_bf16 v[12:15], v[204:207], v[68:71], v[12:15]
    ds_read_b64_tr_b16 v[172:173], v230 offset:19200
    ds_read_b64_tr_b16 v[174:175], v230 offset:20480
    v_mfma_f32_16x16x32_bf16 v[16:19], v[208:211], v[68:71], v[16:19]
    ds_read_b64_tr_b16 v[176:177], v230 offset:19232
    ds_read_b64_tr_b16 v[178:179], v230 offset:20512
    v_mfma_f32_16x16x32_bf16 v[20:23], v[212:215], v[68:71], v[20:23]
    ds_read_b64_tr_b16 v[180:181], v230 offset:19264
    ds_read_b64_tr_b16 v[182:183], v230 offset:20544
    v_mfma_f32_16x16x32_bf16 v[24:27], v[216:219], v[68:71], v[24:27]
    ds_read_b64_tr_b16 v[184:185], v230 offset:19296
    ds_read_b64_tr_b16 v[186:187], v230 offset:20576
    v_mfma_f32_16x16x32_bf16 v[28:31], v[220:223], v[68:71], v[28:31]
    ds_read_b64_tr_b16 v[188:189], v230 offset:19328
    ds_read_b64_tr_b16 v[190:191], v230 offset:20608
    buffer_load_dwordx4 v[104:107], v192, s[16:19], s93 offen offset:3072 sc1
    s_waitcnt vmcnt(9) lgkmcnt(15)
    v_mfma_f32_16x16x32_bf16 v[12:15], v[112:115], v[72:75], v[12:15]
    ds_read_b64_tr_b16 v[204:205], v231 offset:2560
    ds_read_b64_tr_b16 v[206:207], v231 offset:15360
    v_mfma_f32_16x16x32_bf16 v[16:19], v[116:119], v[72:75], v[16:19]
    ds_read_b64_tr_b16 v[208:209], v231 offset:2592
    ds_read_b64_tr_b16 v[210:211], v231 offset:15392
    v_mfma_f32_16x16x32_bf16 v[20:23], v[120:123], v[72:75], v[20:23]
    ds_read_b64_tr_b16 v[212:213], v231 offset:2624
    ds_read_b64_tr_b16 v[214:215], v231 offset:15424
    v_mfma_f32_16x16x32_bf16 v[24:27], v[124:127], v[72:75], v[24:27]
    ds_read_b64_tr_b16 v[216:217], v231 offset:2656
    ds_read_b64_tr_b16 v[218:219], v231 offset:15456
    v_mfma_f32_16x16x32_bf16 v[28:31], v[128:131], v[72:75], v[28:31]
    ds_read_b64_tr_b16 v[220:221], v231 offset:2688
    ds_read_b64_tr_b16 v[222:223], v231 offset:15488
    buffer_load_dwordx2 v[108:109], v193, s[16:19], s94 offen offset:3072 sc1
    s_waitcnt vmcnt(9) lgkmcnt(15)
    v_mfma_f32_16x16x32_bf16 v[12:15], v[132:135], v[76:79], v[12:15]
    ds_read_b64_tr_b16 v[112:113], v230 offset:25600
    ds_read_b64_tr_b16 v[114:115], v230 offset:26880
    v_mfma_f32_16x16x32_bf16 v[16:19], v[136:139], v[76:79], v[16:19]
    ds_read_b64_tr_b16 v[116:117], v230 offset:25632
    ds_read_b64_tr_b16 v[118:119], v230 offset:26912
    v_mfma_f32_16x16x32_bf16 v[20:23], v[140:143], v[76:79], v[20:23]
    ds_read_b64_tr_b16 v[120:121], v230 offset:25664
    ds_read_b64_tr_b16 v[122:123], v230 offset:26944
    v_mfma_f32_16x16x32_bf16 v[24:27], v[144:147], v[76:79], v[24:27]
    ds_read_b64_tr_b16 v[124:125], v230 offset:25696
    ds_read_b64_tr_b16 v[126:127], v230 offset:26976
    v_mfma_f32_16x16x32_bf16 v[28:31], v[148:151], v[76:79], v[28:31]
    ds_read_b64_tr_b16 v[128:129], v230 offset:25728
    ds_read_b64_tr_b16 v[130:131], v230 offset:27008
    buffer_load_dwordx2 v[110:111], v193, s[16:19], s94 offen offset:3584 sc1
    s_waitcnt vmcnt(9) lgkmcnt(15)
    v_mfma_f32_16x16x32_bf16 v[12:15], v[152:155], v[80:83], v[12:15]
    ds_read_b64_tr_b16 v[132:133], v230 offset:32000
    ds_read_b64_tr_b16 v[134:135], v230 offset:33280
    v_mfma_f32_16x16x32_bf16 v[16:19], v[156:159], v[80:83], v[16:19]
    ds_read_b64_tr_b16 v[136:137], v230 offset:32032
    ds_read_b64_tr_b16 v[138:139], v230 offset:33312
    v_mfma_f32_16x16x32_bf16 v[20:23], v[160:163], v[80:83], v[20:23]
    ds_read_b64_tr_b16 v[140:141], v230 offset:32064
    ds_read_b64_tr_b16 v[142:143], v230 offset:33344
    v_mfma_f32_16x16x32_bf16 v[24:27], v[164:167], v[80:83], v[24:27]
    ds_read_b64_tr_b16 v[144:145], v230 offset:32096
    ds_read_b64_tr_b16 v[146:147], v230 offset:33376
    v_mfma_f32_16x16x32_bf16 v[28:31], v[168:171], v[80:83], v[28:31]
    ds_read_b64_tr_b16 v[148:149], v230 offset:32128
    ds_read_b64_tr_b16 v[150:151], v230 offset:33408
    s_waitcnt vmcnt(8) lgkmcnt(15)
    v_mfma_f32_16x16x32_bf16 v[12:15], v[172:175], v[84:87], v[12:15]
    ds_read_b64_tr_b16 v[152:153], v230 offset:38400
    ds_read_b64_tr_b16 v[154:155], v230 offset:39680
    v_mfma_f32_16x16x32_bf16 v[16:19], v[176:179], v[84:87], v[16:19]
    ds_read_b64_tr_b16 v[156:157], v230 offset:38432
    ds_read_b64_tr_b16 v[158:159], v230 offset:39712
    v_mfma_f32_16x16x32_bf16 v[20:23], v[180:183], v[84:87], v[20:23]
    ds_read_b64_tr_b16 v[160:161], v230 offset:38464
    ds_read_b64_tr_b16 v[162:163], v230 offset:39744
    v_mfma_f32_16x16x32_bf16 v[24:27], v[184:187], v[84:87], v[24:27]
    ds_read_b64_tr_b16 v[164:165], v230 offset:38496
    ds_read_b64_tr_b16 v[166:167], v230 offset:39776
    v_mfma_f32_16x16x32_bf16 v[28:31], v[188:191], v[84:87], v[28:31]
    ds_read_b64_tr_b16 v[168:169], v230 offset:38528
    ds_read_b64_tr_b16 v[170:171], v230 offset:39808
    s_waitcnt vmcnt(6) lgkmcnt(15)
    v_mfma_f32_16x16x32_bf16 v[12:15], v[204:207], v[88:91], v[12:15]
    ds_read_b64_tr_b16 v[172:173], v230 offset:44800
    ds_read_b64_tr_b16 v[174:175], v230 offset:46080
    v_mfma_f32_16x16x32_bf16 v[16:19], v[208:211], v[88:91], v[16:19]
    ds_read_b64_tr_b16 v[176:177], v230 offset:44832
    ds_read_b64_tr_b16 v[178:179], v230 offset:46112
    v_mfma_f32_16x16x32_bf16 v[20:23], v[212:215], v[88:91], v[20:23]
    ds_read_b64_tr_b16 v[180:181], v230 offset:44864
    ds_read_b64_tr_b16 v[182:183], v230 offset:46144
    v_mfma_f32_16x16x32_bf16 v[24:27], v[216:219], v[88:91], v[24:27]
    ds_read_b64_tr_b16 v[184:185], v230 offset:44896
    ds_read_b64_tr_b16 v[186:187], v230 offset:46176
    v_mfma_f32_16x16x32_bf16 v[28:31], v[220:223], v[88:91], v[28:31]
    ds_read_b64_tr_b16 v[188:189], v230 offset:44928
    ds_read_b64_tr_b16 v[190:191], v230 offset:46208
    s_waitcnt vmcnt(5) lgkmcnt(15)
    v_mfma_f32_16x16x32_bf16 v[12:15], v[112:115], v[92:95], v[12:15]
    ds_read_b64_tr_b16 v[204:205], v231 offset:28160
    ds_read_b64_tr_b16 v[206:207], v231 offset:40960
    v_mfma_f32_16x16x32_bf16 v[16:19], v[116:119], v[92:95], v[16:19]
    ds_read_b64_tr_b16 v[208:209], v231 offset:28192
    ds_read_b64_tr_b16 v[210:211], v231 offset:40992
    v_mfma_f32_16x16x32_bf16 v[20:23], v[120:123], v[92:95], v[20:23]
    ds_read_b64_tr_b16 v[212:213], v231 offset:28224
    ds_read_b64_tr_b16 v[214:215], v231 offset:41024
    v_mfma_f32_16x16x32_bf16 v[24:27], v[124:127], v[92:95], v[24:27]
    ds_read_b64_tr_b16 v[216:217], v231 offset:28256
    ds_read_b64_tr_b16 v[218:219], v231 offset:41056
    v_mfma_f32_16x16x32_bf16 v[28:31], v[128:131], v[92:95], v[28:31]
    ds_read_b64_tr_b16 v[220:221], v231 offset:28288
    ds_read_b64_tr_b16 v[222:223], v231 offset:41088
    s_waitcnt vmcnt(4) lgkmcnt(15)
    v_mfma_f32_16x16x32_bf16 v[12:15], v[132:135], v[96:99], v[12:15]
    v_mfma_f32_16x16x32_bf16 v[16:19], v[136:139], v[96:99], v[16:19]
    v_mfma_f32_16x16x32_bf16 v[20:23], v[140:143], v[96:99], v[20:23]
    v_mfma_f32_16x16x32_bf16 v[24:27], v[144:147], v[96:99], v[24:27]
    v_mfma_f32_16x16x32_bf16 v[28:31], v[148:151], v[96:99], v[28:31]
    s_waitcnt vmcnt(3) lgkmcnt(15)
    v_mfma_f32_16x16x32_bf16 v[12:15], v[152:155], v[100:103], v[12:15]
    v_mfma_f32_16x16x32_bf16 v[16:19], v[156:159], v[100:103], v[16:19]
    v_mfma_f32_16x16x32_bf16 v[20:23], v[160:163], v[100:103], v[20:23]
    v_mfma_f32_16x16x32_bf16 v[24:27], v[164:167], v[100:103], v[24:27]
    v_mfma_f32_16x16x32_bf16 v[28:31], v[168:171], v[100:103], v[28:31]
    s_waitcnt vmcnt(2) lgkmcnt(10)
    v_mfma_f32_16x16x32_bf16 v[12:15], v[172:175], v[104:107], v[12:15]
    v_mfma_f32_16x16x32_bf16 v[16:19], v[176:179], v[104:107], v[16:19]
    v_mfma_f32_16x16x32_bf16 v[20:23], v[180:183], v[104:107], v[20:23]
    v_mfma_f32_16x16x32_bf16 v[24:27], v[184:187], v[104:107], v[24:27]
    v_mfma_f32_16x16x32_bf16 v[28:31], v[188:191], v[104:107], v[28:31]
    s_waitcnt vmcnt(0) lgkmcnt(0)
    v_mfma_f32_16x16x32_bf16 v[12:15], v[204:207], v[108:111], v[12:15]
    v_mfma_f32_16x16x32_bf16 v[16:19], v[208:211], v[108:111], v[16:19]
    v_mfma_f32_16x16x32_bf16 v[20:23], v[212:215], v[108:111], v[20:23]
    v_mfma_f32_16x16x32_bf16 v[24:27], v[216:219], v[108:111], v[24:27]
    v_mfma_f32_16x16x32_bf16 v[28:31], v[220:223], v[108:111], v[28:31]
L_f_out:
    s_nop 6
    v_cvt_pk_bf16_f32 v32, v12, v13
    v_cvt_pk_bf16_f32 v33, v14, v15
    ds_write_b64 v198, v[32:33] offset:0
    v_cvt_pk_bf16_f32 v34, v16, v17
    v_cvt_pk_bf16_f32 v35, v18, v19
    ds_write_b64 v198, v[34:35] offset:32
    v_cvt_pk_bf16_f32 v36, v20, v21
    v_cvt_pk_bf16_f32 v37, v22, v23
    ds_write_b64 v198, v[36:37] offset:64
    v_cvt_pk_bf16_f32 v38, v24, v25
    v_cvt_pk_bf16_f32 v39, v26, v27
    ds_write_b64 v198, v[38:39] offset:96
    v_cvt_pk_bf16_f32 v40, v28, v29
    v_cvt_pk_bf16_f32 v41, v30, v31
    ds_write_b64 v198, v[40:41] offset:128
    ds_read_b128 v[64:67], v224
    ds_read_b128 v[68:71], v225
    ds_read_b128 v[72:75], v226
    s_waitcnt lgkmcnt(2)
    buffer_store_dwordx4 v[64:67], v227, s[12:15], s53 offen
    s_waitcnt lgkmcnt(1)
    buffer_store_dwordx4 v[68:71], v228, s[12:15], s53 offen
    s_waitcnt lgkmcnt(0)
    s_mov_b32 exec_hi, 0
    buffer_store_dwordx4 v[72:75], v229, s[12:15], s53 offen
    s_branch L_fin
L_spare:
    v_mov_b32 v244, 0
    v_lshlrev_b32 v240, 2, v250
    v_min_u32 v240, 124, v240
    v_add_u32 v240, 163712, v240
    v_lshrrev_b32 v238, 3, v250
    v_mul_u32_u24 v238, 1280, v238
    v_and_b32 v239, 7, v250
    v_lshl_add_u32 v238, v239, 4, v238
    v_bfe_u32 v239, v250, 2, 2
    v_lshlrev_b32 v239, 7, v239
    v_lshrrev_b32 v201, 4, v250
    v_lshl_add_u32 v239, v201, 5, v239
    v_and_b32 v201, 3, v250
    v_lshl_add_u32 v239, v201, 3, v239
    s_mul_i32 s94, s32, 3072
    s_add_u32 s94, s94, 86784
    v_add_u32 v239, s94, v239
    v_lshlrev_b32 v201, 4, v250
    s_mul_i32 s95, s2, 10240
    s_sub_u32 s90, s32, 4
    s_mov_b32 s91, s32
    s_add_u32 s92, s32, 4
    s_min_u32 s92, s92, 9
    s_waitcnt lgkmcnt(0)
    ds_write_b32 v240, v244
    s_mov_b32 s16, s88
    s_and_b32 s17, s89, 0xffff
    s_mov_b32 s18, 33554432
    s_mov_b32 s19, 0x00020000
    s_mov_b32 s20, s64
    s_and_b32 s21, s65, 0xffff
    s_mov_b32 s22, 2621440
    s_mov_b32 s23, 0x00020000
    s_cmp_lt_u32 s32, 4
    s_cbranch_scc1 L_sp_d
    s_add_u32 m0, s94, 0
    s_lshl_b32 s30, s90, 7
    s_add_u32 s30, s30, s95
    buffer_load_dwordx4 v238, s[20:23], s30 offen lds
    s_add_u32 m0, s94, 1024
    s_lshl_b32 s30, s91, 7
    s_add_u32 s30, s30, s95
    buffer_load_dwordx4 v238, s[20:23], s30 offen lds
    s_add_u32 m0, s94, 2048
    s_lshl_b32 s30, s92, 7
    s_add_u32 s30, s30, s95
    buffer_load_dwordx4 v238, s[20:23], s30 offen lds
    s_waitcnt vmcnt(0)
    ds_read_b64_tr_b16 v[176:177], v239 offset:0
    ds_read_b64_tr_b16 v[178:179], v239 offset:512
    ds_read_b64_tr_b16 v[180:181], v239 offset:1024
    ds_read_b64_tr_b16 v[182:183], v239 offset:1536
    ds_read_b64_tr_b16 v[184:185], v239 offset:2048
    ds_read_b64_tr_b16 v[186:187], v239 offset:2560
    s_waitcnt lgkmcnt(0)
    s_lshl_b32 s30, s90, 10
    s_add_u32 s30, s30, s95
    s_add_u32 s30, s30, 10747904
    buffer_store_dwordx4 v[176:179], v201, s[16:19], s30 offen sc1
    s_lshl_b32 s30, s91, 10
    s_add_u32 s30, s30, s95
    s_add_u32 s30, s30, 10747904
    buffer_store_dwordx4 v[180:183], v201, s[16:19], s30 offen sc1
    s_lshl_b32 s30, s92, 10
    s_add_u32 s30, s30, s95
    s_add_u32 s30, s30, 10747904
    buffer_store_dwordx4 v[184:187], v201, s[16:19], s30 offen sc1
L_sp_d:
    s_mov_b32 s44, 1000000
L_ng_23:
    global_load_dwordx2 v[246:247], v244, s[86:87] sc1
L_ng_23_w:
    s_waitcnt vmcnt(0)
    v_readfirstlane_b32 s42, v246
    v_readfirstlane_b32 s43, v247
    s_cmp_lg_u32 s43, 0
    s_cbranch_scc1 L_nd_24
    s_sleep 2
    s_sub_u32 s44, s44, 1
    s_cmp_lg_u32 s44, 0
    s_cbranch_scc1 L_ng_23
L_nd_24:
    s_waitcnt lgkmcnt(0)
    s_barrier
    s_mov_b32 s61, 0
    s_cmp_lg_u32 s32, 0
    s_cbranch_scc1 L_sp_e
    s_lshl_b32 s53, s2, 3
    s_add_u32 s53, s53, 4096
    s_lshr_b32 s31, s53, 5
    s_mul_i32 s31, s31, 4352
    s_and_b32 s53, s53, 31
    s_add_u32 s53, s53, s31
    s_add_u32 s53, s53, 16777216
    v_mov_b32 v240, s42
    v_mov_b32 v241, s43
    v_lshlrev_b32 v242, 3, v250
    s_mov_b64 exec, 0x1
    buffer_store_dwordx2 v[240:241], v242, s[16:19], s53 offen sc1
    s_mov_b64 exec, -1
    s_mov_b32 s61, 1
L_sp_e:
    s_cmp_lt_u32 s32, 4
    s_cbranch_scc1 L_att
    s_and_b32 s41, s32, 3
    v_lshlrev_b32 v192, 4, v250
    s_mul_i32 s52, s39, 163840
    s_add_u32 s52, s52, 2621440
    s_mul_i32 s54, s39, 20
    v_bfe_u32 v240, v250, 4, 1
    v_mul_u32_u24 v240, 19, v240
    v_add_u32 v240, s54, v240
    v_and_b32 v240, 0xff80, v240
    v_lshrrev_b32 v241, 5, v250
    v_mul_u32_u24 v241, 640, v241
    v_and_b32 v242, 15, v250
    v_lshl_add_u32 v241, v242, 3, v241
    v_add_u32 v241, v241, v240
    v_add_u32 v194, 640, v241
    v_lshrrev_b32 v241, 5, v194
    v_mul_u32_u24 v241, 4352, v241
    v_and_b32 v194, 31, v194
    v_add_u32 v194, v194, v241
    v_add_u32 v194, 16777216, v194
    v_and_b32 v195, 3, v250
    v_lshlrev_b32 v195, 2, v195
    v_add_u32 v195, 163776, v195
    s_lshr_b32 s49, s38, 2
    s_mul_i32 s54, s49, 160
    v_add_u32 v243, 0, v250
    v_mul_u32_u24 v241, 52429, v243
    v_lshrrev_b32 v241, 19, v241
    v_mul_u32_u24 v242, 1120, v241
    v_lshl_add_u32 v242, v250, 4, v242
    v_add_u32 v202, s54, v242
    v_add_u32 v243, 64, v250
    v_mul_u32_u24 v241, 52429, v243
    v_lshrrev_b32 v241, 19, v241
    v_mul_u32_u24 v242, 1120, v241
    v_lshl_add_u32 v242, v250, 4, v242
    v_add_u32 v203, s54, v242
    v_add_u32 v243, 128, v250
    v_mul_u32_u24 v241, 52429, v243
    v_lshrrev_b32 v241, 19, v241
    v_mul_u32_u24 v242, 1120, v241
    v_lshl_add_u32 v242, v250, 4, v242
    v_add_u32 v251, s54, v242
    v_add_u32 v243, 192, v250
    v_mul_u32_u24 v241, 52429, v243
    v_lshrrev_b32 v241, 19, v241
    v_mul_u32_u24 v242, 1120, v241
    v_lshl_add_u32 v242, v250, 4, v242
    v_add_u32 v252, s54, v242
    v_add_u32 v243, 256, v250
    v_mul_u32_u24 v241, 52429, v243
    v_lshrrev_b32 v241, 19, v241
    v_mul_u32_u24 v242, 1120, v241
    v_lshl_add_u32 v242, v250, 4, v242
    v_add_u32 v242, 4096, v242
    v_add_u32 v253, s54, v242
    v_bfe_u32 v241, v250, 2, 2
    v_and_b32 v242, 3, v250
    v_lshrrev_b32 v243, 5, v250
    v_mul_u32_u24 v196, 20, v243
    v_bfe_u32 v243, v250, 4, 1
    v_lshl_add_u32 v196, v243, 2, v196
    v_add_u32 v196, v196, v241
    v_mul_u32_u24 v196, 160, v196
    v_lshl_add_u32 v196, v242, 3, v196
    v_lshrrev_b32 v243, 4, v250
    v_mul_u32_u24 v197, 20, v243
    v_add_u32 v197, v197, v241
    v_mul_u32_u24 v197, 160, v197
    v_lshl_add_u32 v197, v242, 3, v197
    v_add_u32 v196, 20480, v196
    v_add_u32 v197, 20480, v197
    v_add_u32 v230, 51200, v196
    v_add_u32 v208, 51200, v197
    s_lshl_b32 s58, s39, 2
    s_add_u32 s58, s58, s41
    v_lshlrev_b32 v193, 3, v250
    v_and_b32 v199, 31, v250
    v_lshlrev_b32 v199, 3, v199
    s_lshl_b32 s54, s37, 8
    s_add_u32 s54, s54, 12288
    v_add_u32 v199, s54, v199
    v_lshrrev_b32 v241, 5, v199
    v_mul_u32_u24 v241, 4352, v241
    v_and_b32 v199, 31, v199
    v_add_u32 v199, v199, v241
    v_add_u32 v199, 16777216, v199
    v_and_b32 v241, 15, v250
    v_mul_u32_u24 v241, 176, v241
    v_lshrrev_b32 v242, 4, v250
    v_lshl_add_u32 v241, v242, 3, v241
    s_mul_i32 s55, s41, 2816
    s_add_u32 s55, s55, 143360
    v_add_u32 v198, s55, v241
    v_add_u32 v242, 0, v250
    v_mul_u32_u24 v243, 52429, v242
    v_lshrrev_b32 v243, 19, v243
    v_mul_u32_u24 v224, 10, v243
    v_sub_u32 v242, v242, v224
    v_lshlrev_b32 v242, 4, v242
    v_mul_u32_u24 v224, 176, v243
    v_add3_u32 v224, v224, v242, s55
    v_mul_u32_u24 v227, 2560, v243
    v_add_u32 v227, v227, v242
    v_add_u32 v242, 64, v250
    v_mul_u32_u24 v243, 52429, v242
    v_lshrrev_b32 v243, 19, v243
    v_mul_u32_u24 v225, 10, v243
    v_sub_u32 v242, v242, v225
    v_lshlrev_b32 v242, 4, v242
    v_mul_u32_u24 v225, 176, v243
    v_add3_u32 v225, v225, v242, s55
    v_mul_u32_u24 v228, 2560, v243
    v_add_u32 v228, v228, v242
    v_add_u32 v242, 128, v250
    v_mul_u32_u24 v243, 52429, v242
    v_lshrrev_b32 v243, 19, v243
    v_mul_u32_u24 v226, 10, v243
    v_sub_u32 v242, v242, v226
    v_lshlrev_b32 v242, 4, v242
    v_mul_u32_u24 v226, 176, v243
    v_add3_u32 v226, v226, v242, s55
    v_mul_u32_u24 v229, 2560, v243
    v_add_u32 v229, v229, v242
    s_mul_i32 s53, s49, 160
    s_mul_i32 s54, s58, 40960
    s_add_u32 s53, s53, s54
    s_add_u32 s53, s53, 1280
    v_mov_b32 v200, 163824
    s_branch L_side
L_compute:
    s_and_b32 s41, s32, 3
    v_lshrrev_b32 v240, 4, v250
    v_and_b32 v243, 1, v240
    v_lshlrev_b32 v243, 2, v243
    v_and_b32 v241, 7, v250
    v_xor_b32 v243, v243, v241
    v_lshlrev_b32 v243, 4, v243
    v_lshrrev_b32 v241, 3, v250
    v_mul_u32_u24 v241, 1280, v241
    v_add_u32 v243, v243, v241
    s_mul_i32 s30, s41, 10240
    s_mul_i32 s31, s33, 163840
    s_add_u32 s30, s30, s31
    v_add_u32 v220, s30, v243
    v_add_u32 v221, 40960, v220
    v_add_u32 v222, 81920, v220
    v_add_u32 v223, 122880, v220
    v_lshlrev_b32 v241, 2, v240
    v_and_b32 v242, 15, v250
    v_xor_b32 v241, v241, v242
    v_lshlrev_b32 v241, 4, v241
    v_mul_u32_u24 v240, 3840, v240
    v_add_u32 v240, v240, v241
    s_mul_i32 s30, s41, 15360
    s_lshl_b32 s31, s34, 8
    s_add_u32 s30, s30, s31
    v_add_u32 v234, s30, v240
    v_add_u32 v235, 61440, v234
    v_add_u32 v236, 122880, v234
    v_add_u32 v237, 184320, v234
    s_lshr_b32 s30, s38, 2
    s_add_u32 s30, s30, s38
    s_and_b32 s30, s30, 3
    s_lshl_b32 s30, s30, 2
    s_lshr_b32 s0, 0x8530, s30
    s_and_b32 s0, s0, 15
    s_lshl_b32 s46, s0, 7
    s_mul_i32 s47, s0, 245760
    s_mul_i32 s3, s41, 1040
    s_lshl_b32 s1, s41, 4
    s_sub_u32 s1, 16640, s1
    s_waitcnt lgkmcnt(0)
    s_mov_b32 s8, s78
    s_and_b32 s9, s79, 0xffff
    s_mov_b32 s10, 2621440
    s_mov_b32 s11, 0x00020000
    s_mov_b32 s12, s80
    s_and_b32 s13, s81, 0xffff
    s_mov_b32 s14, 2457600
    s_mov_b32 s15, 0x00020000
    s_mov_b32 m0, s3
    s_nop 0
    buffer_load_dwordx4 v220, s[8:11], s46 offen lds
    s_add_u32 m0, s3, 4160
    s_nop 0
    buffer_load_dwordx4 v221, s[8:11], s46 offen lds
    s_add_u32 m0, s3, 8320
    s_nop 0
    buffer_load_dwordx4 v222, s[8:11], s46 offen lds
    s_add_u32 m0, s3, 12480
    s_nop 0
    buffer_load_dwordx4 v223, s[8:11], s46 offen lds
    s_add_u32 m0, s3, s1
    s_nop 0
    buffer_load_dwordx4 v234, s[12:15], s47 offen lds
    s_add_u32 m0, m0, 4096
    s_nop 0
    buffer_load_dwordx4 v235, s[12:15], s47 offen lds
    s_add_u32 m0, m0, 4096
    s_nop 0
    buffer_load_dwordx4 v236, s[12:15], s47 offen lds
    s_add_u32 m0, m0, 4096
    s_nop 0
    buffer_load_dwordx4 v237, s[12:15], s47 offen lds
    s_add_u32 s46, s46, 128
    s_add_u32 s47, s47, 245760
    s_cmp_eq_u32 s46, 1280
    s_cselect_b32 s46, 0, s46
    s_cselect_b32 s47, 0, s47
    s_add_u32 s3, s3, 33024
    s_sub_u32 s30, s3, 99072
    s_cmp_ge_u32 s3, 99072
    s_cselect_b32 s3, s30, s3
    s_barrier
    s_and_b32 s35, s32, 1
    s_lshr_b32 s36, s32, 1
    v_mov_b32 v245, 0
    v_bfe_u32 v240, v250, 3, 2
    v_mul_u32_u24 v240, 1040, v240
    v_and_b32 v241, 7, v250
    v_lshl_add_u32 v240, v241, 7, v240
    v_lshrrev_b32 v242, 5, v250
    v_lshl_add_u32 v240, v242, 4, v240
    s_mul_i32 s30, s35, 8320
    v_add_u32 v240, s30, v240
    v_bfe_u32 v241, v250, 1, 1
    v_lshl_add_u32 v200, v241, 6, v240
    v_xor_b32 v241, 1, v241
    v_lshl_add_u32 v201, v241, 6, v240
    v_bfe_u32 v240, v250, 2, 2
    v_bfe_u32 v241, v250, 4, 1
    v_lshlrev_b32 v241, 1, v241
    v_bfe_u32 v242, v250, 1, 1
    v_add_u32 v241, v241, v242
    s_lshl_b32 s30, s36, 3
    s_add_u32 s30, s30, 0
    v_add_u32 v241, s30, v241
    v_lshlrev_b32 v242, 2, v240
    v_xor_b32 v241, v241, v242
    v_lshlrev_b32 v241, 4, v241
    v_and_b32 v242, 1, v250
    v_lshl_add_u32 v241, v242, 3, v241
    v_lshrrev_b32 v242, 5, v250
    v_lshl_add_u32 v242, v242, 3, v240
    v_lshl_add_u32 v241, v242, 8, v241
    v_add_u32 v204, 16640, v241
    v_bfe_u32 v240, v250, 2, 2
    v_bfe_u32 v241, v250, 4, 1
    v_lshlrev_b32 v241, 1, v241
    v_bfe_u32 v242, v250, 1, 1
    v_add_u32 v241, v241, v242
    s_lshl_b32 s30, s36, 3
    s_add_u32 s30, s30, 4
    v_add_u32 v241, s30, v241
    v_lshlrev_b32 v242, 2, v240
    v_xor_b32 v241, v241, v242
    v_lshlrev_b32 v241, 4, v241
    v_and_b32 v242, 1, v250
    v_lshl_add_u32 v241, v242, 3, v241
    v_lshrrev_b32 v242, 5, v250
    v_lshl_add_u32 v242, v242, 3, v240
    v_lshl_add_u32 v241, v242, 8, v241
    v_add_u32 v205, 16640, v241
    v_mov_b32 v206, v200
    v_mov_b32 v207, v201
    v_mov_b32 v210, v204
    v_mov_b32 v211, v205
    s_lshl_b32 s56, s33, 1
    s_add_u32 s56, s56, s35
    s_lshl_b32 s57, s34, 7
    s_lshl_b32 s58, s33, 3
    s_add_u32 s57, s57, s58
    s_add_u32 s57, s57, 0
    s_cmp_ge_u32 s34, 10
    s_cbranch_scc1 L_c_vaddr
    s_cmp_ge_u32 s34, 5
    s_cselect_b32 s58, 163840, 0
    s_cselect_b32 s59, 5120, 0
    s_cselect_b32 s60, 2621440, 0
    s_cselect_b32 s61, 5, 0
    s_cselect_b32 s62, 1.0, 0x3ea52b5c
    s_cselect_b64 vcc, -1, 0
    s_cselect_b32 s30, 0, 81920
    s_cselect_b32 s31, 0, 2560
    s_add_u32 s58, s58, s30
    s_add_u32 s59, s59, s31
    s_sub_u32 s61, s34, s61
    s_lshl_b32 s61, s61, 4
    s_lshl_b32 s30, s36, 3
    s_add_u32 s61, s61, s30
    s_mul_i32 s30, s56, s59
    s_add_u32 s60, s60, s30
    v_and_b32 v240, 31, v250
    v_and_b32 v241, 19, v240
    v_bfe_u32 v242, v240, 2, 1
    v_lshl_add_u32 v241, v242, 3, v241
    v_bfe_u32 v242, v240, 3, 1
    v_lshl_add_u32 v241, v242, 2, v241
    v_cndmask_b32 v240, v240, v241, vcc
    v_lshlrev_b32 v240, 4, v240
    v_add_u32 v240, s60, v240
    v_lshrrev_b32 v241, 5, v250
    v_add_u32 v241, s61, v241
    s_lshl_b32 s63, s58, 1
    v_mov_b32 v247, s58
    v_add_u32 v242, 0, v241
    v_mul_u32_u24 v243, 52429, v242
    v_lshrrev_b32 v243, 18, v243
    v_mul_u32_u24 v244, 5, v243
    v_sub_u32 v242, v242, v244
    v_mul_u32_u24 v243, s63, v243
    v_add_u32 v243, v243, v240
    v_cmp_lt_u32 vcc, 2, v242
    v_cmp_eq_u32 s[90:91], 2, v242
    v_lshlrev_b32 v244, 9, v242
    v_add_u32 v243, v243, v244
    v_subrev_u32 v244, 1536, v247
    v_cndmask_b32 v244, 0, v244, vcc
    v_add_u32 v243, v243, v244
    v_mov_b32 v244, 1024
    v_cndmask_b32 v242, 0, v244, s[90:91]
    v_add_u32 v212, v243, v242
    v_cndmask_b32 v244, v244, v247, s[90:91]
    v_add_u32 v213, v212, v244
    v_add_u32 v242, 2, v241
    v_mul_u32_u24 v243, 52429, v242
    v_lshrrev_b32 v243, 18, v243
    v_mul_u32_u24 v244, 5, v243
    v_sub_u32 v242, v242, v244
    v_mul_u32_u24 v243, s63, v243
    v_add_u32 v243, v243, v240
    v_cmp_lt_u32 vcc, 2, v242
    v_cmp_eq_u32 s[92:93], 2, v242
    v_lshlrev_b32 v244, 9, v242
    v_add_u32 v243, v243, v244
    v_subrev_u32 v244, 1536, v247
    v_cndmask_b32 v244, 0, v244, vcc
    v_add_u32 v243, v243, v244
    v_mov_b32 v244, 1024
    v_cndmask_b32 v242, 0, v244, s[92:93]
    v_add_u32 v214, v243, v242
    v_cndmask_b32 v244, v244, v247, s[92:93]
    v_add_u32 v215, v214, v244
    v_add_u32 v242, 4, v241
    v_mul_u32_u24 v243, 52429, v242
    v_lshrrev_b32 v243, 18, v243
    v_mul_u32_u24 v244, 5, v243
    v_sub_u32 v242, v242, v244
    v_mul_u32_u24 v243, s63, v243
    v_add_u32 v243, v243, v240
    v_cmp_lt_u32 vcc, 2, v242
    v_cmp_eq_u32 s[94:95], 2, v242
    v_lshlrev_b32 v244, 9, v242
    v_add_u32 v243, v243, v244
    v_subrev_u32 v244, 1536, v247
    v_cndmask_b32 v244, 0, v244, vcc
    v_add_u32 v243, v243, v244
    v_mov_b32 v244, 1024
    v_cndmask_b32 v242, 0, v244, s[94:95]
    v_add_u32 v216, v243, v242
    v_cndmask_b32 v244, v244, v247, s[94:95]
    v_add_u32 v217, v216, v244
    v_add_u32 v242, 6, v241
    v_mul_u32_u24 v243, 52429, v242
    v_lshrrev_b32 v243, 18, v243
    v_mul_u32_u24 v244, 5, v243
    v_sub_u32 v242, v242, v244
    v_mul_u32_u24 v243, s63, v243
    v_add_u32 v243, v243, v240
    v_cmp_lt_u32 vcc, 2, v242
    v_cmp_eq_u32 s[28:29], 2, v242
    v_lshlrev_b32 v244, 9, v242
    v_add_u32 v243, v243, v244
    v_subrev_u32 v244, 1536, v247
    v_cndmask_b32 v244, 0, v244, vcc
    v_add_u32 v243, v243, v244
    v_mov_b32 v244, 1024
    v_cndmask_b32 v242, 0, v244, s[28:29]
    v_add_u32 v218, v243, v242
    v_cndmask_b32 v244, v244, v247, s[28:29]
    v_add_u32 v219, v218, v244
    s_branch L_c_addrdone
L_c_vaddr:
    s_sub_u32 s61, s34, 10
    s_lshl_b32 s61, s61, 7
    s_lshl_b32 s30, s36, 6
    s_add_u32 s61, s61, s30
    s_mul_i32 s60, s56, 5120
    s_add_u32 s60, s60, 2624000
    s_mov_b32 s58, 163840
    v_lshrrev_b32 v240, 5, v250
    v_mul_u32_u24 v240, 320, v240
    v_add_u32 v240, s60, v240
    v_and_b32 v241, 31, v250
    v_add_u32 v241, s61, v241
    v_add_u32 v242, 0, v241
    v_mul_u32_u24 v243, 52429, v242
    v_lshrrev_b32 v243, 20, v243
    v_mul_u32_u24 v244, 20, v243
    v_sub_u32 v242, v242, v244
    v_mul_u32_u24 v243, s58, v243
    v_lshl_add_u32 v243, v242, 4, v243
    v_add_u32 v212, v243, v240
    v_add_u32 v242, 32, v241
    v_mul_u32_u24 v243, 52429, v242
    v_lshrrev_b32 v243, 20, v243
    v_mul_u32_u24 v244, 20, v243
    v_sub_u32 v242, v242, v244
    v_mul_u32_u24 v243, s58, v243
    v_lshl_add_u32 v243, v242, 4, v243
    v_add_u32 v213, v243, v240
    v_mov_b32 v214, v212
    v_mov_b32 v215, v212
    v_mov_b32 v216, v212
    v_mov_b32 v217, v212
    v_mov_b32 v218, v212
    v_mov_b32 v219, v212
L_c_addrdone:
    v_mov_b64 v[0:1], 0
    v_mov_b64 v[2:3], 0
    v_mov_b64 v[4:5], 0
    v_mov_b64 v[6:7], 0
    v_mov_b64 v[8:9], 0
    v_mov_b64 v[10:11], 0
    v_mov_b64 v[12:13], 0
    v_mov_b64 v[14:15], 0
    v_mov_b64 v[16:17], 0
    v_mov_b64 v[18:19], 0
    v_mov_b64 v[20:21], 0
    v_mov_b64 v[22:23], 0
    v_mov_b64 v[24:25], 0
    v_mov_b64 v[26:27], 0
    v_mov_b64 v[28:29], 0
    v_mov_b64 v[30:31], 0
    v_mov_b64 v[32:33], 0
    v_mov_b64 v[34:35], 0
    v_mov_b64 v[36:37], 0
    v_mov_b64 v[38:39], 0
    v_mov_b64 v[40:41], 0
    v_mov_b64 v[42:43], 0
    v_mov_b64 v[44:45], 0
    v_mov_b64 v[46:47], 0
    v_mov_b64 v[48:49], 0
    v_mov_b64 v[50:51], 0
    v_mov_b64 v[52:53], 0
    v_mov_b64 v[54:55], 0
    v_mov_b64 v[56:57], 0
    v_mov_b64 v[58:59], 0
    v_mov_b64 v[60:61], 0
    v_mov_b64 v[62:63], 0
    s_mov_b32 s16, s88
    s_and_b32 s17, s89, 0xffff
    s_mov_b32 s18, 33554432
    s_mov_b32 s19, 0x00020000
    v_mov_b32 v228, 163756
    v_mov_b32 v229, 1
    s_mov_b32 m0, s3
    s_nop 0
    buffer_load_dwordx4 v220, s[8:11], s46 offen lds
    s_add_u32 m0, s3, 4160
    s_nop 0
    buffer_load_dwordx4 v221, s[8:11], s46 offen lds
    s_add_u32 m0, s3, 8320
    s_nop 0
    buffer_load_dwordx4 v222, s[8:11], s46 offen lds
    s_add_u32 m0, s3, 12480
    s_nop 0
    buffer_load_dwordx4 v223, s[8:11], s46 offen lds
    s_add_u32 m0, s3, s1
    s_nop 0
    buffer_load_dwordx4 v234, s[12:15], s47 offen lds
    s_add_u32 m0, m0, 4096
    s_nop 0
    buffer_load_dwordx4 v235, s[12:15], s47 offen lds
    s_add_u32 m0, m0, 4096
    s_nop 0
    buffer_load_dwordx4 v236, s[12:15], s47 offen lds
    s_add_u32 m0, m0, 4096
    s_nop 0
    buffer_load_dwordx4 v237, s[12:15], s47 offen lds
    s_add_u32 s46, s46, 128
    s_add_u32 s47, s47, 245760
    s_cmp_eq_u32 s46, 1280
    s_cselect_b32 s46, 0, s46
    s_cselect_b32 s47, 0, s47
    s_add_u32 s3, s3, 33024
    s_sub_u32 s30, s3, 99072
    s_cmp_ge_u32 s3, 99072
    s_cselect_b32 s3, s30, s3
    s_mov_b32 s50, 4
    s_waitcnt vmcnt(8)
    s_mov_b64 exec, 1
    ds_add_rtn_u32 v230, v228, v229
    s_mov_b32 s44, 1000000
    s_waitcnt lgkmcnt(0)
    v_readfirstlane_b32 s45, v230
    s_mov_b64 exec, -1
    s_add_u32 s45, s45, 1
    s_cmp_ge_u32 s45, s50
    s_cbranch_scc1 L_c_s0_d
L_c_s0:
    ds_read_b32 v230, v228
    s_sub_u32 s44, s44, 1
    s_waitcnt lgkmcnt(0)
    v_readfirstlane_b32 s45, v230
    s_cmp_eq_u32 s44, 0
    s_cselect_b32 s45, s50, s45
    s_cmp_lt_u32 s45, s50
    s_cbranch_scc1 L_c_s0
L_c_s0_d:
    s_add_u32 s50, s50, 4
    s_mov_b32 m0, s3
    s_nop 0
    buffer_load_dwordx4 v220, s[8:11], s46 offen lds
    s_add_u32 m0, s3, 4160
    s_nop 0
    buffer_load_dwordx4 v221, s[8:11], s46 offen lds
    s_cmp_ge_u32 s34, 10
    s_cbranch_scc1 L_c_v
    s_mov_b32 s48, 0
    s_mov_b32 s49, 0
    ds_read_b128 v[64:67], v206 offset:0
    ds_read_b64_tr_b16 v[80:81], v210 offset:0
    ds_read_b64_tr_b16 v[82:83], v210 offset:1024
    ds_read_b128 v[68:71], v206 offset:4160
    ds_read_b64_tr_b16 v[84:85], v211 offset:0
    ds_read_b64_tr_b16 v[86:87], v211 offset:1024
L_c_qke:
    s_waitcnt lgkmcnt(3)
    v_mfma_f32_32x32x16_bf16 v[0:15], v[80:83], v[64:67], v[0:15]
    ds_read_b128 v[72:75], v206 offset:32
    ds_read_b64_tr_b16 v[88:89], v210 offset:4096
    s_add_u32 m0, s3, 8320
    s_nop 0
    buffer_load_dwordx4 v222, s[8:11], s46 offen lds
    s_waitcnt lgkmcnt(4)
    v_mfma_f32_32x32x16_bf16 v[16:31], v[80:83], v[68:71], v[16:31]
    ds_read_b64_tr_b16 v[90:91], v210 offset:5120
    ds_read_b128 v[76:79], v206 offset:4192
    s_add_u32 m0, s3, 12480
    s_nop 0
    buffer_load_dwordx4 v223, s[8:11], s46 offen lds
    s_waitcnt lgkmcnt(4)
    v_mfma_f32_32x32x16_bf16 v[32:47], v[84:87], v[64:67], v[32:47]
    ds_read_b64_tr_b16 v[92:93], v211 offset:4096
    ds_read_b64_tr_b16 v[94:95], v211 offset:5120
    v_mfma_f32_32x32x16_bf16 v[48:63], v[84:87], v[68:71], v[48:63]
    s_add_u32 m0, s3, s1
    s_nop 0
    buffer_load_dwordx4 v234, s[12:15], s47 offen lds
    s_waitcnt lgkmcnt(3)
    v_mfma_f32_32x32x16_bf16 v[0:15], v[88:91], v[72:75], v[0:15]
    ds_read_b128 v[64:67], v207 offset:0
    ds_read_b64_tr_b16 v[80:81], v210 offset:8192
    s_add_u32 m0, m0, 4096
    s_nop 0
    buffer_load_dwordx4 v235, s[12:15], s47 offen lds
    s_waitcnt lgkmcnt(4)
    v_mfma_f32_32x32x16_bf16 v[16:31], v[88:91], v[76:79], v[16:31]
    ds_read_b64_tr_b16 v[82:83], v210 offset:9216
    ds_read_b128 v[68:71], v207 offset:4160
    s_add_u32 m0, m0, 4096
    s_nop 0
    buffer_load_dwordx4 v236, s[12:15], s47 offen lds
    s_waitcnt lgkmcnt(4)
    v_mfma_f32_32x32x16_bf16 v[32:47], v[92:95], v[72:75], v[32:47]
    ds_read_b64_tr_b16 v[84:85], v211 offset:8192
    ds_read_b64_tr_b16 v[86:87], v211 offset:9216
    s_add_u32 s48, s48, 33024
    s_cmp_eq_u32 s48, 99072
    s_cselect_b32 s48, 0, s48
    v_mfma_f32_32x32x16_bf16 v[48:63], v[92:95], v[76:79], v[48:63]
    s_add_u32 m0, m0, 4096
    s_nop 0
    buffer_load_dwordx4 v237, s[12:15], s47 offen lds
    s_add_u32 s46, s46, 128
    s_add_u32 s47, s47, 245760
    s_cmp_eq_u32 s46, 1280
    s_cselect_b32 s46, 0, s46
    s_cselect_b32 s47, 0, s47
    s_add_u32 s3, s3, 33024
    s_sub_u32 s30, s3, 99072
    s_cmp_ge_u32 s3, 99072
    s_cselect_b32 s3, s30, s3
    s_waitcnt lgkmcnt(3)
    v_mfma_f32_32x32x16_bf16 v[0:15], v[80:83], v[64:67], v[0:15]
    ds_read_b128 v[72:75], v207 offset:32
    ds_read_b64_tr_b16 v[88:89], v210 offset:12288
    s_waitcnt lgkmcnt(4)
    v_mfma_f32_32x32x16_bf16 v[16:31], v[80:83], v[68:71], v[16:31]
    ds_read_b64_tr_b16 v[90:91], v210 offset:13312
    ds_read_b128 v[76:79], v207 offset:4192
    s_waitcnt lgkmcnt(4)
    v_mfma_f32_32x32x16_bf16 v[32:47], v[84:87], v[64:67], v[32:47]
    ds_read_b64_tr_b16 v[92:93], v211 offset:12288
    ds_read_b64_tr_b16 v[94:95], v211 offset:13312
    v_mfma_f32_32x32x16_bf16 v[48:63], v[84:87], v[68:71], v[48:63]
    v_add_u32 v206, s48, v200
    v_add_u32 v207, s48, v201
    s_waitcnt lgkmcnt(3)
    v_mfma_f32_32x32x16_bf16 v[0:15], v[88:91], v[72:75], v[0:15]
    v_add_u32 v210, s48, v204
    v_add_u32 v211, s48, v205
    s_waitcnt lgkmcnt(0)
    v_mfma_f32_32x32x16_bf16 v[16:31], v[88:91], v[76:79], v[16:31]
    s_waitcnt vmcnt(8)
    s_cmp_eq_u32 s49, 2
    s_cbranch_scc1 L_c_qk_b
    s_mov_b64 exec, 1
    ds_add_rtn_u32 v230, v228, v229
    s_mov_b32 s44, 1000000
    s_waitcnt lgkmcnt(0)
    v_readfirstlane_b32 s45, v230
    s_mov_b64 exec, -1
    s_add_u32 s45, s45, 1
    s_cmp_ge_u32 s45, s50
    s_cbranch_scc1 L_c_qke_s_d
L_c_qke_s:
    ds_read_b32 v230, v228
    s_sub_u32 s44, s44, 1
    s_waitcnt lgkmcnt(0)
    v_readfirstlane_b32 s45, v230
    s_cmp_eq_u32 s44, 0
    s_cselect_b32 s45, s50, s45
    s_cmp_lt_u32 s45, s50
    s_cbranch_scc1 L_c_qke_s
L_c_qke_s_d:
    s_add_u32 s50, s50, 4
    s_mov_b32 m0, s3
    s_nop 0
    buffer_load_dwordx4 v220, s[8:11], s46 offen lds
    s_add_u32 m0, s3, 4160
    s_nop 0
    buffer_load_dwordx4 v221, s[8:11], s46 offen lds
    ds_read_b128 v[64:67], v206 offset:0
    ds_read_b64_tr_b16 v[80:81], v210 offset:0
    ds_read_b64_tr_b16 v[82:83], v210 offset:1024
    v_mfma_f32_32x32x16_bf16 v[32:47], v[92:95], v[72:75], v[32:47]
    ds_read_b128 v[68:71], v206 offset:4160
    ds_read_b64_tr_b16 v[84:85], v211 offset:0
    ds_read_b64_tr_b16 v[86:87], v211 offset:1024
    s_add_u32 s49, s49, 1
    v_mfma_f32_32x32x16_bf16 v[48:63], v[92:95], v[76:79], v[48:63]
    s_branch L_c_qke
L_c_qk:
    s_waitcnt lgkmcnt(3)
    v_mfma_f32_32x32x16_bf16 v[0:15], v[80:83], v[64:67], v[0:15]
    ds_read_b128 v[72:75], v206 offset:32
    ds_read_b64_tr_b16 v[88:89], v210 offset:4096
    s_waitcnt lgkmcnt(4)
    v_mfma_f32_32x32x16_bf16 v[16:31], v[80:83], v[68:71], v[16:31]
    ds_read_b64_tr_b16 v[90:91], v210 offset:5120
    ds_read_b128 v[76:79], v206 offset:4192
    s_waitcnt lgkmcnt(4)
    v_mfma_f32_32x32x16_bf16 v[32:47], v[84:87], v[64:67], v[32:47]
    ds_read_b64_tr_b16 v[92:93], v211 offset:4096
    ds_read_b64_tr_b16 v[94:95], v211 offset:5120
    v_mfma_f32_32x32x16_bf16 v[48:63], v[84:87], v[68:71], v[48:63]
    s_waitcnt lgkmcnt(3)
    v_mfma_f32_32x32x16_bf16 v[0:15], v[88:91], v[72:75], v[0:15]
    ds_read_b128 v[64:67], v207 offset:0
    ds_read_b64_tr_b16 v[80:81], v210 offset:8192
    s_waitcnt lgkmcnt(4)
    v_mfma_f32_32x32x16_bf16 v[16:31], v[88:91], v[76:79], v[16:31]
    ds_read_b64_tr_b16 v[82:83], v210 offset:9216
    ds_read_b128 v[68:71], v207 offset:4160
    s_waitcnt lgkmcnt(4)
    v_mfma_f32_32x32x16_bf16 v[32:47], v[92:95], v[72:75], v[32:47]
    ds_read_b64_tr_b16 v[84:85], v211 offset:8192
    ds_read_b64_tr_b16 v[86:87], v211 offset:9216
    s_add_u32 s48, s48, 33024
    s_cmp_eq_u32 s48, 99072
    s_cselect_b32 s48, 0, s48
    v_mfma_f32_32x32x16_bf16 v[48:63], v[92:95], v[76:79], v[48:63]
    s_waitcnt lgkmcnt(3)
    v_mfma_f32_32x32x16_bf16 v[0:15], v[80:83], v[64:67], v[0:15]
    ds_read_b128 v[72:75], v207 offset:32
    ds_read_b64_tr_b16 v[88:89], v210 offset:12288
    s_waitcnt lgkmcnt(4)
    v_mfma_f32_32x32x16_bf16 v[16:31], v[80:83], v[68:71], v[16:31]
    ds_read_b64_tr_b16 v[90:91], v210 offset:13312
    ds_read_b128 v[76:79], v207 offset:4192
    s_waitcnt lgkmcnt(4)
    v_mfma_f32_32x32x16_bf16 v[32:47], v[84:87], v[64:67], v[32:47]
    ds_read_b64_tr_b16 v[92:93], v211 offset:12288
    ds_read_b64_tr_b16 v[94:95], v211 offset:13312
    v_mfma_f32_32x32x16_bf16 v[48:63], v[84:87], v[68:71], v[48:63]
    v_add_u32 v206, s48, v200
    v_add_u32 v207, s48, v201
    s_waitcnt lgkmcnt(3)
    v_mfma_f32_32x32x16_bf16 v[0:15], v[88:91], v[72:75], v[0:15]
    v_add_u32 v210, s48, v204
    v_add_u32 v211, s48, v205
    s_cmp_eq_u32 s49, 3
    s_cbranch_scc1 L_c_qk_x
L_c_qk_r:
    s_waitcnt lgkmcnt(0)
    v_mfma_f32_32x32x16_bf16 v[16:31], v[88:91], v[76:79], v[16:31]
L_c_qk_b:
    s_barrier
    ds_read_b128 v[64:67], v206 offset:0
    ds_read_b64_tr_b16 v[80:81], v210 offset:0
    ds_read_b64_tr_b16 v[82:83], v210 offset:1024
    v_mfma_f32_32x32x16_bf16 v[32:47], v[92:95], v[72:75], v[32:47]
    ds_read_b128 v[68:71], v206 offset:4160
    ds_read_b64_tr_b16 v[84:85], v211 offset:0
    ds_read_b64_tr_b16 v[86:87], v211 offset:1024
    s_add_u32 s49, s49, 1
    s_cmp_lt_u32 s49, 10
    v_mfma_f32_32x32x16_bf16 v[48:63], v[92:95], v[76:79], v[48:63]
    s_cbranch_scc1 L_c_qk
    s_setprio 3
    s_waitcnt lgkmcnt(0)
    s_nop 11
    s_cmp_ge_u32 s34, 5
    s_cbranch_scc1 L_c_nosc
    v_pk_mul_f32 v[0:1], v[0:1], s[62:63] op_sel_hi:[1,0]
    v_pk_mul_f32 v[2:3], v[2:3], s[62:63] op_sel_hi:[1,0]
    v_pk_mul_f32 v[4:5], v[4:5], s[62:63] op_sel_hi:[1,0]
    v_pk_mul_f32 v[6:7], v[6:7], s[62:63] op_sel_hi:[1,0]
    v_pk_mul_f32 v[8:9], v[8:9], s[62:63] op_sel_hi:[1,0]
    v_pk_mul_f32 v[10:11], v[10:11], s[62:63] op_sel_hi:[1,0]
    v_pk_mul_f32 v[12:13], v[12:13], s[62:63] op_sel_hi:[1,0]
    v_pk_mul_f32 v[14:15], v[14:15], s[62:63] op_sel_hi:[1,0]
    v_pk_mul_f32 v[16:17], v[16:17], s[62:63] op_sel_hi:[1,0]
    v_pk_mul_f32 v[18:19], v[18:19], s[62:63] op_sel_hi:[1,0]
    v_pk_mul_f32 v[20:21], v[20:21], s[62:63] op_sel_hi:[1,0]
    v_pk_mul_f32 v[22:23], v[22:23], s[62:63] op_sel_hi:[1,0]
    v_pk_mul_f32 v[24:25], v[24:25], s[62:63] op_sel_hi:[1,0]
    v_pk_mul_f32 v[26:27], v[26:27], s[62:63] op_sel_hi:[1,0]
    v_pk_mul_f32 v[28:29], v[28:29], s[62:63] op_sel_hi:[1,0]
    v_pk_mul_f32 v[30:31], v[30:31], s[62:63] op_sel_hi:[1,0]
    v_pk_mul_f32 v[32:33], v[32:33], s[62:63] op_sel_hi:[1,0]
    v_pk_mul_f32 v[34:35], v[34:35], s[62:63] op_sel_hi:[1,0]
    v_pk_mul_f32 v[36:37], v[36:37], s[62:63] op_sel_hi:[1,0]
    v_pk_mul_f32 v[38:39], v[38:39], s[62:63] op_sel_hi:[1,0]
    v_pk_mul_f32 v[40:41], v[40:41], s[62:63] op_sel_hi:[1,0]
    v_pk_mul_f32 v[42:43], v[42:43], s[62:63] op_sel_hi:[1,0]
    v_pk_mul_f32 v[44:45], v[44:45], s[62:63] op_sel_hi:[1,0]
    v_pk_mul_f32 v[46:47], v[46:47], s[62:63] op_sel_hi:[1,0]
    v_pk_mul_f32 v[48:49], v[48:49], s[62:63] op_sel_hi:[1,0]
    v_pk_mul_f32 v[50:51], v[50:51], s[62:63] op_sel_hi:[1,0]
    v_pk_mul_f32 v[52:53], v[52:53], s[62:63] op_sel_hi:[1,0]
    v_pk_mul_f32 v[54:55], v[54:55], s[62:63] op_sel_hi:[1,0]
    v_pk_mul_f32 v[56:57], v[56:57], s[62:63] op_sel_hi:[1,0]
    v_pk_mul_f32 v[58:59], v[58:59], s[62:63] op_sel_hi:[1,0]
    v_pk_mul_f32 v[60:61], v[60:61], s[62:63] op_sel_hi:[1,0]
    v_pk_mul_f32 v[62:63], v[62:63], s[62:63] op_sel_hi:[1,0]
L_c_nosc:
    v_cvt_pk_bf16_f32 v64, v0, v1
    v_cvt_pk_bf16_f32 v65, v2, v3
    v_cvt_pk_bf16_f32 v66, v4, v5
    v_cvt_pk_bf16_f32 v67, v6, v7
    v_cvt_pk_bf16_f32 v68, v16, v17
    v_cvt_pk_bf16_f32 v69, v18, v19
    v_cvt_pk_bf16_f32 v70, v20, v21
    v_cvt_pk_bf16_f32 v71, v22, v23
    s_nop 0
    v_permlane32_swap_b32 v64, v66
    v_permlane32_swap_b32 v65, v67
    v_permlane32_swap_b32 v68, v70
    v_permlane32_swap_b32 v69, v71
    s_mov_b64 exec, s[90:91]
    v_swap_b32 v66, v68
    v_swap_b32 v67, v69
    s_mov_b64 exec, -1
    buffer_store_dwordx4 v[64:67], v212, s[16:19], 0 offen sc1
    buffer_store_dwordx4 v[68:71], v213, s[16:19], 0 offen sc1
    v_cvt_pk_bf16_f32 v72, v8, v9
    v_cvt_pk_bf16_f32 v73, v10, v11
    v_cvt_pk_bf16_f32 v74, v12, v13
    v_cvt_pk_bf16_f32 v75, v14, v15
    v_cvt_pk_bf16_f32 v76, v24, v25
    v_cvt_pk_bf16_f32 v77, v26, v27
    v_cvt_pk_bf16_f32 v78, v28, v29
    v_cvt_pk_bf16_f32 v79, v30, v31
    s_nop 0
    v_permlane32_swap_b32 v72, v74
    v_permlane32_swap_b32 v73, v75
    v_permlane32_swap_b32 v76, v78
    v_permlane32_swap_b32 v77, v79
    s_mov_b64 exec, s[92:93]
    v_swap_b32 v74, v76
    v_swap_b32 v75, v77
    s_mov_b64 exec, -1
    buffer_store_dwordx4 v[72:75], v214, s[16:19], 0 offen sc1
    buffer_store_dwordx4 v[76:79], v215, s[16:19], 0 offen sc1
    v_cvt_pk_bf16_f32 v80, v32, v33
    v_cvt_pk_bf16_f32 v81, v34, v35
    v_cvt_pk_bf16_f32 v82, v36, v37
    v_cvt_pk_bf16_f32 v83, v38, v39
    v_cvt_pk_bf16_f32 v84, v48, v49
    v_cvt_pk_bf16_f32 v85, v50, v51
    v_cvt_pk_bf16_f32 v86, v52, v53
    v_cvt_pk_bf16_f32 v87, v54, v55
    s_nop 0
    v_permlane32_swap_b32 v80, v82
    v_permlane32_swap_b32 v81, v83
    v_permlane32_swap_b32 v84, v86
    v_permlane32_swap_b32 v85, v87
    s_mov_b64 exec, s[94:95]
    v_swap_b32 v82, v84
    v_swap_b32 v83, v85
    s_mov_b64 exec, -1
    buffer_store_dwordx4 v[80:83], v216, s[16:19], 0 offen sc1
    buffer_store_dwordx4 v[84:87], v217, s[16:19], 0 offen sc1
    v_cvt_pk_bf16_f32 v88, v40, v41
    v_cvt_pk_bf16_f32 v89, v42, v43
    v_cvt_pk_bf16_f32 v90, v44, v45
    v_cvt_pk_bf16_f32 v91, v46, v47
    v_cvt_pk_bf16_f32 v92, v56, v57
    v_cvt_pk_bf16_f32 v93, v58, v59
    v_cvt_pk_bf16_f32 v94, v60, v61
    v_cvt_pk_bf16_f32 v95, v62, v63
    s_nop 0
    v_permlane32_swap_b32 v88, v90
    v_permlane32_swap_b32 v89, v91
    v_permlane32_swap_b32 v92, v94
    v_permlane32_swap_b32 v93, v95
    s_mov_b64 exec, s[28:29]
    v_swap_b32 v90, v92
    v_swap_b32 v91, v93
    s_mov_b64 exec, -1
    buffer_store_dwordx4 v[88:91], v218, s[16:19], 0 offen sc1
    buffer_store_dwordx4 v[92:95], v219, s[16:19], 0 offen sc1
    s_branch L_c_sig
L_c_qk_x:
    s_waitcnt vmcnt(0)
    global_load_dwordx2 v[248:249], v245, s[86:87] sc1
    s_branch L_c_qk_r
L_c_vl_x:
    s_waitcnt vmcnt(0)
    global_load_dwordx2 v[248:249], v245, s[86:87] sc1
    s_branch L_c_vl_r
L_c_v:
    s_mov_b32 s48, 0
    s_mov_b32 s49, 0
    ds_read_b128 v[64:67], v206 offset:0
    ds_read_b64_tr_b16 v[80:81], v210 offset:0
    ds_read_b64_tr_b16 v[82:83], v210 offset:1024
    ds_read_b128 v[68:71], v206 offset:4160
    ds_read_b64_tr_b16 v[84:85], v211 offset:0
    ds_read_b64_tr_b16 v[86:87], v211 offset:1024
L_c_vle:
    s_waitcnt lgkmcnt(3)
    v_mfma_f32_32x32x16_bf16 v[0:15], v[64:67], v[80:83], v[0:15]
    ds_read_b128 v[72:75], v206 offset:32
    ds_read_b64_tr_b16 v[88:89], v210 offset:4096
    s_add_u32 m0, s3, 8320
    s_nop 0
    buffer_load_dwordx4 v222, s[8:11], s46 offen lds
    s_waitcnt lgkmcnt(4)
    v_mfma_f32_32x32x16_bf16 v[16:31], v[68:71], v[80:83], v[16:31]
    ds_read_b64_tr_b16 v[90:91], v210 offset:5120
    ds_read_b128 v[76:79], v206 offset:4192
    s_add_u32 m0, s3, 12480
    s_nop 0
    buffer_load_dwordx4 v223, s[8:11], s46 offen lds
    s_waitcnt lgkmcnt(4)
    v_mfma_f32_32x32x16_bf16 v[32:47], v[64:67], v[84:87], v[32:47]
    ds_read_b64_tr_b16 v[92:93], v211 offset:4096
    ds_read_b64_tr_b16 v[94:95], v211 offset:5120
    v_mfma_f32_32x32x16_bf16 v[48:63], v[68:71], v[84:87], v[48:63]
    s_add_u32 m0, s3, s1
    s_nop 0
    buffer_load_dwordx4 v234, s[12:15], s47 offen lds
    s_waitcnt lgkmcnt(3)
    v_mfma_f32_32x32x16_bf16 v[0:15], v[72:75], v[88:91], v[0:15]
    ds_read_b128 v[64:67], v207 offset:0
    ds_read_b64_tr_b16 v[80:81], v210 offset:8192
    s_add_u32 m0, m0, 4096
    s_nop 0
    buffer_load_dwordx4 v235, s[12:15], s47 offen lds
    s_waitcnt lgkmcnt(4)
    v_mfma_f32_32x32x16_bf16 v[16:31], v[76:79], v[88:91], v[16:31]
    ds_read_b64_tr_b16 v[82:83], v210 offset:9216
    ds_read_b128 v[68:71], v207 offset:4160
    s_add_u32 m0, m0, 4096
    s_nop 0
    buffer_load_dwordx4 v236, s[12:15], s47 offen lds
    s_waitcnt lgkmcnt(4)
    v_mfma_f32_32x32x16_bf16 v[32:47], v[72:75], v[92:95], v[32:47]
    ds_read_b64_tr_b16 v[84:85], v211 offset:8192
    ds_read_b64_tr_b16 v[86:87], v211 offset:9216
    s_add_u32 s48, s48, 33024
    s_cmp_eq_u32 s48, 99072
    s_cselect_b32 s48, 0, s48
    v_mfma_f32_32x32x16_bf16 v[48:63], v[76:79], v[92:95], v[48:63]
    s_add_u32 m0, m0, 4096
    s_nop 0
    buffer_load_dwordx4 v237, s[12:15], s47 offen lds
    s_add_u32 s46, s46, 128
    s_add_u32 s47, s47, 245760
    s_cmp_eq_u32 s46, 1280
    s_cselect_b32 s46, 0, s46
    s_cselect_b32 s47, 0, s47
    s_add_u32 s3, s3, 33024
    s_sub_u32 s30, s3, 99072
    s_cmp_ge_u32 s3, 99072
    s_cselect_b32 s3, s30, s3
    s_waitcnt lgkmcnt(3)
    v_mfma_f32_32x32x16_bf16 v[0:15], v[64:67], v[80:83], v[0:15]
    ds_read_b128 v[72:75], v207 offset:32
    ds_read_b64_tr_b16 v[88:89], v210 offset:12288
    s_waitcnt lgkmcnt(4)
    v_mfma_f32_32x32x16_bf16 v[16:31], v[68:71], v[80:83], v[16:31]
    ds_read_b64_tr_b16 v[90:91], v210 offset:13312
    ds_read_b128 v[76:79], v207 offset:4192
    s_waitcnt lgkmcnt(4)
    v_mfma_f32_32x32x16_bf16 v[32:47], v[64:67], v[84:87], v[32:47]
    ds_read_b64_tr_b16 v[92:93], v211 offset:12288
    ds_read_b64_tr_b16 v[94:95], v211 offset:13312
    v_mfma_f32_32x32x16_bf16 v[48:63], v[68:71], v[84:87], v[48:63]
    v_add_u32 v206, s48, v200
    v_add_u32 v207, s48, v201
    s_waitcnt lgkmcnt(3)
    v_mfma_f32_32x32x16_bf16 v[0:15], v[72:75], v[88:91], v[0:15]
    v_add_u32 v210, s48, v204
    v_add_u32 v211, s48, v205
    s_waitcnt lgkmcnt(0)
    v_mfma_f32_32x32x16_bf16 v[16:31], v[76:79], v[88:91], v[16:31]
    s_waitcnt vmcnt(8)
    s_cmp_eq_u32 s49, 2
    s_cbranch_scc1 L_c_vl_b
    s_mov_b64 exec, 1
    ds_add_rtn_u32 v230, v228, v229
    s_mov_b32 s44, 1000000
    s_waitcnt lgkmcnt(0)
    v_readfirstlane_b32 s45, v230
    s_mov_b64 exec, -1
    s_add_u32 s45, s45, 1
    s_cmp_ge_u32 s45, s50
    s_cbranch_scc1 L_c_vle_s_d
L_c_vle_s:
    ds_read_b32 v230, v228
    s_sub_u32 s44, s44, 1
    s_waitcnt lgkmcnt(0)
    v_readfirstlane_b32 s45, v230
    s_cmp_eq_u32 s44, 0
    s_cselect_b32 s45, s50, s45
    s_cmp_lt_u32 s45, s50
    s_cbranch_scc1 L_c_vle_s
L_c_vle_s_d:
    s_add_u32 s50, s50, 4
    s_mov_b32 m0, s3
    s_nop 0
    buffer_load_dwordx4 v220, s[8:11], s46 offen lds
    s_add_u32 m0, s3, 4160
    s_nop 0
    buffer_load_dwordx4 v221, s[8:11], s46 offen lds
    ds_read_b128 v[64:67], v206 offset:0
    ds_read_b64_tr_b16 v[80:81], v210 offset:0
    ds_read_b64_tr_b16 v[82:83], v210 offset:1024
    v_mfma_f32_32x32x16_bf16 v[32:47], v[72:75], v[92:95], v[32:47]
    ds_read_b128 v[68:71], v206 offset:4160
    ds_read_b64_tr_b16 v[84:85], v211 offset:0
    ds_read_b64_tr_b16 v[86:87], v211 offset:1024
    s_add_u32 s49, s49, 1
    v_mfma_f32_32x32x16_bf16 v[48:63], v[76:79], v[92:95], v[48:63]
    s_branch L_c_vle
L_c_vl:
    s_waitcnt lgkmcnt(3)
    v_mfma_f32_32x32x16_bf16 v[0:15], v[64:67], v[80:83], v[0:15]
    ds_read_b128 v[72:75], v206 offset:32
    ds_read_b64_tr_b16 v[88:89], v210 offset:4096
    s_waitcnt lgkmcnt(4)
    v_mfma_f32_32x32x16_bf16 v[16:31], v[68:71], v[80:83], v[16:31]
    ds_read_b64_tr_b16 v[90:91], v210 offset:5120
    ds_read_b128 v[76:79], v206 offset:4192
    s_waitcnt lgkmcnt(4)
    v_mfma_f32_32x32x16_bf16 v[32:47], v[64:67], v[84:87], v[32:47]
    ds_read_b64_tr_b16 v[92:93], v211 offset:4096
    ds_read_b64_tr_b16 v[94:95], v211 offset:5120
    v_mfma_f32_32x32x16_bf16 v[48:63], v[68:71], v[84:87], v[48:63]
    s_waitcnt lgkmcnt(3)
    v_mfma_f32_32x32x16_bf16 v[0:15], v[72:75], v[88:91], v[0:15]
    ds_read_b128 v[64:67], v207 offset:0
    ds_read_b64_tr_b16 v[80:81], v210 offset:8192
    s_waitcnt lgkmcnt(4)
    v_mfma_f32_32x32x16_bf16 v[16:31], v[76:79], v[88:91], v[16:31]
    ds_read_b64_tr_b16 v[82:83], v210 offset:9216
    ds_read_b128 v[68:71], v207 offset:4160
    s_waitcnt lgkmcnt(4)
    v_mfma_f32_32x32x16_bf16 v[32:47], v[72:75], v[92:95], v[32:47]
    ds_read_b64_tr_b16 v[84:85], v211 offset:8192
    ds_read_b64_tr_b16 v[86:87], v211 offset:9216
    s_add_u32 s48, s48, 33024
    s_cmp_eq_u32 s48, 99072
    s_cselect_b32 s48, 0, s48
    v_mfma_f32_32x32x16_bf16 v[48:63], v[76:79], v[92:95], v[48:63]
    s_waitcnt lgkmcnt(3)
    v_mfma_f32_32x32x16_bf16 v[0:15], v[64:67], v[80:83], v[0:15]
    ds_read_b128 v[72:75], v207 offset:32
    ds_read_b64_tr_b16 v[88:89], v210 offset:12288
    s_waitcnt lgkmcnt(4)
    v_mfma_f32_32x32x16_bf16 v[16:31], v[68:71], v[80:83], v[16:31]
    ds_read_b64_tr_b16 v[90:91], v210 offset:13312
    ds_read_b128 v[76:79], v207 offset:4192
    s_waitcnt lgkmcnt(4)
    v_mfma_f32_32x32x16_bf16 v[32:47], v[64:67], v[84:87], v[32:47]
    ds_read_b64_tr_b16 v[92:93], v211 offset:12288
    ds_read_b64_tr_b16 v[94:95], v211 offset:13312
    v_mfma_f32_32x32x16_bf16 v[48:63], v[68:71], v[84:87], v[48:63]
    v_add_u32 v206, s48, v200
    v_add_u32 v207, s48, v201
    s_waitcnt lgkmcnt(3)
    v_mfma_f32_32x32x16_bf16 v[0:15], v[72:75], v[88:91], v[0:15]
    v_add_u32 v210, s48, v204
    v_add_u32 v211, s48, v205
    s_cmp_eq_u32 s49, 3
    s_cbranch_scc1 L_c_vl_x
L_c_vl_r:
    s_waitcnt lgkmcnt(0)
    v_mfma_f32_32x32x16_bf16 v[16:31], v[76:79], v[88:91], v[16:31]
L_c_vl_b:
    s_barrier
    ds_read_b128 v[64:67], v206 offset:0
    ds_read_b64_tr_b16 v[80:81], v210 offset:0
    ds_read_b64_tr_b16 v[82:83], v210 offset:1024
    v_mfma_f32_32x32x16_bf16 v[32:47], v[72:75], v[92:95], v[32:47]
    ds_read_b128 v[68:71], v206 offset:4160
    ds_read_b64_tr_b16 v[84:85], v211 offset:0
    ds_read_b64_tr_b16 v[86:87], v211 offset:1024
    s_add_u32 s49, s49, 1
    s_cmp_lt_u32 s49, 10
    v_mfma_f32_32x32x16_bf16 v[48:63], v[76:79], v[92:95], v[48:63]
    s_cbranch_scc1 L_c_vl
    s_setprio 3
    s_waitcnt lgkmcnt(0)
    s_nop 11
    v_cvt_pk_bf16_f32 v64, v0, v1
    v_cvt_pk_bf16_f32 v65, v2, v3
    v_cvt_pk_bf16_f32 v66, v4, v5
    v_cvt_pk_bf16_f32 v67, v6, v7
    buffer_store_dwordx4 v[64:67], v212, s[16:19], 0 offen offset:0 sc1
    v_cvt_pk_bf16_f32 v68, v8, v9
    v_cvt_pk_bf16_f32 v69, v10, v11
    v_cvt_pk_bf16_f32 v70, v12, v13
    v_cvt_pk_bf16_f32 v71, v14, v15
    buffer_store_dwordx4 v[68:71], v212, s[16:19], 0 offen offset:640 sc1
    v_cvt_pk_bf16_f32 v72, v16, v17
    v_cvt_pk_bf16_f32 v73, v18, v19
    v_cvt_pk_bf16_f32 v74, v20, v21
    v_cvt_pk_bf16_f32 v75, v22, v23
    buffer_store_dwordx4 v[72:75], v212, s[16:19], 0 offen offset:1280 sc1
    v_cvt_pk_bf16_f32 v76, v24, v25
    v_cvt_pk_bf16_f32 v77, v26, v27
    v_cvt_pk_bf16_f32 v78, v28, v29
    v_cvt_pk_bf16_f32 v79, v30, v31
    buffer_store_dwordx4 v[76:79], v212, s[16:19], 0 offen offset:1920 sc1
    v_cvt_pk_bf16_f32 v80, v32, v33
    v_cvt_pk_bf16_f32 v81, v34, v35
    v_cvt_pk_bf16_f32 v82, v36, v37
    v_cvt_pk_bf16_f32 v83, v38, v39
    buffer_store_dwordx4 v[80:83], v213, s[16:19], 0 offen offset:0 sc1
    v_cvt_pk_bf16_f32 v84, v40, v41
    v_cvt_pk_bf16_f32 v85, v42, v43
    v_cvt_pk_bf16_f32 v86, v44, v45
    v_cvt_pk_bf16_f32 v87, v46, v47
    buffer_store_dwordx4 v[84:87], v213, s[16:19], 0 offen offset:640 sc1
    v_cvt_pk_bf16_f32 v88, v48, v49
    v_cvt_pk_bf16_f32 v89, v50, v51
    v_cvt_pk_bf16_f32 v90, v52, v53
    v_cvt_pk_bf16_f32 v91, v54, v55
    buffer_store_dwordx4 v[88:91], v213, s[16:19], 0 offen offset:1280 sc1
    v_cvt_pk_bf16_f32 v92, v56, v57
    v_cvt_pk_bf16_f32 v93, v58, v59
    v_cvt_pk_bf16_f32 v94, v60, v61
    v_cvt_pk_bf16_f32 v95, v62, v63
    buffer_store_dwordx4 v[92:95], v213, s[16:19], 0 offen offset:1920 sc1
L_c_sig:
    s_waitcnt vmcnt(8)
    v_readfirstlane_b32 s42, v248
    v_readfirstlane_b32 s43, v249
    s_cmp_lg_u32 s43, 0
    s_cbranch_scc1 L_nf_c
    s_mov_b32 s44, 1000000
L_ng_25:
    global_load_dwordx2 v[248:249], v245, s[86:87] sc1
L_ng_25_w:
    s_waitcnt vmcnt(0)
    v_readfirstlane_b32 s42, v248
    v_readfirstlane_b32 s43, v249
    s_cmp_lg_u32 s43, 0
    s_cbranch_scc1 L_nd_26
    s_sleep 2
    s_sub_u32 s44, s44, 1
    s_cmp_lg_u32 s44, 0
    s_cbranch_scc1 L_ng_25
L_nd_26:
L_nf_c:
    s_waitcnt vmcnt(0)
    v_mov_b32 v240, 163764
    v_mov_b32 v241, 1
    s_mov_b64 exec, 1
    ds_add_rtn_u32 v241, v240, v241
    s_waitcnt lgkmcnt(0)
    v_readfirstlane_b32 s60, v241
    s_mov_b64 exec, -1
    s_mov_b32 s61, 0
    s_cmp_lg_u32 s60, 3
    s_cbranch_scc1 L_c_postn
    s_lshr_b32 s31, s57, 5
    s_mul_i32 s31, s31, 4352
    s_and_b32 s57, s57, 31
    s_add_u32 s57, s57, s31
    s_add_u32 s57, s57, 16777216
    v_mov_b32 v240, s42
    v_mov_b32 v241, s43
    v_lshlrev_b32 v242, 3, v250
    s_mov_b64 exec, 0x1
    buffer_store_dwordx2 v[240:241], v242, s[16:19], s57 offen sc1
    s_mov_b64 exec, -1
    s_mov_b32 s61, 1
L_c_postn:
L_att:
    s_setprio 0
    v_lshlrev_b32 v135, 4, v250
    s_lshr_b32 s54, s38, 2
    s_lshl_b32 s54, s54, 2
    s_add_u32 s40, s54, s32
    s_mul_i32 s57, s39, 81920
    s_mul_i32 s54, s40, 2560
    s_add_u32 s57, s57, s54
    s_mul_i32 s52, s39, 163840
    s_add_u32 s52, s52, 2621440
    v_and_b32 v144, 31, v250
    v_lshrrev_b32 v145, 5, v250
    v_mul_u32_u24 v145, 320, v145
    v_lshl_add_u32 v134, v144, 4, v145
    v_cmp_eq_u32 vcc, 20, v144
    v_mov_b32 v145, 0x3f803f80
    v_mov_b32 v133, v135
    v_cndmask_b32 v145, 0, v145, vcc
    s_mov_b32 s28, 0x000fffff
    s_mov_b32 s29, 0x000fffff
    v_mov_b32 v100, v145
    v_mov_b32 v101, v145
    v_mov_b32 v102, v145
    v_mov_b32 v103, v145
    v_mov_b32 v104, v145
    v_mov_b32 v105, v145
    v_mov_b32 v106, v145
    v_mov_b32 v107, v145
    v_mov_b32 v108, v145
    v_mov_b32 v109, v145
    v_mov_b32 v110, v145
    v_mov_b32 v111, v145
    v_mov_b32 v112, v145
    v_mov_b32 v113, v145
    v_mov_b32 v114, v145
    v_mov_b32 v115, v145
    v_mov_b32 v116, v145
    v_mov_b32 v117, v145
    v_mov_b32 v118, v145
    v_mov_b32 v119, v145
    v_mov_b32 v120, v145
    v_mov_b32 v121, v145
    v_mov_b32 v122, v145
    v_mov_b32 v123, v145
    v_mov_b32 v124, v145
    v_mov_b32 v125, v145
    v_mov_b32 v126, v145
    v_mov_b32 v127, v145
    v_mov_b32 v128, v145
    v_mov_b32 v129, v145
    v_mov_b32 v130, v145
    v_mov_b32 v131, v145
    v_mov_b32 v200, v145
    v_mov_b32 v201, v145
    v_mov_b32 v202, v145
    v_mov_b32 v203, v145
    v_mov_b32 v204, v145
    v_mov_b32 v205, v145
    v_mov_b32 v206, v145
    v_mov_b32 v207, v145
    v_mov_b32 v208, v145
    v_mov_b32 v209, v145
    v_mov_b32 v210, v145
    v_mov_b32 v211, v145
    v_mov_b32 v212, v145
    v_mov_b32 v213, v145
    v_mov_b32 v214, v145
    v_mov_b32 v215, v145
    v_mov_b32 v216, 0
    v_mov_b32 v217, 0
    v_mov_b32 v218, 0
    v_mov_b32 v219, 0
    v_lshrrev_b32 v145, 5, v250
    v_mul_u32_u24 v145, 5120, v145
    v_lshl_add_u32 v220, v144, 4, v145
    v_mov_b32 v32, 0
    v_mov_b32 v33, 0
    v_mov_b32 v34, 0
    v_mov_b32 v35, 0
    v_mov_b32 v36, 0
    v_mov_b32 v37, 0
    v_mov_b32 v38, 0
    v_mov_b32 v39, 0
    v_mov_b32 v40, 0
    v_mov_b32 v41, 0
    v_mov_b32 v42, 0
    v_mov_b32 v43, 0
    v_mov_b32 v44, 0
    v_mov_b32 v45, 0
    v_mov_b32 v46, 0
    v_mov_b32 v47, 0
    v_mov_b32 v48, 0
    v_mov_b32 v49, 0
    v_mov_b32 v50, 0
    v_mov_b32 v51, 0
    v_mov_b32 v52, 0
    v_mov_b32 v53, 0
    v_mov_b32 v54, 0
    v_mov_b32 v55, 0
    v_mov_b32 v56, 0
    v_mov_b32 v57, 0
    v_mov_b32 v58, 0
    v_mov_b32 v59, 0
    v_mov_b32 v60, 0
    v_mov_b32 v61, 0
    v_mov_b32 v62, 0
    v_mov_b32 v63, 0
    v_mov_b32 v72, 0
    v_mov_b32 v73, 0
    v_mov_b32 v74, 0
    v_mov_b32 v75, 0
    v_mov_b32 v132, 0xdddddddd
    s_lshl_b32 s54, s32, 2
    s_add_u32 s55, s54, 163776
    v_mov_b32 v136, s55
    v_mov_b32 v178, 2
    v_mov_b32 v179, 3
    v_mov_b32 v180, 4
    v_mov_b32 v181, 5
    v_mov_b32 v182, 6
    v_mov_b32 v184, 8
    v_mov_b32 v138, 163712
    v_mov_b32 v139, 1
    s_add_u32 s92, s32, 9
    s_mul_i32 s90, s92, 5120
    s_add_u32 s91, s90, s52
    s_mov_b32 s48, 0
    s_mov_b32 s49, 20480
    s_mul_i32 s54, s39, 20
    v_bfe_u32 v144, v250, 4, 1
    v_mul_u32_u24 v144, 19, v144
    v_add_u32 v144, s54, v144
    v_and_b32 v144, 0xff80, v144
    v_lshrrev_b32 v145, 5, v250
    v_mul_u32_u24 v145, 640, v145
    v_and_b32 v146, 15, v250
    v_lshl_add_u32 v145, v146, 3, v145
    v_add_u32 v145, v145, v144
    v_add_u32 v141, 640, v145
    v_lshrrev_b32 v145, 5, v141
    v_mul_u32_u24 v145, 4352, v145
    v_and_b32 v141, 31, v141
    v_add_u32 v141, v141, v145
    v_add_u32 v141, 16777216, v141
    v_and_b32 v146, 1, v250
    v_lshl_add_u32 v144, v146, 3, v144
    s_lshr_b32 s54, s38, 2
    s_lshl_b32 s54, s54, 4
    s_add_u32 s54, s54, 0
    v_add_u32 v142, s54, v144
    v_lshrrev_b32 v145, 5, v142
    v_mul_u32_u24 v145, 4352, v145
    v_and_b32 v142, 31, v142
    v_add_u32 v142, v142, v145
    v_add_u32 v142, 16777216, v142
    v_and_b32 v158, 31, v250
    v_lshlrev_b32 v158, 3, v158
    s_lshl_b32 s54, s37, 8
    s_add_u32 s54, s54, 12288
    v_add_u32 v158, s54, v158
    v_lshrrev_b32 v145, 5, v158
    v_mul_u32_u24 v145, 4352, v145
    v_and_b32 v158, 31, v158
    v_add_u32 v158, v158, v145
    v_add_u32 v158, 16777216, v158
    s_mul_i32 s6, s40, 81920
    s_add_u32 s6, s6, 8060928
    s_lshl_b32 s7, s39, 7
    s_add_u32 s7, s7, s6
    s_add_u32 s7, s7, 16384
    s_lshl_b32 s54, s39, 9
    s_add_u32 s6, s6, s54
    v_bfe_u32 v154, v250, 4, 1
    v_mul_u32_u24 v154, 20480, v154
    v_and_b32 v147, 15, v250
    v_lshl_add_u32 v153, v147, 4, v154
    v_lshlrev_b32 v154, 3, v147
    v_lshrrev_b32 v147, 5, v250
    v_lshl_add_u32 v153, v147, 8, v153
    v_lshrrev_b32 v147, 4, v250
    v_mul_u32_u24 v147, 20480, v147
    v_add_u32 v154, v154, v147
    s_cmp_eq_u32 s61, 0
    s_cbranch_scc1 L_att_np
    s_mov_b32 s30, 0x00070007
    s_mov_b32 s44, 1000000
L_att_pl:
    buffer_load_dwordx2 v[150:151], v142, s[16:19], 0 offen sc1
    buffer_load_dwordx2 v[148:149], v141, s[16:19], 0 offen sc1
    s_waitcnt vmcnt(0)
    v_cmp_eq_u64 vcc, s[42:43], v[150:151]
    v_cmp_eq_u64 s[46:47], s[42:43], v[148:149]
    s_and_b32 s31, s46, s47
    s_and_b32 s31, s31, s30
    s_cmp_eq_u32 s31, s30
    s_cselect_b64 vcc, vcc, 0
    s_cmp_eq_u64 vcc, -1
    s_cbranch_scc1 L_att_pd
    s_sleep 4
    s_sub_u32 s44, s44, 1
    s_cmp_lg_u32 s44, 0
    s_cbranch_scc1 L_att_pl
L_att_pd:
    s_cmp_eq_u64 s[46:47], -1
    s_cselect_b32 s61, 2, 1
    s_setprio 2
    v_mov_b32 v144, 163768
    v_mov_b32 v145, s61
    s_mov_b64 exec, 1
    ds_add_u32 v144, v145
    s_mov_b64 exec, -1
    buffer_load_dwordx4 v[64:67], v135, s[16:19], s57 offen sc1
    s_mov_b32 exec_hi, 0
    buffer_load_dwordx4 v[72:75], v135, s[16:19], s57 offen offset:2048 sc1
    s_not_b64 exec, exec
    buffer_load_dwordx4 v[216:219], v135, s[16:19], s57 offen offset:1536 sc1
    s_mov_b64 exec, -1
    buffer_load_dwordx4 v[68:71], v135, s[16:19], s57 offen offset:1024 sc1
    s_mov_b32 s54, 0
    s_mov_b32 s55, 5
L_lp_first:
    s_mul_i32 s56, s54, 5120
    s_add_u32 s60, s56, s52
    s_add_u32 s54, s54, 1
    s_mov_b32 m0, s56
    s_add_u32 s59, s60, 4096
    buffer_load_dwordx4 v135, s[16:19], s60 offen offset:0 sc1 lds
    buffer_load_dwordx4 v135, s[16:19], s60 offen offset:1024 sc1 lds
    buffer_load_dwordx4 v135, s[16:19], s60 offen offset:2048 sc1 lds
    buffer_load_dwordx4 v135, s[16:19], s60 offen offset:3072 sc1 lds
    s_add_u32 m0, m0, 4096
    s_nop 0
    buffer_load_dwordx4 v135, s[16:19], s59 offen sc1 lds
    s_cmp_lt_u32 s54, s55
    s_cbranch_scc1 L_lp_first
    s_waitcnt vmcnt(10)
    v_mov_b32 v144, 163712
    v_mov_b32 v145, 2
    s_mov_b64 exec, 1
    ds_add_u32 v144, v145
    s_mov_b64 exec, -1
    s_mov_b32 s30, 0x001f001f
    s_and_b32 s31, s46, s47
    s_and_b32 s31, s31, s30
    s_cmp_eq_u32 s31, s30
    s_mov_b32 s55, 9
    s_cbranch_scc1 L_att_p9
    s_waitcnt vmcnt(0)
    v_mov_b32 v144, 163712
    v_mov_b32 v145, 2
    s_mov_b64 exec, 1
    ds_add_u32 v144, v145
    s_mov_b64 exec, -1
    s_mov_b32 s44, 1000000
L_kv_p:
    buffer_load_dwordx2 v[148:149], v141, s[16:19], 0 offen sc1
    s_waitcnt vmcnt(0)
    v_cmp_eq_u64 s[46:47], s[42:43], v[148:149]
    s_and_b32 s31, s46, s47
    s_and_b32 s31, s31, s30
    s_cmp_eq_u32 s31, s30
    s_cbranch_scc1 L_kv_p_d
    s_sleep 4
    s_sub_u32 s44, s44, 1
    s_cmp_lg_u32 s44, 0
    s_cbranch_scc1 L_kv_p
L_kv_p_d:
L_lp_second:
    s_mul_i32 s56, s54, 5120
    s_add_u32 s60, s56, s52
    s_add_u32 s54, s54, 1
    s_mov_b32 m0, s56
    s_add_u32 s59, s60, 4096
    buffer_load_dwordx4 v135, s[16:19], s60 offen offset:0 sc1 lds
    buffer_load_dwordx4 v135, s[16:19], s60 offen offset:1024 sc1 lds
    buffer_load_dwordx4 v135, s[16:19], s60 offen offset:2048 sc1 lds
    buffer_load_dwordx4 v135, s[16:19], s60 offen offset:3072 sc1 lds
    s_add_u32 m0, m0, 4096
    s_nop 0
    buffer_load_dwordx4 v135, s[16:19], s59 offen sc1 lds
    s_cmp_lt_u32 s54, s55
    s_cbranch_scc1 L_lp_second
    s_branch L_att_go
L_att_p9:
    s_mov_b32 s55, 7
L_lp_third:
    s_mul_i32 s56, s54, 5120
    s_add_u32 s60, s56, s52
    s_add_u32 s54, s54, 1
    s_mov_b32 m0, s56
    s_add_u32 s59, s60, 4096
    buffer_load_dwordx4 v135, s[16:19], s60 offen offset:0 sc1 lds
    buffer_load_dwordx4 v135, s[16:19], s60 offen offset:1024 sc1 lds
    buffer_load_dwordx4 v135, s[16:19], s60 offen offset:2048 sc1 lds
    buffer_load_dwordx4 v135, s[16:19], s60 offen offset:3072 sc1 lds
    s_add_u32 m0, m0, 4096
    s_nop 0
    buffer_load_dwordx4 v135, s[16:19], s59 offen sc1 lds
    s_cmp_lt_u32 s54, s55
    s_cbranch_scc1 L_lp_third
    s_waitcnt vmcnt(10)
    v_mov_b32 v144, 163712
    v_mov_b32 v145, 2
    s_mov_b64 exec, 1
    ds_add_u32 v144, v145
    s_mov_b64 exec, -1
    s_mov_b32 s55, 9
    s_branch L_lp_second
L_att_np:
    s_mov_b32 s44, 1000000
    v_mov_b32 v144, 163768
L_lw_27:
    ds_read_b32 v145, v144
    s_waitcnt lgkmcnt(0)
    v_readfirstlane_b32 s45, v145
    s_cmp_ge_u32 s45, 1
    s_cbranch_scc1 L_ld_28
    s_sleep 1
    s_sub_u32 s44, s44, 1
    s_cmp_lg_u32 s44, 0
    s_cbranch_scc1 L_lw_27
L_ld_28:
    s_setprio 2
    s_mov_b32 s61, s45
    buffer_load_dwordx4 v[64:67], v135, s[16:19], s57 offen sc1
    s_mov_b32 exec_hi, 0
    buffer_load_dwordx4 v[72:75], v135, s[16:19], s57 offen offset:2048 sc1
    s_not_b64 exec, exec
    buffer_load_dwordx4 v[216:219], v135, s[16:19], s57 offen offset:1536 sc1
    s_mov_b64 exec, -1
    buffer_load_dwordx4 v[68:71], v135, s[16:19], s57 offen offset:1024 sc1
    s_mov_b32 s44, 1000000
    v_mov_b32 v144, 163712
L_lw_29:
    ds_read_b32 v145, v144
    s_waitcnt lgkmcnt(0)
    v_readfirstlane_b32 s45, v145
    s_cmp_ge_u32 s45, 2
    s_cbranch_scc1 L_ld_30
    s_sub_u32 s44, s44, 1
    s_cmp_lg_u32 s44, 0
    s_cbranch_scc1 L_lw_29
L_ld_30:
    s_waitcnt vmcnt(0)
L_att_go:
    ds_read_b128 v[76:79], v133 offset:0
    ds_read_b128 v[80:83], v133 offset:1024
    ds_read_b128 v[92:95], v133 offset:2048
    s_mov_b64 exec, s[28:29]
    ds_read_b128 v[100:103], v134 offset:2560
    ds_read_b128 v[104:107], v134 offset:3200
    ds_read_b128 v[108:111], v134 offset:3840
    ds_read_b128 v[112:115], v134 offset:4480
    s_mov_b64 exec, -1
    s_waitcnt lgkmcnt(0)
    v_mfma_f32_32x32x16_bf16 v[0:15], v[76:79], v[64:67], 0
    v_mfma_f32_32x32x8_bf16 v[0:15], v[92:93], v[72:73], v[0:15]
    s_nop 11
    v_exp_f32 v0, v0
    v_exp_f32 v1, v1
    v_exp_f32 v2, v2
    v_exp_f32 v3, v3
    v_exp_f32 v4, v4
    v_mfma_f32_32x32x16_bf16 v[16:31], v[76:79], v[68:71], 0
    ds_read_b128 v[84:87], v133 offset:5120
    ds_read_b128 v[88:91], v133 offset:6144
    ds_read_b128 v[188:191], v133 offset:10240
    ds_read_b128 v[192:195], v133 offset:11264
    ds_read_b128 v[96:99], v220 offset:7168
    v_exp_f32 v5, v5
    v_exp_f32 v6, v6
    v_exp_f32 v7, v7
    v_exp_f32 v8, v8
    v_mfma_f32_32x32x8_bf16 v[16:31], v[92:93], v[74:75], v[16:31]
    v_exp_f32 v9, v9
    v_exp_f32 v10, v10
    v_exp_f32 v11, v11
    v_exp_f32 v12, v12
    v_smfmac_f32_32x32x32_bf16 v[32:47], v[100:103], v[0:7], v132
    s_mov_b64 exec, s[28:29]
    ds_read_b128 v[116:119], v134 offset:7680
    ds_read_b128 v[120:123], v134 offset:8320
    ds_read_b128 v[124:127], v134 offset:8960
    ds_read_b128 v[128:131], v134 offset:9600
    ds_read_b128 v[200:203], v134 offset:12800
    ds_read_b128 v[204:207], v134 offset:13440
    ds_read_b128 v[208:211], v134 offset:14080
    ds_read_b128 v[212:215], v134 offset:14720
    s_mov_b64 exec, -1
    v_exp_f32 v13, v13
    v_exp_f32 v14, v14
    v_exp_f32 v15, v15
    v_exp_f32 v16, v16
    v_exp_f32 v17, v17
    v_smfmac_f32_32x32x32_bf16 v[32:47], v[104:107], v[8:15], v132
    s_cmp_lt_u32 s61, 2
    s_cbranch_scc1 L_att_fl0
L_att_flr0:
    v_exp_f32 v18, v18
    v_exp_f32 v19, v19
    v_exp_f32 v20, v20
    v_mfma_f32_32x32x16_bf16 v[0:15], v[80:83], v[64:67], 0
    v_exp_f32 v21, v21
    v_exp_f32 v22, v22
    v_exp_f32 v23, v23
    v_exp_f32 v24, v24
    v_mfma_f32_32x32x8_bf16 v[0:15], v[94:95], v[72:73], v[0:15]
    v_exp_f32 v25, v25
    v_exp_f32 v26, v26
    v_exp_f32 v27, v27
    v_exp_f32 v28, v28
    v_smfmac_f32_32x32x32_bf16 v[48:63], v[100:103], v[16:23], v132
    v_exp_f32 v29, v29
    v_exp_f32 v30, v30
    v_exp_f32 v31, v31
    v_exp_f32 v0, v0
    v_exp_f32 v1, v1
    v_smfmac_f32_32x32x32_bf16 v[48:63], v[104:107], v[24:31], v132
    v_exp_f32 v2, v2
    v_exp_f32 v3, v3
    v_exp_f32 v4, v4
    v_mfma_f32_32x32x16_bf16 v[16:31], v[80:83], v[68:71], 0
    ds_read_b32 v140, v138
    v_exp_f32 v5, v5
    v_exp_f32 v6, v6
    v_exp_f32 v7, v7
    v_exp_f32 v8, v8
    v_mfma_f32_32x32x8_bf16 v[16:31], v[94:95], v[74:75], v[16:31]
    v_exp_f32 v9, v9
    v_exp_f32 v10, v10
    v_exp_f32 v11, v11
    v_exp_f32 v12, v12
    v_smfmac_f32_32x32x32_bf16 v[32:47], v[108:111], v[0:7], v132
    v_exp_f32 v13, v13
    v_exp_f32 v14, v14
    v_exp_f32 v15, v15
    v_exp_f32 v16, v16
    v_exp_f32 v17, v17
    v_smfmac_f32_32x32x32_bf16 v[32:47], v[112:115], v[8:15], v132
    s_waitcnt lgkmcnt(0)
    v_exp_f32 v18, v18
    v_exp_f32 v19, v19
    v_exp_f32 v20, v20
    v_mfma_f32_32x32x16_bf16 v[0:15], v[84:87], v[64:67], 0
    v_exp_f32 v21, v21
    v_exp_f32 v22, v22
    v_exp_f32 v23, v23
    v_exp_f32 v24, v24
    v_mfma_f32_32x32x8_bf16 v[0:15], v[96:97], v[72:73], v[0:15]
    v_exp_f32 v25, v25
    v_exp_f32 v26, v26
    v_exp_f32 v27, v27
    v_exp_f32 v28, v28
    v_smfmac_f32_32x32x32_bf16 v[48:63], v[108:111], v[16:23], v132
    v_exp_f32 v29, v29
    v_exp_f32 v30, v30
    v_exp_f32 v31, v31
    v_exp_f32 v0, v0
    v_exp_f32 v1, v1
    v_smfmac_f32_32x32x32_bf16 v[48:63], v[112:115], v[24:31], v132
    v_exp_f32 v2, v2
    v_exp_f32 v3, v3
    v_exp_f32 v4, v4
    v_mfma_f32_32x32x16_bf16 v[16:31], v[84:87], v[68:71], 0
    v_exp_f32 v5, v5
    v_exp_f32 v6, v6
    v_exp_f32 v7, v7
    v_exp_f32 v8, v8
    v_mfma_f32_32x32x8_bf16 v[16:31], v[96:97], v[74:75], v[16:31]
    v_exp_f32 v9, v9
    v_exp_f32 v10, v10
    v_exp_f32 v11, v11
    v_exp_f32 v12, v12
    v_smfmac_f32_32x32x32_bf16 v[32:47], v[116:119], v[0:7], v132
    s_waitcnt vmcnt(0)
    s_mov_b64 exec, 1
    ds_add_u32 v138, v139 offset:4
    s_mov_b64 exec, -1
    v_exp_f32 v13, v13
    v_exp_f32 v14, v14
    v_exp_f32 v15, v15
    v_exp_f32 v16, v16
    v_exp_f32 v17, v17
    v_smfmac_f32_32x32x32_bf16 v[32:47], v[120:123], v[8:15], v132
    s_cmp_lt_u32 s61, 2
    s_cbranch_scc1 L_att_ft0
L_att_ftr0:
    v_exp_f32 v18, v18
    v_exp_f32 v19, v19
    v_exp_f32 v20, v20
    v_mfma_f32_32x32x16_bf16 v[0:15], v[88:91], v[64:67], 0
    v_exp_f32 v21, v21
    v_exp_f32 v22, v22
    v_exp_f32 v23, v23
    v_exp_f32 v24, v24
    v_mfma_f32_32x32x8_bf16 v[0:15], v[98:99], v[72:73], v[0:15]
    v_exp_f32 v25, v25
    v_exp_f32 v26, v26
    v_exp_f32 v27, v27
    v_exp_f32 v28, v28
    v_smfmac_f32_32x32x32_bf16 v[48:63], v[116:119], v[16:23], v132
    s_mov_b32 m0, s90
    v_exp_f32 v29, v29
    v_exp_f32 v30, v30
    v_exp_f32 v31, v31
    v_exp_f32 v0, v0
    v_exp_f32 v1, v1
    v_smfmac_f32_32x32x32_bf16 v[48:63], v[120:123], v[24:31], v132
    v_exp_f32 v2, v2
    v_exp_f32 v3, v3
    v_readfirstlane_b32 s54, v140
    v_exp_f32 v4, v4
    v_mfma_f32_32x32x16_bf16 v[16:31], v[88:91], v[68:71], 0
    buffer_load_dwordx4 v135, s[16:19], s91 offen offset:0 sc1 lds
    v_exp_f32 v5, v5
    v_exp_f32 v6, v6
    v_exp_f32 v7, v7
    v_exp_f32 v8, v8
    v_mfma_f32_32x32x8_bf16 v[16:31], v[98:99], v[74:75], v[16:31]
    v_exp_f32 v9, v9
    v_exp_f32 v10, v10
    v_exp_f32 v11, v11
    v_exp_f32 v12, v12
    v_smfmac_f32_32x32x32_bf16 v[32:47], v[124:127], v[0:7], v132
    v_exp_f32 v13, v13
    v_exp_f32 v14, v14
    v_exp_f32 v15, v15
    v_exp_f32 v16, v16
    v_exp_f32 v17, v17
    v_smfmac_f32_32x32x32_bf16 v[32:47], v[128:131], v[8:15], v132
    s_cmp_lt_u32 s54, 4
    s_cbranch_scc1 L_att_c0
L_att_c0r:
    v_exp_f32 v18, v18
    v_exp_f32 v19, v19
    v_exp_f32 v20, v20
    v_mfma_f32_32x32x16_bf16 v[0:15], v[188:191], v[64:67], 0
    buffer_load_dwordx4 v135, s[16:19], s91 offen offset:1024 sc1 lds
    v_exp_f32 v21, v21
    v_exp_f32 v22, v22
    v_exp_f32 v23, v23
    v_exp_f32 v24, v24
    v_mfma_f32_32x32x8_bf16 v[0:15], v[96:97], v[216:217], v[0:15]
    v_exp_f32 v25, v25
    v_exp_f32 v26, v26
    v_exp_f32 v27, v27
    v_exp_f32 v28, v28
    v_smfmac_f32_32x32x32_bf16 v[48:63], v[124:127], v[16:23], v132
    v_exp_f32 v29, v29
    v_exp_f32 v30, v30
    v_exp_f32 v31, v31
    v_exp_f32 v0, v0
    v_exp_f32 v1, v1
    v_smfmac_f32_32x32x32_bf16 v[48:63], v[128:131], v[24:31], v132
    v_exp_f32 v2, v2
    v_exp_f32 v3, v3
    v_exp_f32 v4, v4
    v_mfma_f32_32x32x16_bf16 v[16:31], v[188:191], v[68:71], 0
    ds_read_b128 v[76:79], v133 offset:15360
    ds_read_b128 v[80:83], v133 offset:16384
    ds_read_b128 v[84:87], v133 offset:20480
    ds_read_b128 v[88:91], v133 offset:21504
    ds_read_b128 v[196:199], v220 offset:17408
    v_exp_f32 v5, v5
    v_exp_f32 v6, v6
    v_exp_f32 v7, v7
    v_exp_f32 v8, v8
    v_mfma_f32_32x32x8_bf16 v[16:31], v[96:97], v[218:219], v[16:31]
    v_exp_f32 v9, v9
    v_exp_f32 v10, v10
    v_exp_f32 v11, v11
    v_exp_f32 v12, v12
    v_smfmac_f32_32x32x32_bf16 v[32:47], v[200:203], v[0:7], v132
    s_mov_b64 exec, s[28:29]
    ds_read_b128 v[100:103], v134 offset:17920
    ds_read_b128 v[104:107], v134 offset:18560
    ds_read_b128 v[108:111], v134 offset:19200
    ds_read_b128 v[112:115], v134 offset:19840
    ds_read_b128 v[116:119], v134 offset:23040
    ds_read_b128 v[120:123], v134 offset:23680
    ds_read_b128 v[124:127], v134 offset:24320
    ds_read_b128 v[128:131], v134 offset:24960
    s_mov_b64 exec, -1
    v_exp_f32 v13, v13
    v_exp_f32 v14, v14
    v_exp_f32 v15, v15
    v_exp_f32 v16, v16
    v_exp_f32 v17, v17
    v_smfmac_f32_32x32x32_bf16 v[32:47], v[204:207], v[8:15], v132
    v_exp_f32 v18, v18
    v_exp_f32 v19, v19
    v_exp_f32 v20, v20
    v_mfma_f32_32x32x16_bf16 v[0:15], v[192:195], v[64:67], 0
    buffer_load_dwordx4 v135, s[16:19], s91 offen offset:2048 sc1 lds
    v_exp_f32 v21, v21
    v_exp_f32 v22, v22
    v_exp_f32 v23, v23
    v_exp_f32 v24, v24
    v_mfma_f32_32x32x8_bf16 v[0:15], v[98:99], v[216:217], v[0:15]
    v_exp_f32 v25, v25
    v_exp_f32 v26, v26
    v_exp_f32 v27, v27
    v_exp_f32 v28, v28
    v_smfmac_f32_32x32x32_bf16 v[48:63], v[200:203], v[16:23], v132
    v_exp_f32 v29, v29
    v_exp_f32 v30, v30
    v_exp_f32 v31, v31
    v_exp_f32 v0, v0
    v_exp_f32 v1, v1
    v_smfmac_f32_32x32x32_bf16 v[48:63], v[204:207], v[24:31], v132
    v_exp_f32 v2, v2
    v_exp_f32 v3, v3
    v_exp_f32 v4, v4
    v_mfma_f32_32x32x16_bf16 v[16:31], v[192:195], v[68:71], 0
    ds_read_b32 v140, v138 offset:4
    v_exp_f32 v5, v5
    v_exp_f32 v6, v6
    v_exp_f32 v7, v7
    v_exp_f32 v8, v8
    v_mfma_f32_32x32x8_bf16 v[16:31], v[98:99], v[218:219], v[16:31]
    v_exp_f32 v9, v9
    v_exp_f32 v10, v10
    v_exp_f32 v11, v11
    v_exp_f32 v12, v12
    v_smfmac_f32_32x32x32_bf16 v[32:47], v[208:211], v[0:7], v132
    v_exp_f32 v13, v13
    v_exp_f32 v14, v14
    v_exp_f32 v15, v15
    v_exp_f32 v16, v16
    v_exp_f32 v17, v17
    v_smfmac_f32_32x32x32_bf16 v[32:47], v[212:215], v[8:15], v132
    s_waitcnt lgkmcnt(0)
    v_exp_f32 v18, v18
    v_exp_f32 v19, v19
    v_exp_f32 v20, v20
    v_mfma_f32_32x32x16_bf16 v[0:15], v[76:79], v[64:67], 0
    buffer_load_dwordx4 v135, s[16:19], s91 offen offset:3072 sc1 lds
    v_exp_f32 v21, v21
    v_exp_f32 v22, v22
    v_exp_f32 v23, v23
    v_exp_f32 v24, v24
    v_mfma_f32_32x32x8_bf16 v[0:15], v[196:197], v[72:73], v[0:15]
    v_exp_f32 v25, v25
    v_exp_f32 v26, v26
    v_exp_f32 v27, v27
    v_exp_f32 v28, v28
    v_smfmac_f32_32x32x32_bf16 v[48:63], v[208:211], v[16:23], v132
    s_add_u32 m0, m0, 4096
    s_add_u32 s91, s91, 4096
    v_exp_f32 v29, v29
    v_exp_f32 v30, v30
    v_exp_f32 v31, v31
    v_exp_f32 v0, v0
    v_exp_f32 v1, v1
    v_smfmac_f32_32x32x32_bf16 v[48:63], v[212:215], v[24:31], v132
    v_exp_f32 v2, v2
    v_exp_f32 v3, v3
    v_exp_f32 v4, v4
    v_mfma_f32_32x32x16_bf16 v[16:31], v[76:79], v[68:71], 0
    buffer_load_dwordx4 v135, s[16:19], s91 offen sc1 lds
    v_exp_f32 v5, v5
    v_exp_f32 v6, v6
    v_exp_f32 v7, v7
    v_exp_f32 v8, v8
    v_mfma_f32_32x32x8_bf16 v[16:31], v[196:197], v[74:75], v[16:31]
    v_exp_f32 v9, v9
    v_exp_f32 v10, v10
    v_exp_f32 v11, v11
    v_exp_f32 v12, v12
    v_smfmac_f32_32x32x32_bf16 v[32:47], v[100:103], v[0:7], v132
    v_exp_f32 v13, v13
    v_exp_f32 v14, v14
    v_exp_f32 v15, v15
    v_exp_f32 v16, v16
    v_exp_f32 v17, v17
    v_smfmac_f32_32x32x32_bf16 v[32:47], v[104:107], v[8:15], v132
    s_add_u32 s90, s90, 20480
    s_add_u32 s91, s91, 16384
    v_exp_f32 v18, v18
    v_exp_f32 v19, v19
    v_exp_f32 v20, v20
    v_mfma_f32_32x32x16_bf16 v[0:15], v[80:83], v[64:67], 0
    v_exp_f32 v21, v21
    v_exp_f32 v22, v22
    v_exp_f32 v23, v23
    v_exp_f32 v24, v24
    v_mfma_f32_32x32x8_bf16 v[0:15], v[198:199], v[72:73], v[0:15]
    v_exp_f32 v25, v25
    v_exp_f32 v26, v26
    v_exp_f32 v27, v27
    v_exp_f32 v28, v28
    v_smfmac_f32_32x32x32_bf16 v[48:63], v[100:103], v[16:23], v132
    v_exp_f32 v29, v29
    v_exp_f32 v30, v30
    v_exp_f32 v31, v31
    v_exp_f32 v0, v0
    v_exp_f32 v1, v1
    v_smfmac_f32_32x32x32_bf16 v[48:63], v[104:107], v[24:31], v132
    v_exp_f32 v2, v2
    v_exp_f32 v3, v3
    v_readfirstlane_b32 s54, v140
    v_exp_f32 v4, v4
    v_mfma_f32_32x32x16_bf16 v[16:31], v[80:83], v[68:71], 0
    v_exp_f32 v5, v5
    v_exp_f32 v6, v6
    v_exp_f32 v7, v7
    v_exp_f32 v8, v8
    v_mfma_f32_32x32x8_bf16 v[16:31], v[198:199], v[74:75], v[16:31]
    v_exp_f32 v9, v9
    v_exp_f32 v10, v10
    v_exp_f32 v11, v11
    v_exp_f32 v12, v12
    v_smfmac_f32_32x32x32_bf16 v[32:47], v[108:111], v[0:7], v132
    v_exp_f32 v13, v13
    v_exp_f32 v14, v14
    v_exp_f32 v15, v15
    v_exp_f32 v16, v16
    v_exp_f32 v17, v17
    v_smfmac_f32_32x32x32_bf16 v[32:47], v[112:115], v[8:15], v132
    v_exp_f32 v18, v18
    v_exp_f32 v19, v19
    v_exp_f32 v20, v20
    v_mfma_f32_32x32x16_bf16 v[0:15], v[84:87], v[64:67], 0
    v_exp_f32 v21, v21
    v_exp_f32 v22, v22
    v_exp_f32 v23, v23
    v_exp_f32 v24, v24
    v_mfma_f32_32x32x8_bf16 v[0:15], v[196:197], v[216:217], v[0:15]
    v_exp_f32 v25, v25
    v_exp_f32 v26, v26
    v_exp_f32 v27, v27
    v_exp_f32 v28, v28
    v_smfmac_f32_32x32x32_bf16 v[48:63], v[108:111], v[16:23], v132
    s_cmp_lt_u32 s54, 4
    s_cbranch_scc1 L_att_nr0
L_att_nrr0:
    v_exp_f32 v29, v29
    v_exp_f32 v30, v30
    v_exp_f32 v31, v31
    v_exp_f32 v0, v0
    v_exp_f32 v1, v1
    v_smfmac_f32_32x32x32_bf16 v[48:63], v[112:115], v[24:31], v132
    v_exp_f32 v2, v2
    v_exp_f32 v3, v3
    v_exp_f32 v4, v4
    v_mfma_f32_32x32x16_bf16 v[16:31], v[84:87], v[68:71], 0
    ds_read_b128 v[188:191], v133 offset:25600
    ds_read_b128 v[192:195], v133 offset:26624
    ds_read_b128 v[76:79], v133 offset:30720
    ds_read_b128 v[80:83], v133 offset:31744
    ds_read_b128 v[92:95], v220 offset:27648
    v_exp_f32 v5, v5
    v_exp_f32 v6, v6
    v_exp_f32 v7, v7
    v_exp_f32 v8, v8
    v_mfma_f32_32x32x8_bf16 v[16:31], v[196:197], v[218:219], v[16:31]
    v_exp_f32 v9, v9
    v_exp_f32 v10, v10
    v_exp_f32 v11, v11
    v_exp_f32 v12, v12
    v_smfmac_f32_32x32x32_bf16 v[32:47], v[116:119], v[0:7], v132
    s_mov_b64 exec, s[28:29]
    ds_read_b128 v[200:203], v134 offset:28160
    ds_read_b128 v[204:207], v134 offset:28800
    ds_read_b128 v[208:211], v134 offset:29440
    ds_read_b128 v[212:215], v134 offset:30080
    ds_read_b128 v[100:103], v134 offset:33280
    ds_read_b128 v[104:107], v134 offset:33920
    ds_read_b128 v[108:111], v134 offset:34560
    ds_read_b128 v[112:115], v134 offset:35200
    s_mov_b64 exec, -1
    v_exp_f32 v13, v13
    v_exp_f32 v14, v14
    v_exp_f32 v15, v15
    v_exp_f32 v16, v16
    v_exp_f32 v17, v17
    v_smfmac_f32_32x32x32_bf16 v[32:47], v[120:123], v[8:15], v132
    s_cmp_lt_u32 s61, 2
    s_cbranch_scc1 L_att_fl1
L_att_flr1:
    v_exp_f32 v18, v18
    v_exp_f32 v19, v19
    v_exp_f32 v20, v20
    v_mfma_f32_32x32x16_bf16 v[0:15], v[88:91], v[64:67], 0
    v_exp_f32 v21, v21
    v_exp_f32 v22, v22
    v_exp_f32 v23, v23
    v_exp_f32 v24, v24
    v_mfma_f32_32x32x8_bf16 v[0:15], v[198:199], v[216:217], v[0:15]
    v_exp_f32 v25, v25
    v_exp_f32 v26, v26
    v_exp_f32 v27, v27
    v_exp_f32 v28, v28
    v_smfmac_f32_32x32x32_bf16 v[48:63], v[116:119], v[16:23], v132
    v_exp_f32 v29, v29
    v_exp_f32 v30, v30
    v_exp_f32 v31, v31
    v_exp_f32 v0, v0
    v_exp_f32 v1, v1
    v_smfmac_f32_32x32x32_bf16 v[48:63], v[120:123], v[24:31], v132
    v_exp_f32 v2, v2
    v_exp_f32 v3, v3
    v_exp_f32 v4, v4
    v_mfma_f32_32x32x16_bf16 v[16:31], v[88:91], v[68:71], 0
    v_exp_f32 v5, v5
    v_exp_f32 v6, v6
    v_exp_f32 v7, v7
    v_exp_f32 v8, v8
    v_mfma_f32_32x32x8_bf16 v[16:31], v[198:199], v[218:219], v[16:31]
    v_exp_f32 v9, v9
    v_exp_f32 v10, v10
    v_exp_f32 v11, v11
    v_exp_f32 v12, v12
    v_smfmac_f32_32x32x32_bf16 v[32:47], v[124:127], v[0:7], v132
    s_waitcnt vmcnt(0)
    s_mov_b64 exec, 1
    ds_add_u32 v138, v139 offset:8
    s_mov_b64 exec, -1
    v_exp_f32 v13, v13
    v_exp_f32 v14, v14
    v_exp_f32 v15, v15
    v_exp_f32 v16, v16
    v_exp_f32 v17, v17
    v_smfmac_f32_32x32x32_bf16 v[32:47], v[128:131], v[8:15], v132
    s_waitcnt lgkmcnt(0)
    v_exp_f32 v18, v18
    v_exp_f32 v19, v19
    v_exp_f32 v20, v20
    v_mfma_f32_32x32x16_bf16 v[0:15], v[188:191], v[64:67], 0
    v_exp_f32 v21, v21
    v_exp_f32 v22, v22
    v_exp_f32 v23, v23
    v_exp_f32 v24, v24
    v_mfma_f32_32x32x8_bf16 v[0:15], v[92:93], v[72:73], v[0:15]
    v_exp_f32 v25, v25
    v_exp_f32 v26, v26
    v_exp_f32 v27, v27
    v_exp_f32 v28, v28
    v_smfmac_f32_32x32x32_bf16 v[48:63], v[124:127], v[16:23], v132
    v_exp_f32 v29, v29
    v_exp_f32 v30, v30
    v_exp_f32 v31, v31
    v_exp_f32 v0, v0
    v_exp_f32 v1, v1
    v_smfmac_f32_32x32x32_bf16 v[48:63], v[128:131], v[24:31], v132
    v_exp_f32 v2, v2
    v_exp_f32 v3, v3
    v_exp_f32 v4, v4
    v_mfma_f32_32x32x16_bf16 v[16:31], v[188:191], v[68:71], 0
    v_exp_f32 v5, v5
    v_exp_f32 v6, v6
    v_exp_f32 v7, v7
    v_exp_f32 v8, v8
    v_mfma_f32_32x32x8_bf16 v[16:31], v[92:93], v[74:75], v[16:31]
    v_exp_f32 v9, v9
    v_exp_f32 v10, v10
    v_exp_f32 v11, v11
    v_exp_f32 v12, v12
    v_smfmac_f32_32x32x32_bf16 v[32:47], v[200:203], v[0:7], v132
    v_exp_f32 v13, v13
    v_exp_f32 v14, v14
    v_exp_f32 v15, v15
    v_exp_f32 v16, v16
    v_exp_f32 v17, v17
    v_smfmac_f32_32x32x32_bf16 v[32:47], v[204:207], v[8:15], v132
    s_cmp_lt_u32 s61, 2
    s_cbranch_scc1 L_att_ft1
L_att_ftr1:
    v_exp_f32 v18, v18
    v_exp_f32 v19, v19
    v_exp_f32 v20, v20
    v_mfma_f32_32x32x16_bf16 v[0:15], v[192:195], v[64:67], 0
    v_exp_f32 v21, v21
    v_exp_f32 v22, v22
    v_exp_f32 v23, v23
    v_exp_f32 v24, v24
    v_mfma_f32_32x32x8_bf16 v[0:15], v[94:95], v[72:73], v[0:15]
    v_exp_f32 v25, v25
    v_exp_f32 v26, v26
    v_exp_f32 v27, v27
    v_exp_f32 v28, v28
    v_smfmac_f32_32x32x32_bf16 v[48:63], v[200:203], v[16:23], v132
    s_mov_b32 m0, s90
    v_exp_f32 v29, v29
    v_exp_f32 v30, v30
    v_exp_f32 v31, v31
    v_exp_f32 v0, v0
    v_exp_f32 v1, v1
    v_smfmac_f32_32x32x32_bf16 v[48:63], v[204:207], v[24:31], v132
    v_exp_f32 v2, v2
    v_exp_f32 v3, v3
    v_exp_f32 v4, v4
    v_mfma_f32_32x32x16_bf16 v[16:31], v[192:195], v[68:71], 0
    buffer_load_dwordx4 v135, s[16:19], s91 offen offset:0 sc1 lds
    v_exp_f32 v5, v5
    v_exp_f32 v6, v6
    v_exp_f32 v7, v7
    v_exp_f32 v8, v8
    v_mfma_f32_32x32x8_bf16 v[16:31], v[94:95], v[74:75], v[16:31]
    v_exp_f32 v9, v9
    v_exp_f32 v10, v10
    v_exp_f32 v11, v11
    v_exp_f32 v12, v12
    v_smfmac_f32_32x32x32_bf16 v[32:47], v[208:211], v[0:7], v132
    v_exp_f32 v13, v13
    v_exp_f32 v14, v14
    v_exp_f32 v15, v15
    v_exp_f32 v16, v16
    v_exp_f32 v17, v17
    v_smfmac_f32_32x32x32_bf16 v[32:47], v[212:215], v[8:15], v132
    v_exp_f32 v18, v18
    v_exp_f32 v19, v19
    v_exp_f32 v20, v20
    v_mfma_f32_32x32x16_bf16 v[0:15], v[76:79], v[64:67], 0
    buffer_load_dwordx4 v135, s[16:19], s91 offen offset:1024 sc1 lds
    v_exp_f32 v21, v21
    v_exp_f32 v22, v22
    v_exp_f32 v23, v23
    v_exp_f32 v24, v24
    v_mfma_f32_32x32x8_bf16 v[0:15], v[92:93], v[216:217], v[0:15]
    v_exp_f32 v25, v25
    v_exp_f32 v26, v26
    v_exp_f32 v27, v27
    v_exp_f32 v28, v28
    v_smfmac_f32_32x32x32_bf16 v[48:63], v[208:211], v[16:23], v132
    v_exp_f32 v29, v29
    v_exp_f32 v30, v30
    v_exp_f32 v31, v31
    v_exp_f32 v0, v0
    v_exp_f32 v1, v1
    v_smfmac_f32_32x32x32_bf16 v[48:63], v[212:215], v[24:31], v132
    v_exp_f32 v2, v2
    v_exp_f32 v3, v3
    v_exp_f32 v4, v4
    v_mfma_f32_32x32x16_bf16 v[16:31], v[76:79], v[68:71], 0
    ds_read_b128 v[84:87], v133 offset:35840
    ds_read_b128 v[88:91], v133 offset:36864
    ds_read_b128 v[188:191], v133 offset:40960
    ds_read_b128 v[192:195], v133 offset:41984
    ds_read_b128 v[96:99], v220 offset:37888
    v_exp_f32 v5, v5
    v_exp_f32 v6, v6
    v_exp_f32 v7, v7
    v_exp_f32 v8, v8
    v_mfma_f32_32x32x8_bf16 v[16:31], v[92:93], v[218:219], v[16:31]
    v_exp_f32 v9, v9
    v_exp_f32 v10, v10
    v_exp_f32 v11, v11
    v_exp_f32 v12, v12
    v_smfmac_f32_32x32x32_bf16 v[32:47], v[100:103], v[0:7], v132
    s_mov_b64 exec, s[28:29]
    ds_read_b128 v[116:119], v134 offset:38400
    ds_read_b128 v[120:123], v134 offset:39040
    ds_read_b128 v[124:127], v134 offset:39680
    ds_read_b128 v[128:131], v134 offset:40320
    ds_read_b128 v[200:203], v134 offset:43520
    ds_read_b128 v[204:207], v134 offset:44160
    ds_read_b128 v[208:211], v134 offset:44800
    ds_read_b128 v[212:215], v134 offset:45440
    s_mov_b64 exec, -1
    v_exp_f32 v13, v13
    v_exp_f32 v14, v14
    v_exp_f32 v15, v15
    v_exp_f32 v16, v16
    v_exp_f32 v17, v17
    v_smfmac_f32_32x32x32_bf16 v[32:47], v[104:107], v[8:15], v132
    v_exp_f32 v18, v18
    v_exp_f32 v19, v19
    v_exp_f32 v20, v20
    v_mfma_f32_32x32x16_bf16 v[0:15], v[80:83], v[64:67], 0
    buffer_load_dwordx4 v135, s[16:19], s91 offen offset:2048 sc1 lds
    v_exp_f32 v21, v21
    v_exp_f32 v22, v22
    v_exp_f32 v23, v23
    v_exp_f32 v24, v24
    v_mfma_f32_32x32x8_bf16 v[0:15], v[94:95], v[216:217], v[0:15]
    v_exp_f32 v25, v25
    v_exp_f32 v26, v26
    v_exp_f32 v27, v27
    v_exp_f32 v28, v28
    v_smfmac_f32_32x32x32_bf16 v[48:63], v[100:103], v[16:23], v132
    v_exp_f32 v29, v29
    v_exp_f32 v30, v30
    v_exp_f32 v31, v31
    v_exp_f32 v0, v0
    v_exp_f32 v1, v1
    v_smfmac_f32_32x32x32_bf16 v[48:63], v[104:107], v[24:31], v132
    v_exp_f32 v2, v2
    v_exp_f32 v3, v3
    v_exp_f32 v4, v4
    v_mfma_f32_32x32x16_bf16 v[16:31], v[80:83], v[68:71], 0
    ds_read_b32 v140, v138 offset:8
    v_exp_f32 v5, v5
    v_exp_f32 v6, v6
    v_exp_f32 v7, v7
    v_exp_f32 v8, v8
    v_mfma_f32_32x32x8_bf16 v[16:31], v[94:95], v[218:219], v[16:31]
    v_exp_f32 v9, v9
    v_exp_f32 v10, v10
    v_exp_f32 v11, v11
    v_exp_f32 v12, v12
    v_smfmac_f32_32x32x32_bf16 v[32:47], v[108:111], v[0:7], v132
    v_exp_f32 v13, v13
    v_exp_f32 v14, v14
    v_exp_f32 v15, v15
    v_exp_f32 v16, v16
    v_exp_f32 v17, v17
    v_smfmac_f32_32x32x32_bf16 v[32:47], v[112:115], v[8:15], v132
    s_waitcnt lgkmcnt(0)
    v_exp_f32 v18, v18
    v_exp_f32 v19, v19
    v_exp_f32 v20, v20
    v_mfma_f32_32x32x16_bf16 v[0:15], v[84:87], v[64:67], 0
    buffer_load_dwordx4 v135, s[16:19], s91 offen offset:3072 sc1 lds
    v_exp_f32 v21, v21
    v_exp_f32 v22, v22
    v_exp_f32 v23, v23
    v_exp_f32 v24, v24
    v_mfma_f32_32x32x8_bf16 v[0:15], v[96:97], v[72:73], v[0:15]
    v_exp_f32 v25, v25
    v_exp_f32 v26, v26
    v_exp_f32 v27, v27
    v_exp_f32 v28, v28
    v_smfmac_f32_32x32x32_bf16 v[48:63], v[108:111], v[16:23], v132
    s_add_u32 m0, m0, 4096
    s_add_u32 s91, s91, 4096
    v_exp_f32 v29, v29
    v_exp_f32 v30, v30
    v_exp_f32 v31, v31
    v_exp_f32 v0, v0
    v_exp_f32 v1, v1
    v_smfmac_f32_32x32x32_bf16 v[48:63], v[112:115], v[24:31], v132
    v_exp_f32 v2, v2
    v_exp_f32 v3, v3
    v_exp_f32 v4, v4
    v_mfma_f32_32x32x16_bf16 v[16:31], v[84:87], v[68:71], 0
    buffer_load_dwordx4 v135, s[16:19], s91 offen sc1 lds
    v_exp_f32 v5, v5
    v_exp_f32 v6, v6
    v_exp_f32 v7, v7
    v_exp_f32 v8, v8
    v_mfma_f32_32x32x8_bf16 v[16:31], v[96:97], v[74:75], v[16:31]
    v_exp_f32 v9, v9
    v_exp_f32 v10, v10
    v_exp_f32 v11, v11
    v_exp_f32 v12, v12
    v_smfmac_f32_32x32x32_bf16 v[32:47], v[116:119], v[0:7], v132
    v_exp_f32 v13, v13
    v_exp_f32 v14, v14
    v_exp_f32 v15, v15
    v_exp_f32 v16, v16
    v_exp_f32 v17, v17
    v_smfmac_f32_32x32x32_bf16 v[32:47], v[120:123], v[8:15], v132
    v_exp_f32 v18, v18
    v_exp_f32 v19, v19
    v_exp_f32 v20, v20
    v_mfma_f32_32x32x16_bf16 v[0:15], v[88:91], v[64:67], 0
    v_exp_f32 v21, v21
    v_exp_f32 v22, v22
    v_exp_f32 v23, v23
    v_exp_f32 v24, v24
    v_mfma_f32_32x32x8_bf16 v[0:15], v[98:99], v[72:73], v[0:15]
    v_exp_f32 v25, v25
    v_exp_f32 v26, v26
    v_exp_f32 v27, v27
    v_exp_f32 v28, v28
    v_smfmac_f32_32x32x32_bf16 v[48:63], v[116:119], v[16:23], v132
    v_exp_f32 v29, v29
    v_exp_f32 v30, v30
    v_exp_f32 v31, v31
    v_exp_f32 v0, v0
    v_exp_f32 v1, v1
    v_smfmac_f32_32x32x32_bf16 v[48:63], v[120:123], v[24:31], v132
    v_exp_f32 v2, v2
    v_exp_f32 v3, v3
    v_readfirstlane_b32 s54, v140
    v_exp_f32 v4, v4
    v_mfma_f32_32x32x16_bf16 v[16:31], v[88:91], v[68:71], 0
    v_exp_f32 v5, v5
    v_exp_f32 v6, v6
    v_exp_f32 v7, v7
    v_exp_f32 v8, v8
    v_mfma_f32_32x32x8_bf16 v[16:31], v[98:99], v[74:75], v[16:31]
    v_exp_f32 v9, v9
    v_exp_f32 v10, v10
    v_exp_f32 v11, v11
    v_exp_f32 v12, v12
    v_smfmac_f32_32x32x32_bf16 v[32:47], v[124:127], v[0:7], v132
    v_exp_f32 v13, v13
    v_exp_f32 v14, v14
    v_exp_f32 v15, v15
    v_exp_f32 v16, v16
    v_exp_f32 v17, v17
    v_smfmac_f32_32x32x32_bf16 v[32:47], v[128:131], v[8:15], v132
    v_exp_f32 v18, v18
    v_exp_f32 v19, v19
    v_exp_f32 v20, v20
    v_mfma_f32_32x32x16_bf16 v[0:15], v[188:191], v[64:67], 0
    v_exp_f32 v21, v21
    v_exp_f32 v22, v22
    v_exp_f32 v23, v23
    v_exp_f32 v24, v24
    v_mfma_f32_32x32x8_bf16 v[0:15], v[96:97], v[216:217], v[0:15]
    v_exp_f32 v25, v25
    v_exp_f32 v26, v26
    v_exp_f32 v27, v27
    v_exp_f32 v28, v28
    v_smfmac_f32_32x32x32_bf16 v[48:63], v[124:127], v[16:23], v132
    s_cmp_lt_u32 s54, 4
    s_cbranch_scc1 L_att_nr1
L_att_nrr1:
    v_exp_f32 v29, v29
    v_exp_f32 v30, v30
    v_exp_f32 v31, v31
    v_exp_f32 v0, v0
    v_exp_f32 v1, v1
    v_smfmac_f32_32x32x32_bf16 v[48:63], v[128:131], v[24:31], v132
    v_exp_f32 v2, v2
    v_exp_f32 v3, v3
    v_exp_f32 v4, v4
    v_mfma_f32_32x32x16_bf16 v[16:31], v[188:191], v[68:71], 0
    ds_read_b128 v[76:79], v133 offset:46080
    ds_read_b128 v[80:83], v133 offset:47104
    ds_read_b128 v[84:87], v133 offset:51200
    ds_read_b128 v[88:91], v133 offset:52224
    ds_read_b128 v[196:199], v220 offset:48128
    v_exp_f32 v5, v5
    v_exp_f32 v6, v6
    v_exp_f32 v7, v7
    v_exp_f32 v8, v8
    v_mfma_f32_32x32x8_bf16 v[16:31], v[96:97], v[218:219], v[16:31]
    v_exp_f32 v9, v9
    v_exp_f32 v10, v10
    v_exp_f32 v11, v11
    v_exp_f32 v12, v12
    v_smfmac_f32_32x32x32_bf16 v[32:47], v[200:203], v[0:7], v132
    s_mov_b64 exec, s[28:29]
    ds_read_b128 v[100:103], v134 offset:48640
    ds_read_b128 v[104:107], v134 offset:49280
    ds_read_b128 v[108:111], v134 offset:49920
    ds_read_b128 v[112:115], v134 offset:50560
    ds_read_b128 v[116:119], v134 offset:53760
    ds_read_b128 v[120:123], v134 offset:54400
    ds_read_b128 v[124:127], v134 offset:55040
    ds_read_b128 v[128:131], v134 offset:55680
    ds_write_b32 v136, v178
    s_mov_b64 exec, -1
    v_exp_f32 v13, v13
    v_exp_f32 v14, v14
    v_exp_f32 v15, v15
    v_exp_f32 v16, v16
    v_exp_f32 v17, v17
    v_smfmac_f32_32x32x32_bf16 v[32:47], v[204:207], v[8:15], v132
    v_exp_f32 v18, v18
    v_exp_f32 v19, v19
    v_exp_f32 v20, v20
    v_mfma_f32_32x32x16_bf16 v[0:15], v[192:195], v[64:67], 0
    v_exp_f32 v21, v21
    v_exp_f32 v22, v22
    v_exp_f32 v23, v23
    v_exp_f32 v24, v24
    v_mfma_f32_32x32x8_bf16 v[0:15], v[98:99], v[216:217], v[0:15]
    v_exp_f32 v25, v25
    v_exp_f32 v26, v26
    v_exp_f32 v27, v27
    v_exp_f32 v28, v28
    v_smfmac_f32_32x32x32_bf16 v[48:63], v[200:203], v[16:23], v132
    v_exp_f32 v29, v29
    v_exp_f32 v30, v30
    v_exp_f32 v31, v31
    v_exp_f32 v0, v0
    v_exp_f32 v1, v1
    v_smfmac_f32_32x32x32_bf16 v[48:63], v[204:207], v[24:31], v132
    v_exp_f32 v2, v2
    v_exp_f32 v3, v3
    v_exp_f32 v4, v4
    v_mfma_f32_32x32x16_bf16 v[16:31], v[192:195], v[68:71], 0
    v_exp_f32 v5, v5
    v_exp_f32 v6, v6
    v_exp_f32 v7, v7
    v_exp_f32 v8, v8
    v_mfma_f32_32x32x8_bf16 v[16:31], v[98:99], v[218:219], v[16:31]
    v_exp_f32 v9, v9
    v_exp_f32 v10, v10
    v_exp_f32 v11, v11
    v_exp_f32 v12, v12
    v_smfmac_f32_32x32x32_bf16 v[32:47], v[208:211], v[0:7], v132
    s_waitcnt vmcnt(0)
    s_mov_b64 exec, 1
    ds_add_u32 v138, v139 offset:12
    s_mov_b64 exec, -1
    v_exp_f32 v13, v13
    v_exp_f32 v14, v14
    v_exp_f32 v15, v15
    v_exp_f32 v16, v16
    v_exp_f32 v17, v17
    v_smfmac_f32_32x32x32_bf16 v[32:47], v[212:215], v[8:15], v132
    s_waitcnt lgkmcnt(0)
    v_exp_f32 v18, v18
    v_exp_f32 v19, v19
    v_exp_f32 v20, v20
    v_mfma_f32_32x32x16_bf16 v[0:15], v[76:79], v[64:67], 0
    v_exp_f32 v21, v21
    v_exp_f32 v22, v22
    v_exp_f32 v23, v23
    v_exp_f32 v24, v24
    v_mfma_f32_32x32x8_bf16 v[0:15], v[196:197], v[72:73], v[0:15]
    v_exp_f32 v25, v25
    v_exp_f32 v26, v26
    v_exp_f32 v27, v27
    v_exp_f32 v28, v28
    v_smfmac_f32_32x32x32_bf16 v[48:63], v[208:211], v[16:23], v132
    v_exp_f32 v29, v29
    v_exp_f32 v30, v30
    v_exp_f32 v31, v31
    v_exp_f32 v0, v0
    v_exp_f32 v1, v1
    v_smfmac_f32_32x32x32_bf16 v[48:63], v[212:215], v[24:31], v132
    v_exp_f32 v2, v2
    v_exp_f32 v3, v3
    v_exp_f32 v4, v4
    v_mfma_f32_32x32x16_bf16 v[16:31], v[76:79], v[68:71], 0
    v_exp_f32 v5, v5
    v_exp_f32 v6, v6
    v_exp_f32 v7, v7
    v_exp_f32 v8, v8
    v_mfma_f32_32x32x8_bf16 v[16:31], v[196:197], v[74:75], v[16:31]
    v_exp_f32 v9, v9
    v_exp_f32 v10, v10
    v_exp_f32 v11, v11
    v_exp_f32 v12, v12
    v_smfmac_f32_32x32x32_bf16 v[32:47], v[100:103], v[0:7], v132
    v_exp_f32 v13, v13
    v_exp_f32 v14, v14
    v_exp_f32 v15, v15
    v_exp_f32 v16, v16
    v_exp_f32 v17, v17
    v_smfmac_f32_32x32x32_bf16 v[32:47], v[104:107], v[8:15], v132
    v_exp_f32 v18, v18
    v_exp_f32 v19, v19
    v_exp_f32 v20, v20
    v_mfma_f32_32x32x16_bf16 v[0:15], v[80:83], v[64:67], 0
    v_exp_f32 v21, v21
    v_exp_f32 v22, v22
    v_exp_f32 v23, v23
    v_exp_f32 v24, v24
    v_mfma_f32_32x32x8_bf16 v[0:15], v[198:199], v[72:73], v[0:15]
    v_exp_f32 v25, v25
    v_exp_f32 v26, v26
    v_exp_f32 v27, v27
    v_exp_f32 v28, v28
    v_smfmac_f32_32x32x32_bf16 v[48:63], v[100:103], v[16:23], v132
    v_exp_f32 v29, v29
    v_exp_f32 v30, v30
    v_exp_f32 v31, v31
    v_exp_f32 v0, v0
    v_exp_f32 v1, v1
    v_smfmac_f32_32x32x32_bf16 v[48:63], v[104:107], v[24:31], v132
    v_exp_f32 v2, v2
    v_exp_f32 v3, v3
    v_exp_f32 v4, v4
    v_mfma_f32_32x32x16_bf16 v[16:31], v[80:83], v[68:71], 0
    v_exp_f32 v5, v5
    v_exp_f32 v6, v6
    v_exp_f32 v7, v7
    v_exp_f32 v8, v8
    v_mfma_f32_32x32x8_bf16 v[16:31], v[198:199], v[74:75], v[16:31]
    v_exp_f32 v9, v9
    v_exp_f32 v10, v10
    v_exp_f32 v11, v11
    v_exp_f32 v12, v12
    v_smfmac_f32_32x32x32_bf16 v[32:47], v[108:111], v[0:7], v132
    v_exp_f32 v13, v13
    v_exp_f32 v14, v14
    v_exp_f32 v15, v15
    v_exp_f32 v16, v16
    v_exp_f32 v17, v17
    v_smfmac_f32_32x32x32_bf16 v[32:47], v[112:115], v[8:15], v132
    v_exp_f32 v18, v18
    v_exp_f32 v19, v19
    v_exp_f32 v20, v20
    v_mfma_f32_32x32x16_bf16 v[0:15], v[84:87], v[64:67], 0
    v_exp_f32 v21, v21
    v_exp_f32 v22, v22
    v_exp_f32 v23, v23
    v_exp_f32 v24, v24
    v_mfma_f32_32x32x8_bf16 v[0:15], v[196:197], v[216:217], v[0:15]
    v_exp_f32 v25, v25
    v_exp_f32 v26, v26
    v_exp_f32 v27, v27
    v_exp_f32 v28, v28
    v_smfmac_f32_32x32x32_bf16 v[48:63], v[108:111], v[16:23], v132
    v_exp_f32 v29, v29
    v_exp_f32 v30, v30
    v_exp_f32 v31, v31
    v_exp_f32 v0, v0
    v_exp_f32 v1, v1
    v_smfmac_f32_32x32x32_bf16 v[48:63], v[112:115], v[24:31], v132
    v_exp_f32 v2, v2
    v_exp_f32 v3, v3
    v_add_u32 v133, 56320, v133
    v_add_u32 v134, 56320, v134
    v_exp_f32 v4, v4
    v_mfma_f32_32x32x16_bf16 v[16:31], v[84:87], v[68:71], 0
    ds_read_b128 v[188:191], v133 offset:0
    ds_read_b128 v[192:195], v133 offset:1024
    ds_read_b128 v[76:79], v133 offset:5120
    ds_read_b128 v[80:83], v133 offset:6144
    ds_read_b128 v[92:95], v220 offset:58368
    v_exp_f32 v5, v5
    v_exp_f32 v6, v6
    v_exp_f32 v7, v7
    v_exp_f32 v8, v8
    v_mfma_f32_32x32x8_bf16 v[16:31], v[196:197], v[218:219], v[16:31]
    v_exp_f32 v9, v9
    v_exp_f32 v10, v10
    v_exp_f32 v11, v11
    v_exp_f32 v12, v12
    v_smfmac_f32_32x32x32_bf16 v[32:47], v[116:119], v[0:7], v132
    s_mov_b64 exec, s[28:29]
    ds_read_b128 v[200:203], v134 offset:2560
    ds_read_b128 v[204:207], v134 offset:3200
    ds_read_b128 v[208:211], v134 offset:3840
    ds_read_b128 v[212:215], v134 offset:4480
    ds_read_b128 v[100:103], v134 offset:7680
    ds_read_b128 v[104:107], v134 offset:8320
    ds_read_b128 v[108:111], v134 offset:8960
    ds_read_b128 v[112:115], v134 offset:9600
    s_mov_b64 exec, -1
    v_exp_f32 v13, v13
    v_exp_f32 v14, v14
    v_exp_f32 v15, v15
    v_exp_f32 v16, v16
    v_exp_f32 v17, v17
    v_smfmac_f32_32x32x32_bf16 v[32:47], v[120:123], v[8:15], v132
    v_exp_f32 v18, v18
    v_exp_f32 v19, v19
    v_exp_f32 v20, v20
    v_mfma_f32_32x32x16_bf16 v[0:15], v[88:91], v[64:67], 0
    v_exp_f32 v21, v21
    v_exp_f32 v22, v22
    v_exp_f32 v23, v23
    v_exp_f32 v24, v24
    v_mfma_f32_32x32x8_bf16 v[0:15], v[198:199], v[216:217], v[0:15]
    v_exp_f32 v25, v25
    v_exp_f32 v26, v26
    v_exp_f32 v27, v27
    v_exp_f32 v28, v28
    v_smfmac_f32_32x32x32_bf16 v[48:63], v[116:119], v[16:23], v132
    v_exp_f32 v29, v29
    v_exp_f32 v30, v30
    v_exp_f32 v31, v31
    v_exp_f32 v0, v0
    v_exp_f32 v1, v1
    v_smfmac_f32_32x32x32_bf16 v[48:63], v[120:123], v[24:31], v132
    v_exp_f32 v2, v2
    v_exp_f32 v3, v3
    v_exp_f32 v4, v4
    v_mfma_f32_32x32x16_bf16 v[16:31], v[88:91], v[68:71], 0
    ds_read_b32 v140, v138 offset:12
    v_exp_f32 v5, v5
    v_exp_f32 v6, v6
    v_exp_f32 v7, v7
    v_exp_f32 v8, v8
    v_mfma_f32_32x32x8_bf16 v[16:31], v[198:199], v[218:219], v[16:31]
    v_exp_f32 v9, v9
    v_exp_f32 v10, v10
    v_exp_f32 v11, v11
    v_exp_f32 v12, v12
    v_smfmac_f32_32x32x32_bf16 v[32:47], v[124:127], v[0:7], v132
    v_exp_f32 v13, v13
    v_exp_f32 v14, v14
    v_exp_f32 v15, v15
    v_exp_f32 v16, v16
    v_exp_f32 v17, v17
    v_smfmac_f32_32x32x32_bf16 v[32:47], v[128:131], v[8:15], v132
    s_waitcnt lgkmcnt(0)
    v_exp_f32 v18, v18
    v_exp_f32 v19, v19
    v_exp_f32 v20, v20
    v_mfma_f32_32x32x16_bf16 v[0:15], v[188:191], v[64:67], 0
    v_exp_f32 v21, v21
    v_exp_f32 v22, v22
    v_exp_f32 v23, v23
    v_exp_f32 v24, v24
    v_mfma_f32_32x32x8_bf16 v[0:15], v[92:93], v[72:73], v[0:15]
    v_exp_f32 v25, v25
    v_exp_f32 v26, v26
    v_exp_f32 v27, v27
    v_exp_f32 v28, v28
    v_smfmac_f32_32x32x32_bf16 v[48:63], v[124:127], v[16:23], v132
    v_exp_f32 v29, v29
    v_exp_f32 v30, v30
    v_exp_f32 v31, v31
    v_exp_f32 v0, v0
    v_exp_f32 v1, v1
    v_smfmac_f32_32x32x32_bf16 v[48:63], v[128:131], v[24:31], v132
    v_exp_f32 v2, v2
    v_exp_f32 v3, v3
    v_exp_f32 v4, v4
    v_mfma_f32_32x32x16_bf16 v[16:31], v[188:191], v[68:71], 0
    v_exp_f32 v5, v5
    v_exp_f32 v6, v6
    v_exp_f32 v7, v7
    v_exp_f32 v8, v8
    v_mfma_f32_32x32x8_bf16 v[16:31], v[92:93], v[74:75], v[16:31]
    v_exp_f32 v9, v9
    v_exp_f32 v10, v10
    v_exp_f32 v11, v11
    v_exp_f32 v12, v12
    v_smfmac_f32_32x32x32_bf16 v[32:47], v[200:203], v[0:7], v132
    v_exp_f32 v13, v13
    v_exp_f32 v14, v14
    v_exp_f32 v15, v15
    v_exp_f32 v16, v16
    v_exp_f32 v17, v17
    v_smfmac_f32_32x32x32_bf16 v[32:47], v[204:207], v[8:15], v132
    v_exp_f32 v18, v18
    v_exp_f32 v19, v19
    v_exp_f32 v20, v20
    v_mfma_f32_32x32x16_bf16 v[0:15], v[192:195], v[64:67], 0
    v_exp_f32 v21, v21
    v_exp_f32 v22, v22
    v_exp_f32 v23, v23
    v_exp_f32 v24, v24
    v_mfma_f32_32x32x8_bf16 v[0:15], v[94:95], v[72:73], v[0:15]
    v_exp_f32 v25, v25
    v_exp_f32 v26, v26
    v_exp_f32 v27, v27
    v_exp_f32 v28, v28
    v_smfmac_f32_32x32x32_bf16 v[48:63], v[200:203], v[16:23], v132
    v_exp_f32 v29, v29
    v_exp_f32 v30, v30
    v_exp_f32 v31, v31
    v_exp_f32 v0, v0
    v_exp_f32 v1, v1
    v_smfmac_f32_32x32x32_bf16 v[48:63], v[204:207], v[24:31], v132
    v_exp_f32 v2, v2
    v_exp_f32 v3, v3
    v_readfirstlane_b32 s54, v140
    v_exp_f32 v4, v4
    v_mfma_f32_32x32x16_bf16 v[16:31], v[192:195], v[68:71], 0
    v_exp_f32 v5, v5
    v_exp_f32 v6, v6
    v_exp_f32 v7, v7
    v_exp_f32 v8, v8
    v_mfma_f32_32x32x8_bf16 v[16:31], v[94:95], v[74:75], v[16:31]
    v_exp_f32 v9, v9
    v_exp_f32 v10, v10
    v_exp_f32 v11, v11
    v_exp_f32 v12, v12
    v_smfmac_f32_32x32x32_bf16 v[32:47], v[208:211], v[0:7], v132
    v_exp_f32 v13, v13
    v_exp_f32 v14, v14
    v_exp_f32 v15, v15
    v_exp_f32 v16, v16
    v_exp_f32 v17, v17
    v_smfmac_f32_32x32x32_bf16 v[32:47], v[212:215], v[8:15], v132
    v_exp_f32 v18, v18
    v_exp_f32 v19, v19
    v_exp_f32 v20, v20
    v_mfma_f32_32x32x16_bf16 v[0:15], v[76:79], v[64:67], 0
    v_exp_f32 v21, v21
    v_exp_f32 v22, v22
    v_exp_f32 v23, v23
    v_exp_f32 v24, v24
    v_mfma_f32_32x32x8_bf16 v[0:15], v[92:93], v[216:217], v[0:15]
    v_exp_f32 v25, v25
    v_exp_f32 v26, v26
    v_exp_f32 v27, v27
    v_exp_f32 v28, v28
    v_smfmac_f32_32x32x32_bf16 v[48:63], v[208:211], v[16:23], v132
    s_cmp_lt_u32 s54, 4
    s_cbranch_scc1 L_att_nr2
L_att_nrr2:
    v_exp_f32 v29, v29
    v_exp_f32 v30, v30
    v_exp_f32 v31, v31
    v_exp_f32 v0, v0
    v_exp_f32 v1, v1
    v_smfmac_f32_32x32x32_bf16 v[48:63], v[212:215], v[24:31], v132
    v_exp_f32 v2, v2
    v_exp_f32 v3, v3
    v_add_u32 v220, 66560, v220
    v_exp_f32 v4, v4
    v_mfma_f32_32x32x16_bf16 v[16:31], v[76:79], v[68:71], 0
    ds_read_b128 v[84:87], v133 offset:10240
    ds_read_b128 v[88:91], v133 offset:11264
    ds_read_b128 v[188:191], v133 offset:15360
    ds_read_b128 v[192:195], v133 offset:16384
    ds_read_b128 v[96:99], v220 offset:2048
    v_exp_f32 v5, v5
    v_exp_f32 v6, v6
    v_exp_f32 v7, v7
    v_exp_f32 v8, v8
    v_mfma_f32_32x32x8_bf16 v[16:31], v[92:93], v[218:219], v[16:31]
    v_exp_f32 v9, v9
    v_exp_f32 v10, v10
    v_exp_f32 v11, v11
    v_exp_f32 v12, v12
    v_smfmac_f32_32x32x32_bf16 v[32:47], v[100:103], v[0:7], v132
    s_mov_b64 exec, s[28:29]
    ds_read_b128 v[116:119], v134 offset:12800
    ds_read_b128 v[120:123], v134 offset:13440
    ds_read_b128 v[124:127], v134 offset:14080
    ds_read_b128 v[128:131], v134 offset:14720
    ds_read_b128 v[200:203], v134 offset:17920
    ds_read_b128 v[204:207], v134 offset:18560
    ds_read_b128 v[208:211], v134 offset:19200
    ds_read_b128 v[212:215], v134 offset:19840
    ds_write_b32 v136, v179
    s_mov_b64 exec, -1
    v_exp_f32 v13, v13
    v_exp_f32 v14, v14
    v_exp_f32 v15, v15
    v_exp_f32 v16, v16
    v_exp_f32 v17, v17
    v_smfmac_f32_32x32x32_bf16 v[32:47], v[104:107], v[8:15], v132
    v_exp_f32 v18, v18
    v_exp_f32 v19, v19
    v_exp_f32 v20, v20
    v_mfma_f32_32x32x16_bf16 v[0:15], v[80:83], v[64:67], 0
    v_exp_f32 v21, v21
    v_exp_f32 v22, v22
    v_exp_f32 v23, v23
    v_exp_f32 v24, v24
    v_mfma_f32_32x32x8_bf16 v[0:15], v[94:95], v[216:217], v[0:15]
    v_exp_f32 v25, v25
    v_exp_f32 v26, v26
    v_exp_f32 v27, v27
    v_exp_f32 v28, v28
    v_smfmac_f32_32x32x32_bf16 v[48:63], v[100:103], v[16:23], v132
    v_exp_f32 v29, v29
    v_exp_f32 v30, v30
    v_exp_f32 v31, v31
    v_exp_f32 v0, v0
    v_exp_f32 v1, v1
    v_smfmac_f32_32x32x32_bf16 v[48:63], v[104:107], v[24:31], v132
    v_exp_f32 v2, v2
    v_exp_f32 v3, v3
    v_exp_f32 v4, v4
    v_mfma_f32_32x32x16_bf16 v[16:31], v[80:83], v[68:71], 0
    v_exp_f32 v5, v5
    v_exp_f32 v6, v6
    v_exp_f32 v7, v7
    v_exp_f32 v8, v8
    v_mfma_f32_32x32x8_bf16 v[16:31], v[94:95], v[218:219], v[16:31]
    v_exp_f32 v9, v9
    v_exp_f32 v10, v10
    v_exp_f32 v11, v11
    v_exp_f32 v12, v12
    v_smfmac_f32_32x32x32_bf16 v[32:47], v[108:111], v[0:7], v132
    v_exp_f32 v13, v13
    v_exp_f32 v14, v14
    v_exp_f32 v15, v15
    v_exp_f32 v16, v16
    v_exp_f32 v17, v17
    v_smfmac_f32_32x32x32_bf16 v[32:47], v[112:115], v[8:15], v132
    s_waitcnt lgkmcnt(0)
    v_exp_f32 v18, v18
    v_exp_f32 v19, v19
    v_exp_f32 v20, v20
    v_mfma_f32_32x32x16_bf16 v[0:15], v[84:87], v[64:67], 0
    v_exp_f32 v21, v21
    v_exp_f32 v22, v22
    v_exp_f32 v23, v23
    v_exp_f32 v24, v24
    v_mfma_f32_32x32x8_bf16 v[0:15], v[96:97], v[72:73], v[0:15]
    v_exp_f32 v25, v25
    v_exp_f32 v26, v26
    v_exp_f32 v27, v27
    v_exp_f32 v28, v28
    v_smfmac_f32_32x32x32_bf16 v[48:63], v[108:111], v[16:23], v132
    v_exp_f32 v29, v29
    v_exp_f32 v30, v30
    v_exp_f32 v31, v31
    v_exp_f32 v0, v0
    v_exp_f32 v1, v1
    v_smfmac_f32_32x32x32_bf16 v[48:63], v[112:115], v[24:31], v132
    v_exp_f32 v2, v2
    v_exp_f32 v3, v3
    v_exp_f32 v4, v4
    v_mfma_f32_32x32x16_bf16 v[16:31], v[84:87], v[68:71], 0
    v_exp_f32 v5, v5
    v_exp_f32 v6, v6
    v_exp_f32 v7, v7
    v_exp_f32 v8, v8
    v_mfma_f32_32x32x8_bf16 v[16:31], v[96:97], v[74:75], v[16:31]
    v_exp_f32 v9, v9
    v_exp_f32 v10, v10
    v_exp_f32 v11, v11
    v_exp_f32 v12, v12
    v_smfmac_f32_32x32x32_bf16 v[32:47], v[116:119], v[0:7], v132
    v_exp_f32 v13, v13
    v_exp_f32 v14, v14
    v_exp_f32 v15, v15
    v_exp_f32 v16, v16
    v_exp_f32 v17, v17
    v_smfmac_f32_32x32x32_bf16 v[32:47], v[120:123], v[8:15], v132
    v_exp_f32 v18, v18
    v_exp_f32 v19, v19
    v_exp_f32 v20, v20
    v_mfma_f32_32x32x16_bf16 v[0:15], v[88:91], v[64:67], 0
    v_exp_f32 v21, v21
    v_exp_f32 v22, v22
    v_exp_f32 v23, v23
    v_exp_f32 v24, v24
    v_mfma_f32_32x32x8_bf16 v[0:15], v[98:99], v[72:73], v[0:15]
    v_exp_f32 v25, v25
    v_exp_f32 v26, v26
    v_exp_f32 v27, v27
    v_exp_f32 v28, v28
    v_smfmac_f32_32x32x32_bf16 v[48:63], v[116:119], v[16:23], v132
    v_exp_f32 v29, v29
    v_exp_f32 v30, v30
    v_exp_f32 v31, v31
    v_exp_f32 v0, v0
    v_exp_f32 v1, v1
    v_smfmac_f32_32x32x32_bf16 v[48:63], v[120:123], v[24:31], v132
    v_exp_f32 v2, v2
    v_exp_f32 v3, v3
    v_exp_f32 v4, v4
    v_mfma_f32_32x32x16_bf16 v[16:31], v[88:91], v[68:71], 0
    v_exp_f32 v5, v5
    v_exp_f32 v6, v6
    v_exp_f32 v7, v7
    v_exp_f32 v8, v8
    v_mfma_f32_32x32x8_bf16 v[16:31], v[98:99], v[74:75], v[16:31]
    v_exp_f32 v9, v9
    v_exp_f32 v10, v10
    v_exp_f32 v11, v11
    v_exp_f32 v12, v12
    v_smfmac_f32_32x32x32_bf16 v[32:47], v[124:127], v[0:7], v132
    v_exp_f32 v13, v13
    v_exp_f32 v14, v14
    v_exp_f32 v15, v15
    v_exp_f32 v16, v16
    v_exp_f32 v17, v17
    v_smfmac_f32_32x32x32_bf16 v[32:47], v[128:131], v[8:15], v132
    v_exp_f32 v18, v18
    v_exp_f32 v19, v19
    v_exp_f32 v20, v20
    v_mfma_f32_32x32x16_bf16 v[0:15], v[188:191], v[64:67], 0
    v_exp_f32 v21, v21
    v_exp_f32 v22, v22
    v_exp_f32 v23, v23
    v_exp_f32 v24, v24
    v_mfma_f32_32x32x8_bf16 v[0:15], v[96:97], v[216:217], v[0:15]
    v_exp_f32 v25, v25
    v_exp_f32 v26, v26
    v_exp_f32 v27, v27
    v_exp_f32 v28, v28
    v_smfmac_f32_32x32x32_bf16 v[48:63], v[124:127], v[16:23], v132
    v_exp_f32 v29, v29
    v_exp_f32 v30, v30
    v_exp_f32 v31, v31
    v_exp_f32 v0, v0
    v_exp_f32 v1, v1
    v_smfmac_f32_32x32x32_bf16 v[48:63], v[128:131], v[24:31], v132
    v_exp_f32 v2, v2
    v_exp_f32 v3, v3
    v_exp_f32 v4, v4
    v_mfma_f32_32x32x16_bf16 v[16:31], v[188:191], v[68:71], 0
    ds_read_b128 v[76:79], v133 offset:20480
    ds_read_b128 v[80:83], v133 offset:21504
    ds_read_b128 v[84:87], v133 offset:25600
    ds_read_b128 v[88:91], v133 offset:26624
    ds_read_b128 v[196:199], v220 offset:12288
    v_exp_f32 v5, v5
    v_exp_f32 v6, v6
    v_exp_f32 v7, v7
    v_exp_f32 v8, v8
    v_mfma_f32_32x32x8_bf16 v[16:31], v[96:97], v[218:219], v[16:31]
    v_exp_f32 v9, v9
    v_exp_f32 v10, v10
    v_exp_f32 v11, v11
    v_exp_f32 v12, v12
    v_smfmac_f32_32x32x32_bf16 v[32:47], v[200:203], v[0:7], v132
    s_mov_b64 exec, s[28:29]
    ds_read_b128 v[100:103], v134 offset:23040
    ds_read_b128 v[104:107], v134 offset:23680
    ds_read_b128 v[108:111], v134 offset:24320
    ds_read_b128 v[112:115], v134 offset:24960
    ds_read_b128 v[116:119], v134 offset:28160
    ds_read_b128 v[120:123], v134 offset:28800
    ds_read_b128 v[124:127], v134 offset:29440
    ds_read_b128 v[128:131], v134 offset:30080
    s_mov_b64 exec, -1
    v_exp_f32 v13, v13
    v_exp_f32 v14, v14
    v_exp_f32 v15, v15
    v_exp_f32 v16, v16
    v_exp_f32 v17, v17
    v_smfmac_f32_32x32x32_bf16 v[32:47], v[204:207], v[8:15], v132
    v_exp_f32 v18, v18
    v_exp_f32 v19, v19
    v_exp_f32 v20, v20
    v_mfma_f32_32x32x16_bf16 v[0:15], v[192:195], v[64:67], 0
    v_exp_f32 v21, v21
    v_exp_f32 v22, v22
    v_exp_f32 v23, v23
    v_exp_f32 v24, v24
    v_mfma_f32_32x32x8_bf16 v[0:15], v[98:99], v[216:217], v[0:15]
    v_exp_f32 v25, v25
    v_exp_f32 v26, v26
    v_exp_f32 v27, v27
    v_exp_f32 v28, v28
    v_smfmac_f32_32x32x32_bf16 v[48:63], v[200:203], v[16:23], v132
    v_exp_f32 v29, v29
    v_exp_f32 v30, v30
    v_exp_f32 v31, v31
    v_exp_f32 v0, v0
    v_exp_f32 v1, v1
    v_smfmac_f32_32x32x32_bf16 v[48:63], v[204:207], v[24:31], v132
    v_exp_f32 v2, v2
    v_exp_f32 v3, v3
    v_exp_f32 v4, v4
    v_mfma_f32_32x32x16_bf16 v[16:31], v[192:195], v[68:71], 0
    ds_read_b32 v140, v138 offset:16
    v_exp_f32 v5, v5
    v_exp_f32 v6, v6
    v_exp_f32 v7, v7
    v_exp_f32 v8, v8
    v_mfma_f32_32x32x8_bf16 v[16:31], v[98:99], v[218:219], v[16:31]
    v_exp_f32 v9, v9
    v_exp_f32 v10, v10
    v_exp_f32 v11, v11
    v_exp_f32 v12, v12
    v_smfmac_f32_32x32x32_bf16 v[32:47], v[208:211], v[0:7], v132
    v_exp_f32 v13, v13
    v_exp_f32 v14, v14
    v_exp_f32 v15, v15
    v_exp_f32 v16, v16
    v_exp_f32 v17, v17
    v_smfmac_f32_32x32x32_bf16 v[32:47], v[212:215], v[8:15], v132
    s_waitcnt lgkmcnt(0)
    v_exp_f32 v18, v18
    v_exp_f32 v19, v19
    v_exp_f32 v20, v20
    v_mfma_f32_32x32x16_bf16 v[0:15], v[76:79], v[64:67], 0
    v_exp_f32 v21, v21
    v_exp_f32 v22, v22
    v_exp_f32 v23, v23
    v_exp_f32 v24, v24
    v_mfma_f32_32x32x8_bf16 v[0:15], v[196:197], v[72:73], v[0:15]
    v_exp_f32 v25, v25
    v_exp_f32 v26, v26
    v_exp_f32 v27, v27
    v_exp_f32 v28, v28
    v_smfmac_f32_32x32x32_bf16 v[48:63], v[208:211], v[16:23], v132
    v_exp_f32 v29, v29
    v_exp_f32 v30, v30
    v_exp_f32 v31, v31
    v_exp_f32 v0, v0
    v_exp_f32 v1, v1
    v_smfmac_f32_32x32x32_bf16 v[48:63], v[212:215], v[24:31], v132
    v_exp_f32 v2, v2
    v_exp_f32 v3, v3
    v_exp_f32 v4, v4
    v_mfma_f32_32x32x16_bf16 v[16:31], v[76:79], v[68:71], 0
    v_exp_f32 v5, v5
    v_exp_f32 v6, v6
    v_exp_f32 v7, v7
    v_exp_f32 v8, v8
    v_mfma_f32_32x32x8_bf16 v[16:31], v[196:197], v[74:75], v[16:31]
    v_exp_f32 v9, v9
    v_exp_f32 v10, v10
    v_exp_f32 v11, v11
    v_exp_f32 v12, v12
    v_smfmac_f32_32x32x32_bf16 v[32:47], v[100:103], v[0:7], v132
    v_exp_f32 v13, v13
    v_exp_f32 v14, v14
    v_exp_f32 v15, v15
    v_exp_f32 v16, v16
    v_exp_f32 v17, v17
    v_smfmac_f32_32x32x32_bf16 v[32:47], v[104:107], v[8:15], v132
    v_exp_f32 v18, v18
    v_exp_f32 v19, v19
    v_exp_f32 v20, v20
    v_mfma_f32_32x32x16_bf16 v[0:15], v[80:83], v[64:67], 0
    v_exp_f32 v21, v21
    v_exp_f32 v22, v22
    v_exp_f32 v23, v23
    v_exp_f32 v24, v24
    v_mfma_f32_32x32x8_bf16 v[0:15], v[198:199], v[72:73], v[0:15]
    v_exp_f32 v25, v25
    v_exp_f32 v26, v26
    v_exp_f32 v27, v27
    v_exp_f32 v28, v28
    v_smfmac_f32_32x32x32_bf16 v[48:63], v[100:103], v[16:23], v132
    v_exp_f32 v29, v29
    v_exp_f32 v30, v30
    v_exp_f32 v31, v31
    v_exp_f32 v0, v0
    v_exp_f32 v1, v1
    v_smfmac_f32_32x32x32_bf16 v[48:63], v[104:107], v[24:31], v132
    v_exp_f32 v2, v2
    v_exp_f32 v3, v3
    v_readfirstlane_b32 s54, v140
    v_exp_f32 v4, v4
    v_mfma_f32_32x32x16_bf16 v[16:31], v[80:83], v[68:71], 0
    v_exp_f32 v5, v5
    v_exp_f32 v6, v6
    v_exp_f32 v7, v7
    v_exp_f32 v8, v8
    v_mfma_f32_32x32x8_bf16 v[16:31], v[198:199], v[74:75], v[16:31]
    v_exp_f32 v9, v9
    v_exp_f32 v10, v10
    v_exp_f32 v11, v11
    v_exp_f32 v12, v12
    v_smfmac_f32_32x32x32_bf16 v[32:47], v[108:111], v[0:7], v132
    v_exp_f32 v13, v13
    v_exp_f32 v14, v14
    v_exp_f32 v15, v15
    v_exp_f32 v16, v16
    v_exp_f32 v17, v17
    v_smfmac_f32_32x32x32_bf16 v[32:47], v[112:115], v[8:15], v132
    v_exp_f32 v18, v18
    v_exp_f32 v19, v19
    v_exp_f32 v20, v20
    v_mfma_f32_32x32x16_bf16 v[0:15], v[84:87], v[64:67], 0
    v_exp_f32 v21, v21
    v_exp_f32 v22, v22
    v_exp_f32 v23, v23
    v_exp_f32 v24, v24
    v_mfma_f32_32x32x8_bf16 v[0:15], v[196:197], v[216:217], v[0:15]
    v_exp_f32 v25, v25
    v_exp_f32 v26, v26
    v_exp_f32 v27, v27
    v_exp_f32 v28, v28
    v_smfmac_f32_32x32x32_bf16 v[48:63], v[108:111], v[16:23], v132
    s_cmp_lt_u32 s54, 4
    s_cbranch_scc1 L_att_nr3
L_att_nrr3:
    v_exp_f32 v29, v29
    v_exp_f32 v30, v30
    v_exp_f32 v31, v31
    v_exp_f32 v0, v0
    v_exp_f32 v1, v1
    v_smfmac_f32_32x32x32_bf16 v[48:63], v[112:115], v[24:31], v132
    v_exp_f32 v2, v2
    v_exp_f32 v3, v3
    v_exp_f32 v4, v4
    v_mfma_f32_32x32x16_bf16 v[16:31], v[84:87], v[68:71], 0
    ds_read_b128 v[188:191], v133 offset:30720
    ds_read_b128 v[192:195], v133 offset:31744
    ds_read_b128 v[76:79], v133 offset:35840
    ds_read_b128 v[80:83], v133 offset:36864
    ds_read_b128 v[92:95], v220 offset:22528
    v_exp_f32 v5, v5
    v_exp_f32 v6, v6
    v_exp_f32 v7, v7
    v_exp_f32 v8, v8
    v_mfma_f32_32x32x8_bf16 v[16:31], v[196:197], v[218:219], v[16:31]
    v_exp_f32 v9, v9
    v_exp_f32 v10, v10
    v_exp_f32 v11, v11
    v_exp_f32 v12, v12
    v_smfmac_f32_32x32x32_bf16 v[32:47], v[116:119], v[0:7], v132
    s_mov_b64 exec, s[28:29]
    ds_read_b128 v[200:203], v134 offset:33280
    ds_read_b128 v[204:207], v134 offset:33920
    ds_read_b128 v[208:211], v134 offset:34560
    ds_read_b128 v[212:215], v134 offset:35200
    ds_read_b128 v[100:103], v134 offset:38400
    ds_read_b128 v[104:107], v134 offset:39040
    ds_read_b128 v[108:111], v134 offset:39680
    ds_read_b128 v[112:115], v134 offset:40320
    ds_write_b32 v136, v180
    s_mov_b64 exec, -1
    v_exp_f32 v13, v13
    v_exp_f32 v14, v14
    v_exp_f32 v15, v15
    v_exp_f32 v16, v16
    v_exp_f32 v17, v17
    v_smfmac_f32_32x32x32_bf16 v[32:47], v[120:123], v[8:15], v132
    v_exp_f32 v18, v18
    v_exp_f32 v19, v19
    v_exp_f32 v20, v20
    v_mfma_f32_32x32x16_bf16 v[0:15], v[88:91], v[64:67], 0
    v_exp_f32 v21, v21
    v_exp_f32 v22, v22
    v_exp_f32 v23, v23
    v_exp_f32 v24, v24
    v_mfma_f32_32x32x8_bf16 v[0:15], v[198:199], v[216:217], v[0:15]
    v_exp_f32 v25, v25
    v_exp_f32 v26, v26
    v_exp_f32 v27, v27
    v_exp_f32 v28, v28
    v_smfmac_f32_32x32x32_bf16 v[48:63], v[116:119], v[16:23], v132
    v_exp_f32 v29, v29
    v_exp_f32 v30, v30
    v_exp_f32 v31, v31
    v_exp_f32 v0, v0
    v_exp_f32 v1, v1
    v_smfmac_f32_32x32x32_bf16 v[48:63], v[120:123], v[24:31], v132
    v_exp_f32 v2, v2
    v_exp_f32 v3, v3
    v_exp_f32 v4, v4
    v_mfma_f32_32x32x16_bf16 v[16:31], v[88:91], v[68:71], 0
    v_exp_f32 v5, v5
    v_exp_f32 v6, v6
    v_exp_f32 v7, v7
    v_exp_f32 v8, v8
    v_mfma_f32_32x32x8_bf16 v[16:31], v[198:199], v[218:219], v[16:31]
    v_exp_f32 v9, v9
    v_exp_f32 v10, v10
    v_exp_f32 v11, v11
    v_exp_f32 v12, v12
    v_smfmac_f32_32x32x32_bf16 v[32:47], v[124:127], v[0:7], v132
    v_exp_f32 v13, v13
    v_exp_f32 v14, v14
    v_exp_f32 v15, v15
    v_exp_f32 v16, v16
    v_exp_f32 v17, v17
    v_smfmac_f32_32x32x32_bf16 v[32:47], v[128:131], v[8:15], v132
    s_waitcnt lgkmcnt(0)
    v_exp_f32 v18, v18
    v_exp_f32 v19, v19
    v_exp_f32 v20, v20
    v_mfma_f32_32x32x16_bf16 v[0:15], v[188:191], v[64:67], 0
    v_exp_f32 v21, v21
    v_exp_f32 v22, v22
    v_exp_f32 v23, v23
    v_exp_f32 v24, v24
    v_mfma_f32_32x32x8_bf16 v[0:15], v[92:93], v[72:73], v[0:15]
    v_exp_f32 v25, v25
    v_exp_f32 v26, v26
    v_exp_f32 v27, v27
    v_exp_f32 v28, v28
    v_smfmac_f32_32x32x32_bf16 v[48:63], v[124:127], v[16:23], v132
    v_exp_f32 v29, v29
    v_exp_f32 v30, v30
    v_exp_f32 v31, v31
    v_exp_f32 v0, v0
    v_exp_f32 v1, v1
    v_smfmac_f32_32x32x32_bf16 v[48:63], v[128:131], v[24:31], v132
    v_exp_f32 v2, v2
    v_exp_f32 v3, v3
    v_exp_f32 v4, v4
    v_mfma_f32_32x32x16_bf16 v[16:31], v[188:191], v[68:71], 0
    v_exp_f32 v5, v5
    v_exp_f32 v6, v6
    v_exp_f32 v7, v7
    v_exp_f32 v8, v8
    v_mfma_f32_32x32x8_bf16 v[16:31], v[92:93], v[74:75], v[16:31]
    v_exp_f32 v9, v9
    v_exp_f32 v10, v10
    v_exp_f32 v11, v11
    v_exp_f32 v12, v12
    v_smfmac_f32_32x32x32_bf16 v[32:47], v[200:203], v[0:7], v132
    v_exp_f32 v13, v13
    v_exp_f32 v14, v14
    v_exp_f32 v15, v15
    v_exp_f32 v16, v16
    v_exp_f32 v17, v17
    v_smfmac_f32_32x32x32_bf16 v[32:47], v[204:207], v[8:15], v132
    v_exp_f32 v18, v18
    v_exp_f32 v19, v19
    v_exp_f32 v20, v20
    v_mfma_f32_32x32x16_bf16 v[0:15], v[192:195], v[64:67], 0
    v_exp_f32 v21, v21
    v_exp_f32 v22, v22
    v_exp_f32 v23, v23
    v_exp_f32 v24, v24
    v_mfma_f32_32x32x8_bf16 v[0:15], v[94:95], v[72:73], v[0:15]
    v_exp_f32 v25, v25
    v_exp_f32 v26, v26
    v_exp_f32 v27, v27
    v_exp_f32 v28, v28
    v_smfmac_f32_32x32x32_bf16 v[48:63], v[200:203], v[16:23], v132
    v_exp_f32 v29, v29
    v_exp_f32 v30, v30
    v_exp_f32 v31, v31
    v_exp_f32 v0, v0
    v_exp_f32 v1, v1
    v_smfmac_f32_32x32x32_bf16 v[48:63], v[204:207], v[24:31], v132
    v_exp_f32 v2, v2
    v_exp_f32 v3, v3
    v_exp_f32 v4, v4
    v_mfma_f32_32x32x16_bf16 v[16:31], v[192:195], v[68:71], 0
    v_exp_f32 v5, v5
    v_exp_f32 v6, v6
    v_exp_f32 v7, v7
    v_exp_f32 v8, v8
    v_mfma_f32_32x32x8_bf16 v[16:31], v[94:95], v[74:75], v[16:31]
    v_exp_f32 v9, v9
    v_exp_f32 v10, v10
    v_exp_f32 v11, v11
    v_exp_f32 v12, v12
    v_smfmac_f32_32x32x32_bf16 v[32:47], v[208:211], v[0:7], v132
    v_exp_f32 v13, v13
    v_exp_f32 v14, v14
    v_exp_f32 v15, v15
    v_exp_f32 v16, v16
    v_exp_f32 v17, v17
    v_smfmac_f32_32x32x32_bf16 v[32:47], v[212:215], v[8:15], v132
    v_exp_f32 v18, v18
    v_exp_f32 v19, v19
    v_exp_f32 v20, v20
    v_mfma_f32_32x32x16_bf16 v[0:15], v[76:79], v[64:67], 0
    v_exp_f32 v21, v21
    v_exp_f32 v22, v22
    v_exp_f32 v23, v23
    v_exp_f32 v24, v24
    v_mfma_f32_32x32x8_bf16 v[0:15], v[92:93], v[216:217], v[0:15]
    v_exp_f32 v25, v25
    v_exp_f32 v26, v26
    v_exp_f32 v27, v27
    v_exp_f32 v28, v28
    v_smfmac_f32_32x32x32_bf16 v[48:63], v[208:211], v[16:23], v132
    v_exp_f32 v29, v29
    v_exp_f32 v30, v30
    v_exp_f32 v31, v31
    v_exp_f32 v0, v0
    v_exp_f32 v1, v1
    v_smfmac_f32_32x32x32_bf16 v[48:63], v[212:215], v[24:31], v132
    v_exp_f32 v2, v2
    v_exp_f32 v3, v3
    v_exp_f32 v4, v4
    v_mfma_f32_32x32x16_bf16 v[16:31], v[76:79], v[68:71], 0
    ds_read_b128 v[84:87], v133 offset:40960
    ds_read_b128 v[88:91], v133 offset:41984
    ds_read_b128 v[188:191], v133 offset:46080
    ds_read_b128 v[192:195], v133 offset:47104
    ds_read_b128 v[96:99], v220 offset:32768
    v_exp_f32 v5, v5
    v_exp_f32 v6, v6
    v_exp_f32 v7, v7
    v_exp_f32 v8, v8
    v_mfma_f32_32x32x8_bf16 v[16:31], v[92:93], v[218:219], v[16:31]
    v_exp_f32 v9, v9
    v_exp_f32 v10, v10
    v_exp_f32 v11, v11
    v_exp_f32 v12, v12
    v_smfmac_f32_32x32x32_bf16 v[32:47], v[100:103], v[0:7], v132
    s_mov_b64 exec, s[28:29]
    ds_read_b128 v[116:119], v134 offset:43520
    ds_read_b128 v[120:123], v134 offset:44160
    ds_read_b128 v[124:127], v134 offset:44800
    ds_read_b128 v[128:131], v134 offset:45440
    ds_read_b128 v[200:203], v134 offset:48640
    ds_read_b128 v[204:207], v134 offset:49280
    ds_read_b128 v[208:211], v134 offset:49920
    ds_read_b128 v[212:215], v134 offset:50560
    s_mov_b64 exec, -1
    v_exp_f32 v13, v13
    v_exp_f32 v14, v14
    v_exp_f32 v15, v15
    v_exp_f32 v16, v16
    v_exp_f32 v17, v17
    v_smfmac_f32_32x32x32_bf16 v[32:47], v[104:107], v[8:15], v132
    v_exp_f32 v18, v18
    v_exp_f32 v19, v19
    v_exp_f32 v20, v20
    v_mfma_f32_32x32x16_bf16 v[0:15], v[80:83], v[64:67], 0
    v_exp_f32 v21, v21
    v_exp_f32 v22, v22
    v_exp_f32 v23, v23
    v_exp_f32 v24, v24
    v_mfma_f32_32x32x8_bf16 v[0:15], v[94:95], v[216:217], v[0:15]
    v_exp_f32 v25, v25
    v_exp_f32 v26, v26
    v_exp_f32 v27, v27
    v_exp_f32 v28, v28
    v_smfmac_f32_32x32x32_bf16 v[48:63], v[100:103], v[16:23], v132
    v_exp_f32 v29, v29
    v_exp_f32 v30, v30
    v_exp_f32 v31, v31
    v_exp_f32 v0, v0
    v_exp_f32 v1, v1
    v_smfmac_f32_32x32x32_bf16 v[48:63], v[104:107], v[24:31], v132
    v_exp_f32 v2, v2
    v_exp_f32 v3, v3
    v_exp_f32 v4, v4
    v_mfma_f32_32x32x16_bf16 v[16:31], v[80:83], v[68:71], 0
    ds_read_b32 v140, v138 offset:20
    v_exp_f32 v5, v5
    v_exp_f32 v6, v6
    v_exp_f32 v7, v7
    v_exp_f32 v8, v8
    v_mfma_f32_32x32x8_bf16 v[16:31], v[94:95], v[218:219], v[16:31]
    v_exp_f32 v9, v9
    v_exp_f32 v10, v10
    v_exp_f32 v11, v11
    v_exp_f32 v12, v12
    v_smfmac_f32_32x32x32_bf16 v[32:47], v[108:111], v[0:7], v132
    v_exp_f32 v13, v13
    v_exp_f32 v14, v14
    v_exp_f32 v15, v15
    v_exp_f32 v16, v16
    v_exp_f32 v17, v17
    v_smfmac_f32_32x32x32_bf16 v[32:47], v[112:115], v[8:15], v132
    s_waitcnt lgkmcnt(0)
    v_exp_f32 v18, v18
    v_exp_f32 v19, v19
    v_exp_f32 v20, v20
    v_mfma_f32_32x32x16_bf16 v[0:15], v[84:87], v[64:67], 0
    v_exp_f32 v21, v21
    v_exp_f32 v22, v22
    v_exp_f32 v23, v23
    v_exp_f32 v24, v24
    v_mfma_f32_32x32x8_bf16 v[0:15], v[96:97], v[72:73], v[0:15]
    v_exp_f32 v25, v25
    v_exp_f32 v26, v26
    v_exp_f32 v27, v27
    v_exp_f32 v28, v28
    v_smfmac_f32_32x32x32_bf16 v[48:63], v[108:111], v[16:23], v132
    v_exp_f32 v29, v29
    v_exp_f32 v30, v30
    v_exp_f32 v31, v31
    v_exp_f32 v0, v0
    v_exp_f32 v1, v1
    v_smfmac_f32_32x32x32_bf16 v[48:63], v[112:115], v[24:31], v132
    v_exp_f32 v2, v2
    v_exp_f32 v3, v3
    v_exp_f32 v4, v4
    v_mfma_f32_32x32x16_bf16 v[16:31], v[84:87], v[68:71], 0
    v_exp_f32 v5, v5
    v_exp_f32 v6, v6
    v_exp_f32 v7, v7
    v_exp_f32 v8, v8
    v_mfma_f32_32x32x8_bf16 v[16:31], v[96:97], v[74:75], v[16:31]
    v_exp_f32 v9, v9
    v_exp_f32 v10, v10
    v_exp_f32 v11, v11
    v_exp_f32 v12, v12
    v_smfmac_f32_32x32x32_bf16 v[32:47], v[116:119], v[0:7], v132
    v_exp_f32 v13, v13
    v_exp_f32 v14, v14
    v_exp_f32 v15, v15
    v_exp_f32 v16, v16
    v_exp_f32 v17, v17
    v_smfmac_f32_32x32x32_bf16 v[32:47], v[120:123], v[8:15], v132
    v_exp_f32 v18, v18
    v_exp_f32 v19, v19
    v_exp_f32 v20, v20
    v_mfma_f32_32x32x16_bf16 v[0:15], v[88:91], v[64:67], 0
    v_exp_f32 v21, v21
    v_exp_f32 v22, v22
    v_exp_f32 v23, v23
    v_exp_f32 v24, v24
    v_mfma_f32_32x32x8_bf16 v[0:15], v[98:99], v[72:73], v[0:15]
    v_exp_f32 v25, v25
    v_exp_f32 v26, v26
    v_exp_f32 v27, v27
    v_exp_f32 v28, v28
    v_smfmac_f32_32x32x32_bf16 v[48:63], v[116:119], v[16:23], v132
    v_exp_f32 v29, v29
    v_exp_f32 v30, v30
    v_exp_f32 v31, v31
    v_exp_f32 v0, v0
    v_exp_f32 v1, v1
    v_smfmac_f32_32x32x32_bf16 v[48:63], v[120:123], v[24:31], v132
    v_exp_f32 v2, v2
    v_exp_f32 v3, v3
    v_readfirstlane_b32 s54, v140
    v_exp_f32 v4, v4
    v_mfma_f32_32x32x16_bf16 v[16:31], v[88:91], v[68:71], 0
    v_exp_f32 v5, v5
    v_exp_f32 v6, v6
    v_exp_f32 v7, v7
    v_exp_f32 v8, v8
    v_mfma_f32_32x32x8_bf16 v[16:31], v[98:99], v[74:75], v[16:31]
    v_exp_f32 v9, v9
    v_exp_f32 v10, v10
    v_exp_f32 v11, v11
    v_exp_f32 v12, v12
    v_smfmac_f32_32x32x32_bf16 v[32:47], v[124:127], v[0:7], v132
    v_exp_f32 v13, v13
    v_exp_f32 v14, v14
    v_exp_f32 v15, v15
    v_exp_f32 v16, v16
    v_exp_f32 v17, v17
    v_smfmac_f32_32x32x32_bf16 v[32:47], v[128:131], v[8:15], v132
    v_exp_f32 v18, v18
    v_exp_f32 v19, v19
    v_exp_f32 v20, v20
    v_mfma_f32_32x32x16_bf16 v[0:15], v[188:191], v[64:67], 0
    v_exp_f32 v21, v21
    v_exp_f32 v22, v22
    v_exp_f32 v23, v23
    v_exp_f32 v24, v24
    v_mfma_f32_32x32x8_bf16 v[0:15], v[96:97], v[216:217], v[0:15]
    v_exp_f32 v25, v25
    v_exp_f32 v26, v26
    v_exp_f32 v27, v27
    v_exp_f32 v28, v28
    v_smfmac_f32_32x32x32_bf16 v[48:63], v[124:127], v[16:23], v132
    s_cmp_lt_u32 s54, 4
    s_cbranch_scc1 L_att_nr4
L_att_nrr4:
    v_exp_f32 v29, v29
    v_exp_f32 v30, v30
    v_exp_f32 v31, v31
    v_exp_f32 v0, v0
    v_exp_f32 v1, v1
    v_smfmac_f32_32x32x32_bf16 v[48:63], v[128:131], v[24:31], v132
    v_exp_f32 v2, v2
    v_exp_f32 v3, v3
    v_exp_f32 v4, v4
    v_mfma_f32_32x32x16_bf16 v[16:31], v[188:191], v[68:71], 0
    ds_read_b128 v[76:79], v133 offset:51200
    ds_read_b128 v[80:83], v133 offset:52224
    ds_read_b128 v[84:87], v133 offset:56320
    ds_read_b128 v[88:91], v133 offset:57344
    ds_read_b128 v[196:199], v220 offset:43008
    v_exp_f32 v5, v5
    v_exp_f32 v6, v6
    v_exp_f32 v7, v7
    v_exp_f32 v8, v8
    v_mfma_f32_32x32x8_bf16 v[16:31], v[96:97], v[218:219], v[16:31]
    v_exp_f32 v9, v9
    v_exp_f32 v10, v10
    v_exp_f32 v11, v11
    v_exp_f32 v12, v12
    v_smfmac_f32_32x32x32_bf16 v[32:47], v[200:203], v[0:7], v132
    s_mov_b64 exec, s[28:29]
    ds_read_b128 v[100:103], v134 offset:53760
    ds_read_b128 v[104:107], v134 offset:54400
    ds_read_b128 v[108:111], v134 offset:55040
    ds_read_b128 v[112:115], v134 offset:55680
    ds_read_b128 v[116:119], v134 offset:58880
    ds_read_b128 v[120:123], v134 offset:59520
    ds_read_b128 v[124:127], v134 offset:60160
    ds_read_b128 v[128:131], v134 offset:60800
    ds_write_b32 v136, v181
    s_mov_b64 exec, -1
    v_exp_f32 v13, v13
    v_exp_f32 v14, v14
    v_exp_f32 v15, v15
    v_exp_f32 v16, v16
    v_exp_f32 v17, v17
    v_smfmac_f32_32x32x32_bf16 v[32:47], v[204:207], v[8:15], v132
    v_exp_f32 v18, v18
    v_exp_f32 v19, v19
    v_exp_f32 v20, v20
    v_mfma_f32_32x32x16_bf16 v[0:15], v[192:195], v[64:67], 0
    v_exp_f32 v21, v21
    v_exp_f32 v22, v22
    v_exp_f32 v23, v23
    v_exp_f32 v24, v24
    v_mfma_f32_32x32x8_bf16 v[0:15], v[98:99], v[216:217], v[0:15]
    v_exp_f32 v25, v25
    v_exp_f32 v26, v26
    v_exp_f32 v27, v27
    v_exp_f32 v28, v28
    v_smfmac_f32_32x32x32_bf16 v[48:63], v[200:203], v[16:23], v132
    v_exp_f32 v29, v29
    v_exp_f32 v30, v30
    v_exp_f32 v31, v31
    v_exp_f32 v0, v0
    v_exp_f32 v1, v1
    v_smfmac_f32_32x32x32_bf16 v[48:63], v[204:207], v[24:31], v132
    v_exp_f32 v2, v2
    v_exp_f32 v3, v3
    v_exp_f32 v4, v4
    v_mfma_f32_32x32x16_bf16 v[16:31], v[192:195], v[68:71], 0
    v_exp_f32 v5, v5
    v_exp_f32 v6, v6
    v_exp_f32 v7, v7
    v_exp_f32 v8, v8
    v_mfma_f32_32x32x8_bf16 v[16:31], v[98:99], v[218:219], v[16:31]
    v_exp_f32 v9, v9
    v_exp_f32 v10, v10
    v_exp_f32 v11, v11
    v_exp_f32 v12, v12
    v_smfmac_f32_32x32x32_bf16 v[32:47], v[208:211], v[0:7], v132
    v_exp_f32 v13, v13
    v_exp_f32 v14, v14
    v_exp_f32 v15, v15
    v_exp_f32 v16, v16
    v_exp_f32 v17, v17
    v_smfmac_f32_32x32x32_bf16 v[32:47], v[212:215], v[8:15], v132
    s_waitcnt lgkmcnt(0)
    v_exp_f32 v18, v18
    v_exp_f32 v19, v19
    v_exp_f32 v20, v20
    v_mfma_f32_32x32x16_bf16 v[0:15], v[76:79], v[64:67], 0
    v_exp_f32 v21, v21
    v_exp_f32 v22, v22
    v_exp_f32 v23, v23
    v_exp_f32 v24, v24
    v_mfma_f32_32x32x8_bf16 v[0:15], v[196:197], v[72:73], v[0:15]
    v_exp_f32 v25, v25
    v_exp_f32 v26, v26
    v_exp_f32 v27, v27
    v_exp_f32 v28, v28
    v_smfmac_f32_32x32x32_bf16 v[48:63], v[208:211], v[16:23], v132
    v_exp_f32 v29, v29
    v_exp_f32 v30, v30
    v_exp_f32 v31, v31
    v_exp_f32 v0, v0
    v_exp_f32 v1, v1
    v_smfmac_f32_32x32x32_bf16 v[48:63], v[212:215], v[24:31], v132
    v_exp_f32 v2, v2
    v_exp_f32 v3, v3
    v_exp_f32 v4, v4
    v_mfma_f32_32x32x16_bf16 v[16:31], v[76:79], v[68:71], 0
    v_exp_f32 v5, v5
    v_exp_f32 v6, v6
    v_exp_f32 v7, v7
    v_exp_f32 v8, v8
    v_mfma_f32_32x32x8_bf16 v[16:31], v[196:197], v[74:75], v[16:31]
    v_exp_f32 v9, v9
    v_exp_f32 v10, v10
    v_exp_f32 v11, v11
    v_exp_f32 v12, v12
    v_smfmac_f32_32x32x32_bf16 v[32:47], v[100:103], v[0:7], v132
    v_exp_f32 v13, v13
    v_exp_f32 v14, v14
    v_exp_f32 v15, v15
    v_exp_f32 v16, v16
    v_exp_f32 v17, v17
    v_smfmac_f32_32x32x32_bf16 v[32:47], v[104:107], v[8:15], v132
    v_exp_f32 v18, v18
    v_exp_f32 v19, v19
    v_exp_f32 v20, v20
    v_mfma_f32_32x32x16_bf16 v[0:15], v[80:83], v[64:67], 0
    v_exp_f32 v21, v21
    v_exp_f32 v22, v22
    v_exp_f32 v23, v23
    v_exp_f32 v24, v24
    v_mfma_f32_32x32x8_bf16 v[0:15], v[198:199], v[72:73], v[0:15]
    v_exp_f32 v25, v25
    v_exp_f32 v26, v26
    v_exp_f32 v27, v27
    v_exp_f32 v28, v28
    v_smfmac_f32_32x32x32_bf16 v[48:63], v[100:103], v[16:23], v132
    v_exp_f32 v29, v29
    v_exp_f32 v30, v30
    v_exp_f32 v31, v31
    v_exp_f32 v0, v0
    v_exp_f32 v1, v1
    v_smfmac_f32_32x32x32_bf16 v[48:63], v[104:107], v[24:31], v132
    v_exp_f32 v2, v2
    v_exp_f32 v3, v3
    v_exp_f32 v4, v4
    v_mfma_f32_32x32x16_bf16 v[16:31], v[80:83], v[68:71], 0
    v_exp_f32 v5, v5
    v_exp_f32 v6, v6
    v_exp_f32 v7, v7
    v_exp_f32 v8, v8
    v_mfma_f32_32x32x8_bf16 v[16:31], v[198:199], v[74:75], v[16:31]
    v_exp_f32 v9, v9
    v_exp_f32 v10, v10
    v_exp_f32 v11, v11
    v_exp_f32 v12, v12
    v_smfmac_f32_32x32x32_bf16 v[32:47], v[108:111], v[0:7], v132
    v_exp_f32 v13, v13
    v_exp_f32 v14, v14
    v_exp_f32 v15, v15
    v_exp_f32 v16, v16
    v_exp_f32 v17, v17
    v_smfmac_f32_32x32x32_bf16 v[32:47], v[112:115], v[8:15], v132
    v_exp_f32 v18, v18
    v_exp_f32 v19, v19
    v_exp_f32 v20, v20
    v_mfma_f32_32x32x16_bf16 v[0:15], v[84:87], v[64:67], 0
    v_exp_f32 v21, v21
    v_exp_f32 v22, v22
    v_exp_f32 v23, v23
    v_exp_f32 v24, v24
    v_mfma_f32_32x32x8_bf16 v[0:15], v[196:197], v[216:217], v[0:15]
    v_exp_f32 v25, v25
    v_exp_f32 v26, v26
    v_exp_f32 v27, v27
    v_exp_f32 v28, v28
    v_smfmac_f32_32x32x32_bf16 v[48:63], v[108:111], v[16:23], v132
    v_exp_f32 v29, v29
    v_exp_f32 v30, v30
    v_exp_f32 v31, v31
    v_exp_f32 v0, v0
    v_exp_f32 v1, v1
    v_smfmac_f32_32x32x32_bf16 v[48:63], v[112:115], v[24:31], v132
    v_exp_f32 v2, v2
    v_exp_f32 v3, v3
    v_add_u32 v133, 61440, v133
    v_add_u32 v134, 61440, v134
    v_exp_f32 v4, v4
    v_mfma_f32_32x32x16_bf16 v[16:31], v[84:87], v[68:71], 0
    ds_read_b128 v[188:191], v133 offset:0
    ds_read_b128 v[192:195], v133 offset:1024
    ds_read_b128 v[76:79], v133 offset:5120
    ds_read_b128 v[80:83], v133 offset:6144
    ds_read_b128 v[92:95], v220 offset:53248
    v_exp_f32 v5, v5
    v_exp_f32 v6, v6
    v_exp_f32 v7, v7
    v_exp_f32 v8, v8
    v_mfma_f32_32x32x8_bf16 v[16:31], v[196:197], v[218:219], v[16:31]
    v_exp_f32 v9, v9
    v_exp_f32 v10, v10
    v_exp_f32 v11, v11
    v_exp_f32 v12, v12
    v_smfmac_f32_32x32x32_bf16 v[32:47], v[116:119], v[0:7], v132
    s_mov_b64 exec, s[28:29]
    ds_read_b128 v[200:203], v134 offset:2560
    ds_read_b128 v[204:207], v134 offset:3200
    ds_read_b128 v[208:211], v134 offset:3840
    ds_read_b128 v[212:215], v134 offset:4480
    ds_read_b128 v[100:103], v134 offset:7680
    ds_read_b128 v[104:107], v134 offset:8320
    ds_read_b128 v[108:111], v134 offset:8960
    ds_read_b128 v[112:115], v134 offset:9600
    s_mov_b64 exec, -1
    v_exp_f32 v13, v13
    v_exp_f32 v14, v14
    v_exp_f32 v15, v15
    v_exp_f32 v16, v16
    v_exp_f32 v17, v17
    v_smfmac_f32_32x32x32_bf16 v[32:47], v[120:123], v[8:15], v132
    v_exp_f32 v18, v18
    v_exp_f32 v19, v19
    v_exp_f32 v20, v20
    v_mfma_f32_32x32x16_bf16 v[0:15], v[88:91], v[64:67], 0
    v_exp_f32 v21, v21
    v_exp_f32 v22, v22
    v_exp_f32 v23, v23
    v_exp_f32 v24, v24
    v_mfma_f32_32x32x8_bf16 v[0:15], v[198:199], v[216:217], v[0:15]
    v_exp_f32 v25, v25
    v_exp_f32 v26, v26
    v_exp_f32 v27, v27
    v_exp_f32 v28, v28
    v_smfmac_f32_32x32x32_bf16 v[48:63], v[116:119], v[16:23], v132
    v_exp_f32 v29, v29
    v_exp_f32 v30, v30
    v_exp_f32 v31, v31
    v_exp_f32 v0, v0
    v_exp_f32 v1, v1
    v_smfmac_f32_32x32x32_bf16 v[48:63], v[120:123], v[24:31], v132
    v_exp_f32 v2, v2
    v_exp_f32 v3, v3
    v_exp_f32 v4, v4
    v_mfma_f32_32x32x16_bf16 v[16:31], v[88:91], v[68:71], 0
    ds_read_b32 v140, v138 offset:24
    v_exp_f32 v5, v5
    v_exp_f32 v6, v6
    v_exp_f32 v7, v7
    v_exp_f32 v8, v8
    v_mfma_f32_32x32x8_bf16 v[16:31], v[198:199], v[218:219], v[16:31]
    v_exp_f32 v9, v9
    v_exp_f32 v10, v10
    v_exp_f32 v11, v11
    v_exp_f32 v12, v12
    v_smfmac_f32_32x32x32_bf16 v[32:47], v[124:127], v[0:7], v132
    v_exp_f32 v13, v13
    v_exp_f32 v14, v14
    v_exp_f32 v15, v15
    v_exp_f32 v16, v16
    v_exp_f32 v17, v17
    v_smfmac_f32_32x32x32_bf16 v[32:47], v[128:131], v[8:15], v132
    s_waitcnt lgkmcnt(0)
    v_exp_f32 v18, v18
    v_exp_f32 v19, v19
    v_exp_f32 v20, v20
    v_mfma_f32_32x32x16_bf16 v[0:15], v[188:191], v[64:67], 0
    v_exp_f32 v21, v21
    v_exp_f32 v22, v22
    v_exp_f32 v23, v23
    v_exp_f32 v24, v24
    v_mfma_f32_32x32x8_bf16 v[0:15], v[92:93], v[72:73], v[0:15]
    v_exp_f32 v25, v25
    v_exp_f32 v26, v26
    v_exp_f32 v27, v27
    v_exp_f32 v28, v28
    v_smfmac_f32_32x32x32_bf16 v[48:63], v[124:127], v[16:23], v132
    v_exp_f32 v29, v29
    v_exp_f32 v30, v30
    v_exp_f32 v31, v31
    v_exp_f32 v0, v0
    v_exp_f32 v1, v1
    v_smfmac_f32_32x32x32_bf16 v[48:63], v[128:131], v[24:31], v132
    v_exp_f32 v2, v2
    v_exp_f32 v3, v3
    v_exp_f32 v4, v4
    v_mfma_f32_32x32x16_bf16 v[16:31], v[188:191], v[68:71], 0
    v_exp_f32 v5, v5
    v_exp_f32 v6, v6
    v_exp_f32 v7, v7
    v_exp_f32 v8, v8
    v_mfma_f32_32x32x8_bf16 v[16:31], v[92:93], v[74:75], v[16:31]
    v_exp_f32 v9, v9
    v_exp_f32 v10, v10
    v_exp_f32 v11, v11
    v_exp_f32 v12, v12
    v_smfmac_f32_32x32x32_bf16 v[32:47], v[200:203], v[0:7], v132
    v_exp_f32 v13, v13
    v_exp_f32 v14, v14
    v_exp_f32 v15, v15
    v_exp_f32 v16, v16
    v_exp_f32 v17, v17
    v_smfmac_f32_32x32x32_bf16 v[32:47], v[204:207], v[8:15], v132
    v_exp_f32 v18, v18
    v_exp_f32 v19, v19
    v_exp_f32 v20, v20
    v_mfma_f32_32x32x16_bf16 v[0:15], v[192:195], v[64:67], 0
    v_exp_f32 v21, v21
    v_exp_f32 v22, v22
    v_exp_f32 v23, v23
    v_exp_f32 v24, v24
    v_mfma_f32_32x32x8_bf16 v[0:15], v[94:95], v[72:73], v[0:15]
    v_exp_f32 v25, v25
    v_exp_f32 v26, v26
    v_exp_f32 v27, v27
    v_exp_f32 v28, v28
    v_smfmac_f32_32x32x32_bf16 v[48:63], v[200:203], v[16:23], v132
    v_exp_f32 v29, v29
    v_exp_f32 v30, v30
    v_exp_f32 v31, v31
    v_exp_f32 v0, v0
    v_exp_f32 v1, v1
    v_smfmac_f32_32x32x32_bf16 v[48:63], v[204:207], v[24:31], v132
    v_exp_f32 v2, v2
    v_exp_f32 v3, v3
    v_readfirstlane_b32 s54, v140
    v_exp_f32 v4, v4
    v_mfma_f32_32x32x16_bf16 v[16:31], v[192:195], v[68:71], 0
    v_exp_f32 v5, v5
    v_exp_f32 v6, v6
    v_exp_f32 v7, v7
    v_exp_f32 v8, v8
    v_mfma_f32_32x32x8_bf16 v[16:31], v[94:95], v[74:75], v[16:31]
    v_exp_f32 v9, v9
    v_exp_f32 v10, v10
    v_exp_f32 v11, v11
    v_exp_f32 v12, v12
    v_smfmac_f32_32x32x32_bf16 v[32:47], v[208:211], v[0:7], v132
    v_exp_f32 v13, v13
    v_exp_f32 v14, v14
    v_exp_f32 v15, v15
    v_exp_f32 v16, v16
    v_exp_f32 v17, v17
    v_smfmac_f32_32x32x32_bf16 v[32:47], v[212:215], v[8:15], v132
    v_exp_f32 v18, v18
    v_exp_f32 v19, v19
    v_exp_f32 v20, v20
    v_mfma_f32_32x32x16_bf16 v[0:15], v[76:79], v[64:67], 0
    v_exp_f32 v21, v21
    v_exp_f32 v22, v22
    v_exp_f32 v23, v23
    v_exp_f32 v24, v24
    v_mfma_f32_32x32x8_bf16 v[0:15], v[92:93], v[216:217], v[0:15]
    v_exp_f32 v25, v25
    v_exp_f32 v26, v26
    v_exp_f32 v27, v27
    v_exp_f32 v28, v28
    v_smfmac_f32_32x32x32_bf16 v[48:63], v[208:211], v[16:23], v132
    s_cmp_lt_u32 s54, 4
    s_cbranch_scc1 L_att_nr5
L_att_nrr5:
    v_exp_f32 v29, v29
    v_exp_f32 v30, v30
    v_exp_f32 v31, v31
    v_exp_f32 v0, v0
    v_exp_f32 v1, v1
    v_smfmac_f32_32x32x32_bf16 v[48:63], v[212:215], v[24:31], v132
    v_exp_f32 v2, v2
    v_exp_f32 v3, v3
    v_add_u32 v220, 61440, v220
    v_exp_f32 v4, v4
    v_mfma_f32_32x32x16_bf16 v[16:31], v[76:79], v[68:71], 0
    ds_read_b128 v[84:87], v133 offset:10240
    ds_read_b128 v[88:91], v133 offset:11264
    ds_read_b128 v[188:191], v133 offset:15360
    ds_read_b128 v[192:195], v133 offset:16384
    ds_read_b128 v[96:99], v220 offset:2048
    v_exp_f32 v5, v5
    v_exp_f32 v6, v6
    v_exp_f32 v7, v7
    v_exp_f32 v8, v8
    v_mfma_f32_32x32x8_bf16 v[16:31], v[92:93], v[218:219], v[16:31]
    v_exp_f32 v9, v9
    v_exp_f32 v10, v10
    v_exp_f32 v11, v11
    v_exp_f32 v12, v12
    v_smfmac_f32_32x32x32_bf16 v[32:47], v[100:103], v[0:7], v132
    s_mov_b64 exec, s[28:29]
    ds_read_b128 v[116:119], v134 offset:12800
    ds_read_b128 v[120:123], v134 offset:13440
    ds_read_b128 v[124:127], v134 offset:14080
    ds_read_b128 v[128:131], v134 offset:14720
    ds_read_b128 v[200:203], v134 offset:17920
    ds_read_b128 v[204:207], v134 offset:18560
    ds_read_b128 v[208:211], v134 offset:19200
    ds_read_b128 v[212:215], v134 offset:19840
    ds_write_b32 v136, v182
    s_mov_b64 exec, -1
    v_exp_f32 v13, v13
    v_exp_f32 v14, v14
    v_exp_f32 v15, v15
    v_exp_f32 v16, v16
    v_exp_f32 v17, v17
    v_smfmac_f32_32x32x32_bf16 v[32:47], v[104:107], v[8:15], v132
    v_exp_f32 v18, v18
    v_exp_f32 v19, v19
    v_exp_f32 v20, v20
    v_mfma_f32_32x32x16_bf16 v[0:15], v[80:83], v[64:67], 0
    v_exp_f32 v21, v21
    v_exp_f32 v22, v22
    v_exp_f32 v23, v23
    v_exp_f32 v24, v24
    v_mfma_f32_32x32x8_bf16 v[0:15], v[94:95], v[216:217], v[0:15]
    v_exp_f32 v25, v25
    v_exp_f32 v26, v26
    v_exp_f32 v27, v27
    v_exp_f32 v28, v28
    v_smfmac_f32_32x32x32_bf16 v[48:63], v[100:103], v[16:23], v132
    v_exp_f32 v29, v29
    v_exp_f32 v30, v30
    v_exp_f32 v31, v31
    v_exp_f32 v0, v0
    v_exp_f32 v1, v1
    v_smfmac_f32_32x32x32_bf16 v[48:63], v[104:107], v[24:31], v132
    v_exp_f32 v2, v2
    v_exp_f32 v3, v3
    v_exp_f32 v4, v4
    v_mfma_f32_32x32x16_bf16 v[16:31], v[80:83], v[68:71], 0
    v_exp_f32 v5, v5
    v_exp_f32 v6, v6
    v_exp_f32 v7, v7
    v_exp_f32 v8, v8
    v_mfma_f32_32x32x8_bf16 v[16:31], v[94:95], v[218:219], v[16:31]
    v_exp_f32 v9, v9
    v_exp_f32 v10, v10
    v_exp_f32 v11, v11
    v_exp_f32 v12, v12
    v_smfmac_f32_32x32x32_bf16 v[32:47], v[108:111], v[0:7], v132
    v_exp_f32 v13, v13
    v_exp_f32 v14, v14
    v_exp_f32 v15, v15
    v_exp_f32 v16, v16
    v_exp_f32 v17, v17
    v_smfmac_f32_32x32x32_bf16 v[32:47], v[112:115], v[8:15], v132
    s_waitcnt lgkmcnt(0)
    v_exp_f32 v18, v18
    v_exp_f32 v19, v19
    v_exp_f32 v20, v20
    v_mfma_f32_32x32x16_bf16 v[0:15], v[84:87], v[64:67], 0
    v_exp_f32 v21, v21
    v_exp_f32 v22, v22
    v_exp_f32 v23, v23
    v_exp_f32 v24, v24
    v_mfma_f32_32x32x8_bf16 v[0:15], v[96:97], v[72:73], v[0:15]
    v_exp_f32 v25, v25
    v_exp_f32 v26, v26
    v_exp_f32 v27, v27
    v_exp_f32 v28, v28
    v_smfmac_f32_32x32x32_bf16 v[48:63], v[108:111], v[16:23], v132
    v_exp_f32 v29, v29
    v_exp_f32 v30, v30
    v_exp_f32 v31, v31
    v_exp_f32 v0, v0
    v_exp_f32 v1, v1
    v_smfmac_f32_32x32x32_bf16 v[48:63], v[112:115], v[24:31], v132
    v_exp_f32 v2, v2
    v_exp_f32 v3, v3
    v_exp_f32 v4, v4
    v_mfma_f32_32x32x16_bf16 v[16:31], v[84:87], v[68:71], 0
    v_exp_f32 v5, v5
    v_exp_f32 v6, v6
    v_exp_f32 v7, v7
    v_exp_f32 v8, v8
    v_mfma_f32_32x32x8_bf16 v[16:31], v[96:97], v[74:75], v[16:31]
    v_exp_f32 v9, v9
    v_exp_f32 v10, v10
    v_exp_f32 v11, v11
    v_exp_f32 v12, v12
    v_smfmac_f32_32x32x32_bf16 v[32:47], v[116:119], v[0:7], v132
    v_exp_f32 v13, v13
    v_exp_f32 v14, v14
    v_exp_f32 v15, v15
    v_exp_f32 v16, v16
    v_exp_f32 v17, v17
    v_smfmac_f32_32x32x32_bf16 v[32:47], v[120:123], v[8:15], v132
    v_exp_f32 v18, v18
    v_exp_f32 v19, v19
    v_exp_f32 v20, v20
    v_mfma_f32_32x32x16_bf16 v[0:15], v[88:91], v[64:67], 0
    v_exp_f32 v21, v21
    v_exp_f32 v22, v22
    v_exp_f32 v23, v23
    v_exp_f32 v24, v24
    v_mfma_f32_32x32x8_bf16 v[0:15], v[98:99], v[72:73], v[0:15]
    v_exp_f32 v25, v25
    v_exp_f32 v26, v26
    v_exp_f32 v27, v27
    v_exp_f32 v28, v28
    v_smfmac_f32_32x32x32_bf16 v[48:63], v[116:119], v[16:23], v132
    v_exp_f32 v29, v29
    v_exp_f32 v30, v30
    v_exp_f32 v31, v31
    v_exp_f32 v0, v0
    v_exp_f32 v1, v1
    v_smfmac_f32_32x32x32_bf16 v[48:63], v[120:123], v[24:31], v132
    v_exp_f32 v2, v2
    v_exp_f32 v3, v3
    v_exp_f32 v4, v4
    v_mfma_f32_32x32x16_bf16 v[16:31], v[88:91], v[68:71], 0
    v_exp_f32 v5, v5
    v_exp_f32 v6, v6
    v_exp_f32 v7, v7
    v_exp_f32 v8, v8
    v_mfma_f32_32x32x8_bf16 v[16:31], v[98:99], v[74:75], v[16:31]
    v_exp_f32 v9, v9
    v_exp_f32 v10, v10
    v_exp_f32 v11, v11
    v_exp_f32 v12, v12
    v_smfmac_f32_32x32x32_bf16 v[32:47], v[124:127], v[0:7], v132
    v_exp_f32 v13, v13
    v_exp_f32 v14, v14
    v_exp_f32 v15, v15
    v_exp_f32 v16, v16
    v_exp_f32 v17, v17
    v_smfmac_f32_32x32x32_bf16 v[32:47], v[128:131], v[8:15], v132
    v_exp_f32 v18, v18
    v_exp_f32 v19, v19
    v_exp_f32 v20, v20
    v_mfma_f32_32x32x16_bf16 v[0:15], v[188:191], v[64:67], 0
    v_exp_f32 v21, v21
    v_exp_f32 v22, v22
    v_exp_f32 v23, v23
    v_exp_f32 v24, v24
    v_mfma_f32_32x32x8_bf16 v[0:15], v[96:97], v[216:217], v[0:15]
    v_exp_f32 v25, v25
    v_exp_f32 v26, v26
    v_exp_f32 v27, v27
    v_exp_f32 v28, v28
    v_smfmac_f32_32x32x32_bf16 v[48:63], v[124:127], v[16:23], v132
    v_exp_f32 v29, v29
    v_exp_f32 v30, v30
    v_exp_f32 v31, v31
    v_exp_f32 v0, v0
    v_exp_f32 v1, v1
    v_smfmac_f32_32x32x32_bf16 v[48:63], v[128:131], v[24:31], v132
    v_exp_f32 v2, v2
    v_exp_f32 v3, v3
    v_exp_f32 v4, v4
    v_mfma_f32_32x32x16_bf16 v[16:31], v[188:191], v[68:71], 0
    ds_read_b128 v[76:79], v133 offset:20480
    ds_read_b128 v[80:83], v133 offset:21504
    ds_read_b128 v[196:199], v133 offset:22528
    v_add_u32 v133, 4294849536, v133
    ds_read_b128 v[84:87], v133 offset:0
    ds_read_b128 v[88:91], v133 offset:1024
    ds_read_b128 v[92:95], v133 offset:2048
    v_exp_f32 v5, v5
    v_exp_f32 v6, v6
    v_exp_f32 v7, v7
    v_exp_f32 v8, v8
    v_mfma_f32_32x32x8_bf16 v[16:31], v[96:97], v[218:219], v[16:31]
    v_exp_f32 v9, v9
    v_exp_f32 v10, v10
    v_exp_f32 v11, v11
    v_exp_f32 v12, v12
    v_smfmac_f32_32x32x32_bf16 v[32:47], v[200:203], v[0:7], v132
    s_mov_b64 exec, s[28:29]
    ds_read_b128 v[100:103], v134 offset:23040
    ds_read_b128 v[104:107], v134 offset:23680
    ds_read_b128 v[108:111], v134 offset:24320
    ds_read_b128 v[112:115], v134 offset:24960
    v_add_u32 v134, 4294849536, v134
    ds_read_b128 v[116:119], v134 offset:2560
    ds_read_b128 v[120:123], v134 offset:3200
    ds_read_b128 v[124:127], v134 offset:3840
    ds_read_b128 v[128:131], v134 offset:4480
    s_mov_b64 exec, -1
    v_exp_f32 v13, v13
    v_exp_f32 v14, v14
    v_exp_f32 v15, v15
    v_exp_f32 v16, v16
    v_exp_f32 v17, v17
    v_smfmac_f32_32x32x32_bf16 v[32:47], v[204:207], v[8:15], v132
    v_exp_f32 v18, v18
    v_exp_f32 v19, v19
    v_exp_f32 v20, v20
    v_mfma_f32_32x32x16_bf16 v[0:15], v[192:195], v[64:67], 0
    v_exp_f32 v21, v21
    v_exp_f32 v22, v22
    v_exp_f32 v23, v23
    v_exp_f32 v24, v24
    v_mfma_f32_32x32x8_bf16 v[0:15], v[98:99], v[216:217], v[0:15]
    v_exp_f32 v25, v25
    v_exp_f32 v26, v26
    v_exp_f32 v27, v27
    v_exp_f32 v28, v28
    v_smfmac_f32_32x32x32_bf16 v[48:63], v[200:203], v[16:23], v132
    v_exp_f32 v29, v29
    v_exp_f32 v30, v30
    v_exp_f32 v31, v31
    v_exp_f32 v0, v0
    v_exp_f32 v1, v1
    v_smfmac_f32_32x32x32_bf16 v[48:63], v[204:207], v[24:31], v132
    v_exp_f32 v2, v2
    v_exp_f32 v3, v3
    v_exp_f32 v4, v4
    v_mfma_f32_32x32x16_bf16 v[16:31], v[192:195], v[68:71], 0
    ds_read_b32 v140, v138 offset:28
    v_exp_f32 v5, v5
    v_exp_f32 v6, v6
    v_exp_f32 v7, v7
    v_exp_f32 v8, v8
    v_mfma_f32_32x32x8_bf16 v[16:31], v[98:99], v[218:219], v[16:31]
    v_exp_f32 v9, v9
    v_exp_f32 v10, v10
    v_exp_f32 v11, v11
    v_exp_f32 v12, v12
    v_smfmac_f32_32x32x32_bf16 v[32:47], v[208:211], v[0:7], v132
    v_exp_f32 v13, v13
    v_exp_f32 v14, v14
    v_exp_f32 v15, v15
    v_exp_f32 v16, v16
    v_exp_f32 v17, v17
    v_smfmac_f32_32x32x32_bf16 v[32:47], v[212:215], v[8:15], v132
    s_waitcnt lgkmcnt(0)
    v_exp_f32 v18, v18
    v_exp_f32 v19, v19
    v_exp_f32 v20, v20
    v_mfma_f32_32x32x16_bf16 v[0:15], v[76:79], v[64:67], 0
    v_exp_f32 v21, v21
    v_exp_f32 v22, v22
    v_exp_f32 v23, v23
    v_exp_f32 v24, v24
    v_mfma_f32_32x32x8_bf16 v[0:15], v[196:197], v[72:73], v[0:15]
    v_exp_f32 v25, v25
    v_exp_f32 v26, v26
    v_exp_f32 v27, v27
    v_exp_f32 v28, v28
    v_smfmac_f32_32x32x32_bf16 v[48:63], v[208:211], v[16:23], v132
    v_exp_f32 v29, v29
    v_exp_f32 v30, v30
    v_exp_f32 v31, v31
    v_exp_f32 v0, v0
    v_exp_f32 v1, v1
    v_smfmac_f32_32x32x32_bf16 v[48:63], v[212:215], v[24:31], v132
    v_exp_f32 v2, v2
    v_exp_f32 v3, v3
    v_exp_f32 v4, v4
    v_mfma_f32_32x32x16_bf16 v[16:31], v[76:79], v[68:71], 0
    v_exp_f32 v5, v5
    v_exp_f32 v6, v6
    v_exp_f32 v7, v7
    v_exp_f32 v8, v8
    v_mfma_f32_32x32x8_bf16 v[16:31], v[196:197], v[74:75], v[16:31]
    v_exp_f32 v9, v9
    v_exp_f32 v10, v10
    v_exp_f32 v11, v11
    v_exp_f32 v12, v12
    v_smfmac_f32_32x32x32_bf16 v[32:47], v[100:103], v[0:7], v132
    v_exp_f32 v13, v13
    v_exp_f32 v14, v14
    v_exp_f32 v15, v15
    v_exp_f32 v16, v16
    v_exp_f32 v17, v17
    v_smfmac_f32_32x32x32_bf16 v[32:47], v[104:107], v[8:15], v132
    v_exp_f32 v18, v18
    v_exp_f32 v19, v19
    v_exp_f32 v20, v20
    v_mfma_f32_32x32x16_bf16 v[0:15], v[80:83], v[64:67], 0
    v_exp_f32 v21, v21
    v_exp_f32 v22, v22
    v_exp_f32 v23, v23
    v_exp_f32 v24, v24
    v_mfma_f32_32x32x8_bf16 v[0:15], v[198:199], v[72:73], v[0:15]
    v_exp_f32 v25, v25
    v_exp_f32 v26, v26
    v_exp_f32 v27, v27
    v_exp_f32 v28, v28
    v_smfmac_f32_32x32x32_bf16 v[48:63], v[100:103], v[16:23], v132
    v_exp_f32 v29, v29
    v_exp_f32 v30, v30
    v_exp_f32 v31, v31
    v_exp_f32 v0, v0
    v_exp_f32 v1, v1
    v_smfmac_f32_32x32x32_bf16 v[48:63], v[104:107], v[24:31], v132
    v_exp_f32 v2, v2
    v_exp_f32 v3, v3
    v_readfirstlane_b32 s54, v140
    v_exp_f32 v4, v4
    v_mfma_f32_32x32x16_bf16 v[16:31], v[80:83], v[68:71], 0
    v_exp_f32 v5, v5
    v_exp_f32 v6, v6
    v_exp_f32 v7, v7
    v_exp_f32 v8, v8
    v_mfma_f32_32x32x8_bf16 v[16:31], v[198:199], v[74:75], v[16:31]
    v_exp_f32 v9, v9
    v_exp_f32 v10, v10
    v_exp_f32 v11, v11
    v_exp_f32 v12, v12
    v_smfmac_f32_32x32x32_bf16 v[32:47], v[108:111], v[0:7], v132
    v_exp_f32 v13, v13
    v_exp_f32 v14, v14
    v_exp_f32 v15, v15
    v_exp_f32 v16, v16
    v_exp_f32 v17, v17
    v_smfmac_f32_32x32x32_bf16 v[32:47], v[112:115], v[8:15], v132
    v_exp_f32 v18, v18
    v_exp_f32 v19, v19
    v_exp_f32 v20, v20
    v_mfma_f32_32x32x16_bf16 v[0:15], v[84:87], v[64:67], 0
    v_exp_f32 v21, v21
    v_exp_f32 v22, v22
    v_exp_f32 v23, v23
    v_exp_f32 v24, v24
    v_mfma_f32_32x32x8_bf16 v[0:15], v[92:93], v[72:73], v[0:15]
    v_exp_f32 v25, v25
    v_exp_f32 v26, v26
    v_exp_f32 v27, v27
    v_exp_f32 v28, v28
    v_smfmac_f32_32x32x32_bf16 v[48:63], v[108:111], v[16:23], v132
    s_cmp_lt_u32 s54, 4
    s_cbranch_scc1 L_att_nr6
L_att_nrr6:
    v_exp_f32 v29, v29
    v_exp_f32 v30, v30
    v_exp_f32 v31, v31
    v_exp_f32 v0, v0
    v_exp_f32 v1, v1
    v_smfmac_f32_32x32x32_bf16 v[48:63], v[112:115], v[24:31], v132
    v_exp_f32 v2, v2
    v_exp_f32 v3, v3
    v_add_u32 v220, 4294844416, v220
    v_exp_f32 v4, v4
    v_mfma_f32_32x32x16_bf16 v[16:31], v[84:87], v[68:71], 0
    ds_read_b128 v[188:191], v133 offset:5120
    ds_read_b128 v[192:195], v133 offset:6144
    ds_read_b128 v[76:79], v133 offset:10240
    ds_read_b128 v[80:83], v133 offset:11264
    ds_read_b128 v[96:99], v220 offset:2048
    v_exp_f32 v5, v5
    v_exp_f32 v6, v6
    v_exp_f32 v7, v7
    v_exp_f32 v8, v8
    v_mfma_f32_32x32x8_bf16 v[16:31], v[92:93], v[74:75], v[16:31]
    v_exp_f32 v9, v9
    v_exp_f32 v10, v10
    v_exp_f32 v11, v11
    v_exp_f32 v12, v12
    v_smfmac_f32_32x32x32_bf16 v[32:47], v[116:119], v[0:7], v132
    s_mov_b64 exec, s[28:29]
    ds_read_b128 v[200:203], v134 offset:7680
    ds_read_b128 v[204:207], v134 offset:8320
    ds_read_b128 v[208:211], v134 offset:8960
    ds_read_b128 v[212:215], v134 offset:9600
    ds_read_b128 v[100:103], v134 offset:12800
    ds_read_b128 v[104:107], v134 offset:13440
    ds_read_b128 v[108:111], v134 offset:14080
    ds_read_b128 v[112:115], v134 offset:14720
    s_mov_b64 exec, -1
    v_exp_f32 v13, v13
    v_exp_f32 v14, v14
    v_exp_f32 v15, v15
    v_exp_f32 v16, v16
    v_exp_f32 v17, v17
    v_smfmac_f32_32x32x32_bf16 v[32:47], v[120:123], v[8:15], v132
    v_exp_f32 v18, v18
    v_exp_f32 v19, v19
    v_exp_f32 v20, v20
    v_mfma_f32_32x32x16_bf16 v[0:15], v[88:91], v[64:67], 0
    v_exp_f32 v21, v21
    v_exp_f32 v22, v22
    v_exp_f32 v23, v23
    v_exp_f32 v24, v24
    v_mfma_f32_32x32x8_bf16 v[0:15], v[94:95], v[72:73], v[0:15]
    v_exp_f32 v25, v25
    v_exp_f32 v26, v26
    v_exp_f32 v27, v27
    v_exp_f32 v28, v28
    v_smfmac_f32_32x32x32_bf16 v[48:63], v[116:119], v[16:23], v132
    v_exp_f32 v29, v29
    v_exp_f32 v30, v30
    v_exp_f32 v31, v31
    v_exp_f32 v0, v0
    v_exp_f32 v1, v1
    v_smfmac_f32_32x32x32_bf16 v[48:63], v[120:123], v[24:31], v132
    v_exp_f32 v2, v2
    v_exp_f32 v3, v3
    v_exp_f32 v4, v4
    v_mfma_f32_32x32x16_bf16 v[16:31], v[88:91], v[68:71], 0
    v_exp_f32 v5, v5
    v_exp_f32 v6, v6
    v_exp_f32 v7, v7
    v_exp_f32 v8, v8
    v_mfma_f32_32x32x8_bf16 v[16:31], v[94:95], v[74:75], v[16:31]
    v_exp_f32 v9, v9
    v_exp_f32 v10, v10
    v_exp_f32 v11, v11
    v_exp_f32 v12, v12
    v_smfmac_f32_32x32x32_bf16 v[32:47], v[124:127], v[0:7], v132
    v_exp_f32 v13, v13
    v_exp_f32 v14, v14
    v_exp_f32 v15, v15
    v_exp_f32 v16, v16
    v_exp_f32 v17, v17
    v_smfmac_f32_32x32x32_bf16 v[32:47], v[128:131], v[8:15], v132
    s_waitcnt lgkmcnt(0)
    v_exp_f32 v18, v18
    v_exp_f32 v19, v19
    v_exp_f32 v20, v20
    v_mfma_f32_32x32x16_bf16 v[0:15], v[188:191], v[64:67], 0
    v_exp_f32 v21, v21
    v_exp_f32 v22, v22
    v_exp_f32 v23, v23
    v_exp_f32 v24, v24
    v_mfma_f32_32x32x8_bf16 v[0:15], v[96:97], v[72:73], v[0:15]
    v_exp_f32 v25, v25
    v_exp_f32 v26, v26
    v_exp_f32 v27, v27
    v_exp_f32 v28, v28
    v_smfmac_f32_32x32x32_bf16 v[48:63], v[124:127], v[16:23], v132
    v_exp_f32 v29, v29
    v_exp_f32 v30, v30
    v_exp_f32 v31, v31
    v_exp_f32 v0, v0
    v_exp_f32 v1, v1
    v_smfmac_f32_32x32x32_bf16 v[48:63], v[128:131], v[24:31], v132
    v_exp_f32 v2, v2
    v_exp_f32 v3, v3
    v_exp_f32 v4, v4
    v_mfma_f32_32x32x16_bf16 v[16:31], v[188:191], v[68:71], 0
    v_exp_f32 v5, v5
    v_exp_f32 v6, v6
    v_exp_f32 v7, v7
    v_exp_f32 v8, v8
    v_mfma_f32_32x32x8_bf16 v[16:31], v[96:97], v[74:75], v[16:31]
    v_exp_f32 v9, v9
    v_exp_f32 v10, v10
    v_exp_f32 v11, v11
    v_exp_f32 v12, v12
    v_smfmac_f32_32x32x32_bf16 v[32:47], v[200:203], v[0:7], v132
    v_exp_f32 v13, v13
    v_exp_f32 v14, v14
    v_exp_f32 v15, v15
    v_exp_f32 v16, v16
    v_exp_f32 v17, v17
    v_smfmac_f32_32x32x32_bf16 v[32:47], v[204:207], v[8:15], v132
    v_exp_f32 v18, v18
    v_exp_f32 v19, v19
    v_exp_f32 v20, v20
    v_mfma_f32_32x32x16_bf16 v[0:15], v[192:195], v[64:67], 0
    v_exp_f32 v21, v21
    v_exp_f32 v22, v22
    v_exp_f32 v23, v23
    v_exp_f32 v24, v24
    v_mfma_f32_32x32x8_bf16 v[0:15], v[98:99], v[72:73], v[0:15]
    v_exp_f32 v25, v25
    v_exp_f32 v26, v26
    v_exp_f32 v27, v27
    v_exp_f32 v28, v28
    v_smfmac_f32_32x32x32_bf16 v[48:63], v[200:203], v[16:23], v132
    v_exp_f32 v29, v29
    v_exp_f32 v30, v30
    v_exp_f32 v31, v31
    v_exp_f32 v0, v0
    v_exp_f32 v1, v1
    v_smfmac_f32_32x32x32_bf16 v[48:63], v[204:207], v[24:31], v132
    v_exp_f32 v2, v2
    v_exp_f32 v3, v3
    v_exp_f32 v4, v4
    v_mfma_f32_32x32x16_bf16 v[16:31], v[192:195], v[68:71], 0
    v_exp_f32 v5, v5
    v_exp_f32 v6, v6
    v_exp_f32 v7, v7
    v_exp_f32 v8, v8
    v_mfma_f32_32x32x8_bf16 v[16:31], v[98:99], v[74:75], v[16:31]
    v_exp_f32 v9, v9
    v_exp_f32 v10, v10
    v_exp_f32 v11, v11
    v_exp_f32 v12, v12
    v_smfmac_f32_32x32x32_bf16 v[32:47], v[208:211], v[0:7], v132
    v_exp_f32 v13, v13
    v_exp_f32 v14, v14
    v_exp_f32 v15, v15
    v_exp_f32 v16, v16
    v_exp_f32 v17, v17
    v_smfmac_f32_32x32x32_bf16 v[32:47], v[212:215], v[8:15], v132
    v_exp_f32 v18, v18
    v_exp_f32 v19, v19
    v_exp_f32 v20, v20
    v_mfma_f32_32x32x16_bf16 v[0:15], v[76:79], v[64:67], 0
    v_exp_f32 v21, v21
    v_exp_f32 v22, v22
    v_exp_f32 v23, v23
    v_exp_f32 v24, v24
    v_mfma_f32_32x32x8_bf16 v[0:15], v[96:97], v[216:217], v[0:15]
    v_exp_f32 v25, v25
    v_exp_f32 v26, v26
    v_exp_f32 v27, v27
    v_exp_f32 v28, v28
    v_smfmac_f32_32x32x32_bf16 v[48:63], v[208:211], v[16:23], v132
    v_exp_f32 v29, v29
    v_exp_f32 v30, v30
    v_exp_f32 v31, v31
    v_exp_f32 v0, v0
    v_exp_f32 v1, v1
    v_smfmac_f32_32x32x32_bf16 v[48:63], v[212:215], v[24:31], v132
    v_exp_f32 v2, v2
    v_exp_f32 v3, v3
    v_exp_f32 v4, v4
    v_mfma_f32_32x32x16_bf16 v[16:31], v[76:79], v[68:71], 0
    ds_read_b128 v[84:87], v133 offset:15360
    ds_read_b128 v[88:91], v133 offset:16384
    ds_read_b128 v[196:199], v133 offset:17408
    v_exp_f32 v5, v5
    v_exp_f32 v6, v6
    v_exp_f32 v7, v7
    v_exp_f32 v8, v8
    v_mfma_f32_32x32x8_bf16 v[16:31], v[96:97], v[218:219], v[16:31]
    v_exp_f32 v9, v9
    v_exp_f32 v10, v10
    v_exp_f32 v11, v11
    v_exp_f32 v12, v12
    v_smfmac_f32_32x32x32_bf16 v[32:47], v[100:103], v[0:7], v132
    s_mov_b64 exec, s[28:29]
    ds_read_b128 v[116:119], v134 offset:17920
    ds_read_b128 v[120:123], v134 offset:18560
    ds_read_b128 v[124:127], v134 offset:19200
    ds_read_b128 v[128:131], v134 offset:19840
    s_mov_b64 exec, -1
    v_exp_f32 v13, v13
    v_exp_f32 v14, v14
    v_exp_f32 v15, v15
    v_exp_f32 v16, v16
    v_exp_f32 v17, v17
    v_smfmac_f32_32x32x32_bf16 v[32:47], v[104:107], v[8:15], v132
    v_exp_f32 v18, v18
    v_exp_f32 v19, v19
    v_exp_f32 v20, v20
    v_mfma_f32_32x32x16_bf16 v[0:15], v[80:83], v[64:67], 0
    v_exp_f32 v21, v21
    v_exp_f32 v22, v22
    v_exp_f32 v23, v23
    v_exp_f32 v24, v24
    v_mfma_f32_32x32x8_bf16 v[0:15], v[98:99], v[216:217], v[0:15]
    v_exp_f32 v25, v25
    v_exp_f32 v26, v26
    v_exp_f32 v27, v27
    v_exp_f32 v28, v28
    v_smfmac_f32_32x32x32_bf16 v[48:63], v[100:103], v[16:23], v132
    v_exp_f32 v29, v29
    v_exp_f32 v30, v30
    v_exp_f32 v31, v31
    v_exp_f32 v0, v0
    v_exp_f32 v1, v1
    v_smfmac_f32_32x32x32_bf16 v[48:63], v[104:107], v[24:31], v132
    v_exp_f32 v2, v2
    v_exp_f32 v3, v3
    v_exp_f32 v4, v4
    v_mfma_f32_32x32x16_bf16 v[16:31], v[80:83], v[68:71], 0
    v_exp_f32 v5, v5
    v_exp_f32 v6, v6
    v_exp_f32 v7, v7
    v_exp_f32 v8, v8
    v_mfma_f32_32x32x8_bf16 v[16:31], v[98:99], v[218:219], v[16:31]
    v_exp_f32 v9, v9
    v_exp_f32 v10, v10
    v_exp_f32 v11, v11
    v_exp_f32 v12, v12
    v_smfmac_f32_32x32x32_bf16 v[32:47], v[108:111], v[0:7], v132
    v_exp_f32 v13, v13
    v_exp_f32 v14, v14
    v_exp_f32 v15, v15
    v_exp_f32 v16, v16
    v_exp_f32 v17, v17
    v_smfmac_f32_32x32x32_bf16 v[32:47], v[112:115], v[8:15], v132
    s_waitcnt lgkmcnt(0)
    v_exp_f32 v18, v18
    v_exp_f32 v19, v19
    v_exp_f32 v20, v20
    v_mfma_f32_32x32x16_bf16 v[0:15], v[84:87], v[64:67], 0
    v_exp_f32 v21, v21
    v_exp_f32 v22, v22
    v_exp_f32 v23, v23
    v_exp_f32 v24, v24
    v_mfma_f32_32x32x8_bf16 v[0:15], v[196:197], v[72:73], v[0:15]
    v_exp_f32 v25, v25
    v_exp_f32 v26, v26
    v_exp_f32 v27, v27
    v_exp_f32 v28, v28
    v_smfmac_f32_32x32x32_bf16 v[48:63], v[108:111], v[16:23], v132
    v_exp_f32 v29, v29
    v_exp_f32 v30, v30
    v_exp_f32 v31, v31
    v_exp_f32 v0, v0
    v_exp_f32 v1, v1
    v_smfmac_f32_32x32x32_bf16 v[48:63], v[112:115], v[24:31], v132
    v_exp_f32 v2, v2
    v_exp_f32 v3, v3
    v_exp_f32 v4, v4
    v_mfma_f32_32x32x16_bf16 v[16:31], v[84:87], v[68:71], 0
    v_exp_f32 v5, v5
    v_exp_f32 v6, v6
    v_exp_f32 v7, v7
    v_exp_f32 v8, v8
    v_mfma_f32_32x32x8_bf16 v[16:31], v[196:197], v[74:75], v[16:31]
    v_exp_f32 v9, v9
    v_exp_f32 v10, v10
    v_exp_f32 v11, v11
    v_exp_f32 v12, v12
    v_smfmac_f32_32x32x32_bf16 v[32:47], v[116:119], v[0:7], v132
    v_exp_f32 v13, v13
    v_exp_f32 v14, v14
    v_exp_f32 v15, v15
    v_exp_f32 v16, v16
    v_exp_f32 v17, v17
    v_smfmac_f32_32x32x32_bf16 v[32:47], v[120:123], v[8:15], v132
    v_exp_f32 v18, v18
    v_exp_f32 v19, v19
    v_exp_f32 v20, v20
    v_mfma_f32_32x32x16_bf16 v[0:15], v[88:91], v[64:67], 0
    v_exp_f32 v21, v21
    v_exp_f32 v22, v22
    v_exp_f32 v23, v23
    v_exp_f32 v24, v24
    v_mfma_f32_32x32x8_bf16 v[0:15], v[198:199], v[72:73], v[0:15]
    v_exp_f32 v25, v25
    v_exp_f32 v26, v26
    v_exp_f32 v27, v27
    v_exp_f32 v28, v28
    v_smfmac_f32_32x32x32_bf16 v[48:63], v[116:119], v[16:23], v132
    v_exp_f32 v29, v29
    v_exp_f32 v30, v30
    v_exp_f32 v31, v31
    v_exp_f32 v0, v0
    v_exp_f32 v1, v1
    v_smfmac_f32_32x32x32_bf16 v[48:63], v[120:123], v[24:31], v132
    v_exp_f32 v2, v2
    v_exp_f32 v3, v3
    v_exp_f32 v4, v4
    v_mfma_f32_32x32x16_bf16 v[16:31], v[88:91], v[68:71], 0
    v_exp_f32 v5, v5
    v_exp_f32 v6, v6
    v_exp_f32 v7, v7
    v_exp_f32 v8, v8
    v_mfma_f32_32x32x8_bf16 v[16:31], v[198:199], v[74:75], v[16:31]
    v_exp_f32 v9, v9
    v_exp_f32 v10, v10
    v_exp_f32 v11, v11
    v_exp_f32 v12, v12
    v_smfmac_f32_32x32x32_bf16 v[32:47], v[124:127], v[0:7], v132
    v_exp_f32 v13, v13
    v_exp_f32 v14, v14
    v_exp_f32 v15, v15
    v_exp_f32 v16, v16
    v_exp_f32 v17, v17
    v_smfmac_f32_32x32x32_bf16 v[32:47], v[128:131], v[8:15], v132
    v_exp_f32 v18, v18
    v_exp_f32 v19, v19
    v_exp_f32 v20, v20
    v_exp_f32 v21, v21
    v_exp_f32 v22, v22
    v_exp_f32 v23, v23
    v_exp_f32 v24, v24
    v_exp_f32 v25, v25
    v_exp_f32 v26, v26
    v_exp_f32 v27, v27
    v_exp_f32 v28, v28
    v_smfmac_f32_32x32x32_bf16 v[48:63], v[124:127], v[16:23], v132
    v_exp_f32 v29, v29
    v_exp_f32 v30, v30
    v_exp_f32 v31, v31
    s_nop 0
L_att_done:
    ds_write_b32 v136, v184
    v_smfmac_f32_32x32x32_bf16 v[48:63], v[128:131], v[24:31], v132
    s_mov_b32 s46, 0x1f800000
    s_mov_b32 s47, 0x5f800000
    v_mov_b32 v144, v40
    v_mov_b32 v156, v40
    s_nop 1
    v_permlane32_swap_b32 v144, v156
    v_cmp_le_f32 vcc, s46, v156
    v_cmp_ge_f32 s[54:55], s47, v156
    s_and_b64 s[54:55], s[54:55], vcc
    s_cmp_eq_u64 s[54:55], -1
    s_cbranch_scc0 L_att_slow0
L_att_fin0:
    v_rcp_f32 v156, v156
    s_nop 0
    v_mul_f32 v32, v32, v156
    v_mul_f32 v33, v33, v156
    v_mul_f32 v34, v34, v156
    v_mul_f32 v35, v35, v156
    v_mul_f32 v36, v36, v156
    v_mul_f32 v37, v37, v156
    v_mul_f32 v38, v38, v156
    v_mul_f32 v39, v39, v156
    v_mul_f32 v40, v40, v156
    v_mul_f32 v41, v41, v156
    v_mul_f32 v42, v42, v156
    v_mul_f32 v43, v43, v156
    v_cvt_pk_bf16_f32 v160, v32, v33
    v_cvt_pk_bf16_f32 v161, v34, v35
    v_cvt_pk_bf16_f32 v162, v36, v37
    v_cvt_pk_bf16_f32 v163, v38, v39
    v_cvt_pk_bf16_f32 v164, v40, v41
    v_cvt_pk_bf16_f32 v165, v42, v43
    buffer_store_dwordx4 v[160:163], v153, s[16:19], s6 offen sc1
    s_add_u32 s6, s6, 40960
    v_mov_b32 v144, v56
    v_mov_b32 v157, v56
    s_nop 1
    v_permlane32_swap_b32 v144, v157
    v_cmp_le_f32 vcc, s46, v157
    v_cmp_ge_f32 s[54:55], s47, v157
    s_and_b64 s[54:55], s[54:55], vcc
    s_cmp_eq_u64 s[54:55], -1
    s_cbranch_scc0 L_att_slow1
L_att_fin1:
    v_rcp_f32 v157, v157
    s_nop 0
    v_mul_f32 v48, v48, v157
    v_mul_f32 v49, v49, v157
    v_mul_f32 v50, v50, v157
    v_mul_f32 v51, v51, v157
    v_mul_f32 v52, v52, v157
    v_mul_f32 v53, v53, v157
    v_mul_f32 v54, v54, v157
    v_mul_f32 v55, v55, v157
    v_mul_f32 v56, v56, v157
    v_mul_f32 v57, v57, v157
    v_mul_f32 v58, v58, v157
    v_mul_f32 v59, v59, v157
    v_cvt_pk_bf16_f32 v168, v48, v49
    v_cvt_pk_bf16_f32 v169, v50, v51
    v_cvt_pk_bf16_f32 v170, v52, v53
    v_cvt_pk_bf16_f32 v171, v54, v55
    v_cvt_pk_bf16_f32 v172, v56, v57
    v_cvt_pk_bf16_f32 v173, v58, v59
    buffer_store_dwordx4 v[168:171], v153, s[16:19], s6 offen sc1
    s_add_u32 s6, s6, 40960
    v_permlane32_swap_b32 v164, v172
    v_permlane32_swap_b32 v165, v173
    buffer_store_dwordx2 v[164:165], v154, s[16:19], s7 offen sc1
    s_lshr_b32 s54, s38, 2
    s_lshl_b32 s54, s54, 8
    s_lshl_b32 s55, s39, 3
    s_add_u32 s54, s54, s55
    s_add_u32 s54, s54, 12288
    s_waitcnt vmcnt(0)
    v_mov_b32 v144, 163772
    v_mov_b32 v145, 1
    s_mov_b64 exec, 1
    ds_add_rtn_u32 v145, v144, v145
    s_waitcnt lgkmcnt(0)
    v_readfirstlane_b32 s63, v145
    s_mov_b64 exec, -1
    s_cmp_lg_u32 s63, 3
    s_cbranch_scc1 L_fin
    s_lshr_b32 s31, s54, 5
    s_mul_i32 s31, s31, 4352
    s_and_b32 s54, s54, 31
    s_add_u32 s54, s54, s31
    s_add_u32 s54, s54, 16777216
    v_mov_b32 v144, s42
    v_mov_b32 v145, s43
    v_lshlrev_b32 v146, 3, v250
    s_mov_b64 exec, 0x1
    buffer_store_dwordx2 v[144:145], v146, s[16:19], s54 offen sc1
    s_mov_b64 exec, -1
    s_mov_b32 s44, 1000000
L_pl_31:
    buffer_load_dwordx2 v[148:149], v158, s[16:19], 0 offen sc1
    s_waitcnt vmcnt(0)
    v_cmp_eq_u64 s[46:47], s[42:43], v[148:149]
    s_cmp_eq_u64 s[46:47], -1
    s_cbranch_scc1 L_pd_32
    s_sleep 5
    s_sub_u32 s44, s44, 1
    s_cmp_lg_u32 s44, 0
    s_cbranch_scc1 L_pl_31
L_pd_32:
    v_mov_b32 v144, 163824
    v_mov_b32 v145, 1
    s_mov_b64 exec, 1
    ds_add_u32 v144, v145
    s_mov_b64 exec, -1
L_fin:
L_end:
    s_endpgm
L_att_c0:
    s_mov_b32 s44, 1000000
    v_mov_b32 v144, 163712
L_lw_33:
    ds_read_b32 v145, v144
    s_waitcnt lgkmcnt(0)
    v_readfirstlane_b32 s45, v145
    s_cmp_ge_u32 s45, 4
    s_cbranch_scc1 L_ld_34
    s_sleep 1
    s_sub_u32 s44, s44, 1
    s_cmp_lg_u32 s44, 0
    s_cbranch_scc1 L_lw_33
L_ld_34:
    s_branch L_att_c0r
L_att_nr0:
    s_mov_b32 s44, 1000000
    v_mov_b32 v144, 163716
L_lw_35:
    ds_read_b32 v145, v144
    s_waitcnt lgkmcnt(0)
    v_readfirstlane_b32 s45, v145
    s_cmp_ge_u32 s45, 4
    s_cbranch_scc1 L_ld_36
    s_sleep 1
    s_sub_u32 s44, s44, 1
    s_cmp_lg_u32 s44, 0
    s_cbranch_scc1 L_lw_35
L_ld_36:
    s_branch L_att_nrr0
L_att_nr1:
    s_mov_b32 s44, 1000000
    v_mov_b32 v144, 163720
L_lw_37:
    ds_read_b32 v145, v144
    s_waitcnt lgkmcnt(0)
    v_readfirstlane_b32 s45, v145
    s_cmp_ge_u32 s45, 4
    s_cbranch_scc1 L_ld_38
    s_sleep 1
    s_sub_u32 s44, s44, 1
    s_cmp_lg_u32 s44, 0
    s_cbranch_scc1 L_lw_37
L_ld_38:
    s_branch L_att_nrr1
L_att_nr2:
    s_mov_b32 s44, 1000000
    v_mov_b32 v144, 163724
L_lw_39:
    ds_read_b32 v145, v144
    s_waitcnt lgkmcnt(0)
    v_readfirstlane_b32 s45, v145
    s_cmp_ge_u32 s45, 4
    s_cbranch_scc1 L_ld_40
    s_sleep 1
    s_sub_u32 s44, s44, 1
    s_cmp_lg_u32 s44, 0
    s_cbranch_scc1 L_lw_39
L_ld_40:
    s_branch L_att_nrr2
L_att_nr3:
    s_mov_b32 s44, 1000000
    v_mov_b32 v144, 163728
L_lw_41:
    ds_read_b32 v145, v144
    s_waitcnt lgkmcnt(0)
    v_readfirstlane_b32 s45, v145
    s_cmp_ge_u32 s45, 4
    s_cbranch_scc1 L_ld_42
    s_sleep 1
    s_sub_u32 s44, s44, 1
    s_cmp_lg_u32 s44, 0
    s_cbranch_scc1 L_lw_41
L_ld_42:
    s_branch L_att_nrr3
L_att_nr4:
    s_mov_b32 s44, 1000000
    v_mov_b32 v144, 163732
L_lw_43:
    ds_read_b32 v145, v144
    s_waitcnt lgkmcnt(0)
    v_readfirstlane_b32 s45, v145
    s_cmp_ge_u32 s45, 4
    s_cbranch_scc1 L_ld_44
    s_sleep 1
    s_sub_u32 s44, s44, 1
    s_cmp_lg_u32 s44, 0
    s_cbranch_scc1 L_lw_43
L_ld_44:
    s_branch L_att_nrr4
L_att_nr5:
    s_mov_b32 s44, 1000000
    v_mov_b32 v144, 163736
L_lw_45:
    ds_read_b32 v145, v144
    s_waitcnt lgkmcnt(0)
    v_readfirstlane_b32 s45, v145
    s_cmp_ge_u32 s45, 4
    s_cbranch_scc1 L_ld_46
    s_sleep 1
    s_sub_u32 s44, s44, 1
    s_cmp_lg_u32 s44, 0
    s_cbranch_scc1 L_lw_45
L_ld_46:
    s_branch L_att_nrr5
L_att_nr6:
    s_mov_b32 s44, 1000000
    v_mov_b32 v144, 163740
L_lw_47:
    ds_read_b32 v145, v144
    s_waitcnt lgkmcnt(0)
    v_readfirstlane_b32 s45, v145
    s_cmp_ge_u32 s45, 4
    s_cbranch_scc1 L_ld_48
    s_sleep 1
    s_sub_u32 s44, s44, 1
    s_cmp_lg_u32 s44, 0
    s_cbranch_scc1 L_lw_47
L_ld_48:
    s_branch L_att_nrr6
L_att_fl0:
    buffer_load_dwordx2 v[148:149], v141, s[16:19], 0 offen sc1
    s_branch L_att_flr0
L_att_ft0:
    s_add_u32 s30, s92, 0
    s_lshr_b32 s30, s30, 1
    s_lshl_b32 s30, 0x00010001, s30
    s_waitcnt vmcnt(0)
    v_cmp_eq_u64 s[46:47], s[42:43], v[148:149]
    s_and_b32 s31, s46, s47
    s_and_b32 s31, s31, s30
    s_cmp_eq_u32 s31, s30
    s_cbranch_scc1 L_att_ft20
    s_mov_b32 s44, 1000000
L_kv_l0:
    buffer_load_dwordx2 v[148:149], v141, s[16:19], 0 offen sc1
    s_waitcnt vmcnt(0)
    v_cmp_eq_u64 s[46:47], s[42:43], v[148:149]
    s_and_b32 s31, s46, s47
    s_and_b32 s31, s31, s30
    s_cmp_eq_u32 s31, s30
    s_cbranch_scc1 L_kv_l0_d
    s_sleep 4
    s_sub_u32 s44, s44, 1
    s_cmp_lg_u32 s44, 0
    s_cbranch_scc1 L_kv_l0
L_kv_l0_d:
L_att_ft20:
    s_cmp_eq_u64 s[46:47], -1
    s_cselect_b32 s61, 2, 1
    s_branch L_att_ftr0
L_att_fl1:
    buffer_load_dwordx2 v[148:149], v141, s[16:19], 0 offen sc1
    s_branch L_att_flr1
L_att_ft1:
    s_add_u32 s30, s92, 4
    s_lshr_b32 s30, s30, 1
    s_lshl_b32 s30, 0x00010001, s30
    s_waitcnt vmcnt(0)
    v_cmp_eq_u64 s[46:47], s[42:43], v[148:149]
    s_and_b32 s31, s46, s47
    s_and_b32 s31, s31, s30
    s_cmp_eq_u32 s31, s30
    s_cbranch_scc1 L_att_ft21
    s_mov_b32 s44, 1000000
L_kv_l1:
    buffer_load_dwordx2 v[148:149], v141, s[16:19], 0 offen sc1
    s_waitcnt vmcnt(0)
    v_cmp_eq_u64 s[46:47], s[42:43], v[148:149]
    s_and_b32 s31, s46, s47
    s_and_b32 s31, s31, s30
    s_cmp_eq_u32 s31, s30
    s_cbranch_scc1 L_kv_l1_d
    s_sleep 4
    s_sub_u32 s44, s44, 1
    s_cmp_lg_u32 s44, 0
    s_cbranch_scc1 L_kv_l1
L_kv_l1_d:
L_att_ft21:
    s_cmp_eq_u64 s[46:47], -1
    s_cselect_b32 s61, 2, 1
    s_branch L_att_ftr1
L_codeend:
L_att_slow0:
    s_waitcnt vmcnt(0) lgkmcnt(0)
    s_nop 15
    v_mov_b32 v152, 0xff800000
    s_mov_b32 s48, 0
    s_mov_b32 s56, s52
L_att_slow10:
    buffer_load_dwordx4 v[76:79], v135, s[16:19], s56 offen offset:0 sc1
    buffer_load_dwordx4 v[92:95], v135, s[16:19], s56 offen offset:2048 sc1
    s_waitcnt vmcnt(0)
    v_mfma_f32_32x32x16_bf16 v[0:15], v[76:79], v[64:67], 0
    v_mfma_f32_32x32x8_bf16 v[0:15], v[92:93], v[72:73], v[0:15]
    s_nop 15
    v_max3_f32 v152, v0, v1, v152
    v_max3_f32 v152, v2, v3, v152
    v_max3_f32 v152, v4, v5, v152
    v_max3_f32 v152, v6, v7, v152
    v_max3_f32 v152, v8, v9, v152
    v_max3_f32 v152, v10, v11, v152
    v_max3_f32 v152, v12, v13, v152
    v_max3_f32 v152, v14, v15, v152
    buffer_load_dwordx4 v[76:79], v135, s[16:19], s56 offen offset:1024 sc1
    buffer_load_dwordx4 v[92:95], v135, s[16:19], s56 offen offset:2048 sc1
    s_waitcnt vmcnt(0)
    v_mfma_f32_32x32x16_bf16 v[0:15], v[76:79], v[64:67], 0
    v_mfma_f32_32x32x8_bf16 v[0:15], v[94:95], v[72:73], v[0:15]
    s_nop 15
    v_max3_f32 v152, v0, v1, v152
    v_max3_f32 v152, v2, v3, v152
    v_max3_f32 v152, v4, v5, v152
    v_max3_f32 v152, v6, v7, v152
    v_max3_f32 v152, v8, v9, v152
    v_max3_f32 v152, v10, v11, v152
    v_max3_f32 v152, v12, v13, v152
    v_max3_f32 v152, v14, v15, v152
    s_add_u32 s56, s56, 5120
    s_add_u32 s48, s48, 1
    s_cmp_lt_u32 s48, 32
    s_cbranch_scc1 L_att_slow10
    v_mov_b32 v144, v152
    s_nop 1
    v_permlane32_swap_b32 v144, v152
    s_nop 1
    v_max_f32 v152, v152, v144
    v_and_b32 v144, 31, v250
    v_lshrrev_b32 v145, 5, v250
    v_mul_u32_u24 v145, 320, v145
    v_lshl_add_u32 v134, v144, 4, v145
    v_mov_b32 v32, 0
    v_mov_b32 v33, 0
    v_mov_b32 v34, 0
    v_mov_b32 v35, 0
    v_mov_b32 v36, 0
    v_mov_b32 v37, 0
    v_mov_b32 v38, 0
    v_mov_b32 v39, 0
    v_mov_b32 v40, 0
    v_mov_b32 v41, 0
    v_mov_b32 v42, 0
    v_mov_b32 v43, 0
    v_mov_b32 v44, 0
    v_mov_b32 v45, 0
    v_mov_b32 v46, 0
    v_mov_b32 v47, 0
    s_mov_b32 s48, 0
    s_mov_b32 s56, s52
L_att_slow20:
    s_add_u32 s57, s56, 2560
    s_mov_b64 exec, s[28:29]
    buffer_load_dwordx4 v[100:103], v134, s[16:19], s57 offen sc1
    buffer_load_dwordx4 v[104:107], v134, s[16:19], s57 offen offset:640 sc1
    s_mov_b64 exec, -1
    buffer_load_dwordx4 v[76:79], v135, s[16:19], s56 offen offset:0 sc1
    buffer_load_dwordx4 v[92:95], v135, s[16:19], s56 offen offset:2048 sc1
    s_waitcnt vmcnt(0)
    v_mfma_f32_32x32x16_bf16 v[0:15], v[76:79], v[64:67], 0
    v_mfma_f32_32x32x8_bf16 v[0:15], v[92:93], v[72:73], v[0:15]
    s_nop 15
    v_sub_f32 v0, v0, v152
    v_sub_f32 v1, v1, v152
    v_sub_f32 v2, v2, v152
    v_sub_f32 v3, v3, v152
    v_sub_f32 v4, v4, v152
    v_sub_f32 v5, v5, v152
    v_sub_f32 v6, v6, v152
    v_sub_f32 v7, v7, v152
    v_sub_f32 v8, v8, v152
    v_sub_f32 v9, v9, v152
    v_sub_f32 v10, v10, v152
    v_sub_f32 v11, v11, v152
    v_sub_f32 v12, v12, v152
    v_sub_f32 v13, v13, v152
    v_sub_f32 v14, v14, v152
    v_sub_f32 v15, v15, v152
    v_exp_f32 v0, v0
    v_exp_f32 v1, v1
    v_exp_f32 v2, v2
    v_exp_f32 v3, v3
    v_exp_f32 v4, v4
    v_exp_f32 v5, v5
    v_exp_f32 v6, v6
    v_exp_f32 v7, v7
    v_exp_f32 v8, v8
    v_exp_f32 v9, v9
    v_exp_f32 v10, v10
    v_exp_f32 v11, v11
    v_exp_f32 v12, v12
    v_exp_f32 v13, v13
    v_exp_f32 v14, v14
    v_exp_f32 v15, v15
    s_nop 2
    v_smfmac_f32_32x32x32_bf16 v[32:47], v[100:103], v[0:7], v132
    v_smfmac_f32_32x32x32_bf16 v[32:47], v[104:107], v[8:15], v132
    s_nop 15
    s_add_u32 s57, s56, 3840
    s_mov_b64 exec, s[28:29]
    buffer_load_dwordx4 v[100:103], v134, s[16:19], s57 offen sc1
    buffer_load_dwordx4 v[104:107], v134, s[16:19], s57 offen offset:640 sc1
    s_mov_b64 exec, -1
    buffer_load_dwordx4 v[76:79], v135, s[16:19], s56 offen offset:1024 sc1
    buffer_load_dwordx4 v[92:95], v135, s[16:19], s56 offen offset:2048 sc1
    s_waitcnt vmcnt(0)
    v_mfma_f32_32x32x16_bf16 v[0:15], v[76:79], v[64:67], 0
    v_mfma_f32_32x32x8_bf16 v[0:15], v[94:95], v[72:73], v[0:15]
    s_nop 15
    v_sub_f32 v0, v0, v152
    v_sub_f32 v1, v1, v152
    v_sub_f32 v2, v2, v152
    v_sub_f32 v3, v3, v152
    v_sub_f32 v4, v4, v152
    v_sub_f32 v5, v5, v152
    v_sub_f32 v6, v6, v152
    v_sub_f32 v7, v7, v152
    v_sub_f32 v8, v8, v152
    v_sub_f32 v9, v9, v152
    v_sub_f32 v10, v10, v152
    v_sub_f32 v11, v11, v152
    v_sub_f32 v12, v12, v152
    v_sub_f32 v13, v13, v152
    v_sub_f32 v14, v14, v152
    v_sub_f32 v15, v15, v152
    v_exp_f32 v0, v0
    v_exp_f32 v1, v1
    v_exp_f32 v2, v2
    v_exp_f32 v3, v3
    v_exp_f32 v4, v4
    v_exp_f32 v5, v5
    v_exp_f32 v6, v6
    v_exp_f32 v7, v7
    v_exp_f32 v8, v8
    v_exp_f32 v9, v9
    v_exp_f32 v10, v10
    v_exp_f32 v11, v11
    v_exp_f32 v12, v12
    v_exp_f32 v13, v13
    v_exp_f32 v14, v14
    v_exp_f32 v15, v15
    s_nop 2
    v_smfmac_f32_32x32x32_bf16 v[32:47], v[100:103], v[0:7], v132
    v_smfmac_f32_32x32x32_bf16 v[32:47], v[104:107], v[8:15], v132
    s_nop 15
    s_add_u32 s56, s56, 5120
    s_add_u32 s48, s48, 1
    s_cmp_lt_u32 s48, 32
    s_cbranch_scc1 L_att_slow20
    v_mov_b32 v144, v40
    v_mov_b32 v156, v40
    s_nop 1
    v_permlane32_swap_b32 v144, v156
    s_nop 1
    s_branch L_att_fin0
L_att_slow1:
    s_waitcnt vmcnt(0) lgkmcnt(0)
    s_nop 15
    v_mov_b32 v152, 0xff800000
    s_mov_b32 s48, 0
    s_mov_b32 s56, s52
L_att_slow11:
    buffer_load_dwordx4 v[76:79], v135, s[16:19], s56 offen offset:0 sc1
    buffer_load_dwordx4 v[92:95], v135, s[16:19], s56 offen offset:2048 sc1
    s_waitcnt vmcnt(0)
    v_mfma_f32_32x32x16_bf16 v[0:15], v[76:79], v[68:71], 0
    v_mfma_f32_32x32x8_bf16 v[0:15], v[92:93], v[74:75], v[0:15]
    s_nop 15
    v_max3_f32 v152, v0, v1, v152
    v_max3_f32 v152, v2, v3, v152
    v_max3_f32 v152, v4, v5, v152
    v_max3_f32 v152, v6, v7, v152
    v_max3_f32 v152, v8, v9, v152
    v_max3_f32 v152, v10, v11, v152
    v_max3_f32 v152, v12, v13, v152
    v_max3_f32 v152, v14, v15, v152
    buffer_load_dwordx4 v[76:79], v135, s[16:19], s56 offen offset:1024 sc1
    buffer_load_dwordx4 v[92:95], v135, s[16:19], s56 offen offset:2048 sc1
    s_waitcnt vmcnt(0)
    v_mfma_f32_32x32x16_bf16 v[0:15], v[76:79], v[68:71], 0
    v_mfma_f32_32x32x8_bf16 v[0:15], v[94:95], v[74:75], v[0:15]
    s_nop 15
    v_max3_f32 v152, v0, v1, v152
    v_max3_f32 v152, v2, v3, v152
    v_max3_f32 v152, v4, v5, v152
    v_max3_f32 v152, v6, v7, v152
    v_max3_f32 v152, v8, v9, v152
    v_max3_f32 v152, v10, v11, v152
    v_max3_f32 v152, v12, v13, v152
    v_max3_f32 v152, v14, v15, v152
    s_add_u32 s56, s56, 5120
    s_add_u32 s48, s48, 1
    s_cmp_lt_u32 s48, 32
    s_cbranch_scc1 L_att_slow11
    v_mov_b32 v144, v152
    s_nop 1
    v_permlane32_swap_b32 v144, v152
    s_nop 1
    v_max_f32 v152, v152, v144
    v_and_b32 v144, 31, v250
    v_lshrrev_b32 v145, 5, v250
    v_mul_u32_u24 v145, 320, v145
    v_lshl_add_u32 v134, v144, 4, v145
    v_mov_b32 v48, 0
    v_mov_b32 v49, 0
    v_mov_b32 v50, 0
    v_mov_b32 v51, 0
    v_mov_b32 v52, 0
    v_mov_b32 v53, 0
    v_mov_b32 v54, 0
    v_mov_b32 v55, 0
    v_mov_b32 v56, 0
    v_mov_b32 v57, 0
    v_mov_b32 v58, 0
    v_mov_b32 v59, 0
    v_mov_b32 v60, 0
    v_mov_b32 v61, 0
    v_mov_b32 v62, 0
    v_mov_b32 v63, 0
    s_mov_b32 s48, 0
    s_mov_b32 s56, s52
L_att_slow21:
    s_add_u32 s57, s56, 2560
    s_mov_b64 exec, s[28:29]
    buffer_load_dwordx4 v[100:103], v134, s[16:19], s57 offen sc1
    buffer_load_dwordx4 v[104:107], v134, s[16:19], s57 offen offset:640 sc1
    s_mov_b64 exec, -1
    buffer_load_dwordx4 v[76:79], v135, s[16:19], s56 offen offset:0 sc1
    buffer_load_dwordx4 v[92:95], v135, s[16:19], s56 offen offset:2048 sc1
    s_waitcnt vmcnt(0)
    v_mfma_f32_32x32x16_bf16 v[0:15], v[76:79], v[68:71], 0
    v_mfma_f32_32x32x8_bf16 v[0:15], v[92:93], v[74:75], v[0:15]
    s_nop 15
    v_sub_f32 v0, v0, v152
    v_sub_f32 v1, v1, v152
    v_sub_f32 v2, v2, v152
    v_sub_f32 v3, v3, v152
    v_sub_f32 v4, v4, v152
    v_sub_f32 v5, v5, v152
    v_sub_f32 v6, v6, v152
    v_sub_f32 v7, v7, v152
    v_sub_f32 v8, v8, v152
    v_sub_f32 v9, v9, v152
    v_sub_f32 v10, v10, v152
    v_sub_f32 v11, v11, v152
    v_sub_f32 v12, v12, v152
    v_sub_f32 v13, v13, v152
    v_sub_f32 v14, v14, v152
    v_sub_f32 v15, v15, v152
    v_exp_f32 v0, v0
    v_exp_f32 v1, v1
    v_exp_f32 v2, v2
    v_exp_f32 v3, v3
    v_exp_f32 v4, v4
    v_exp_f32 v5, v5
    v_exp_f32 v6, v6
    v_exp_f32 v7, v7
    v_exp_f32 v8, v8
    v_exp_f32 v9, v9
    v_exp_f32 v10, v10
    v_exp_f32 v11, v11
    v_exp_f32 v12, v12
    v_exp_f32 v13, v13
    v_exp_f32 v14, v14
    v_exp_f32 v15, v15
    s_nop 2
    v_smfmac_f32_32x32x32_bf16 v[48:63], v[100:103], v[0:7], v132
    v_smfmac_f32_32x32x32_bf16 v[48:63], v[104:107], v[8:15], v132
    s_nop 15
    s_add_u32 s57, s56, 3840
    s_mov_b64 exec, s[28:29]
    buffer_load_dwordx4 v[100:103], v134, s[16:19], s57 offen sc1
    buffer_load_dwordx4 v[104:107], v134, s[16:19], s57 offen offset:640 sc1
    s_mov_b64 exec, -1
    buffer_load_dwordx4 v[76:79], v135, s[16:19], s56 offen offset:1024 sc1
    buffer_load_dwordx4 v[92:95], v135, s[16:19], s56 offen offset:2048 sc1
    s_waitcnt vmcnt(0)
    v_mfma_f32_32x32x16_bf16 v[0:15], v[76:79], v[68:71], 0
    v_mfma_f32_32x32x8_bf16 v[0:15], v[94:95], v[74:75], v[0:15]
    s_nop 15
    v_sub_f32 v0, v0, v152
    v_sub_f32 v1, v1, v152
    v_sub_f32 v2, v2, v152
    v_sub_f32 v3, v3, v152
    v_sub_f32 v4, v4, v152
    v_sub_f32 v5, v5, v152
    v_sub_f32 v6, v6, v152
    v_sub_f32 v7, v7, v152
    v_sub_f32 v8, v8, v152
    v_sub_f32 v9, v9, v152
    v_sub_f32 v10, v10, v152
    v_sub_f32 v11, v11, v152
    v_sub_f32 v12, v12, v152
    v_sub_f32 v13, v13, v152
    v_sub_f32 v14, v14, v152
    v_sub_f32 v15, v15, v152
    v_exp_f32 v0, v0
    v_exp_f32 v1, v1
    v_exp_f32 v2, v2
    v_exp_f32 v3, v3
    v_exp_f32 v4, v4
    v_exp_f32 v5, v5
    v_exp_f32 v6, v6
    v_exp_f32 v7, v7
    v_exp_f32 v8, v8
    v_exp_f32 v9, v9
    v_exp_f32 v10, v10
    v_exp_f32 v11, v11
    v_exp_f32 v12, v12
    v_exp_f32 v13, v13
    v_exp_f32 v14, v14
    v_exp_f32 v15, v15
    s_nop 2
    v_smfmac_f32_32x32x32_bf16 v[48:63], v[100:103], v[0:7], v132
    v_smfmac_f32_32x32x32_bf16 v[48:63], v[104:107], v[8:15], v132
    s_nop 15
    s_add_u32 s56, s56, 5120
    s_add_u32 s48, s48, 1
    s_cmp_lt_u32 s48, 32
    s_cbranch_scc1 L_att_slow21
    v_mov_b32 v144, v56
    v_mov_b32 v157, v56
    s_nop 1
    v_permlane32_swap_b32 v144, v157
    s_nop 1
    s_branch L_att_fin1
.section .rodata,"a"
.p2align 6
.amdhsa_kernel concat_heads__ssm_conv_s4d__mha_block__prompt_kernel
  .amdhsa_next_free_vgpr 256
  .amdhsa_next_free_sgpr 102
  .amdhsa_accum_offset 256
  .amdhsa_group_segment_fixed_size 0
  .amdhsa_kernarg_size 104
  .amdhsa_user_sgpr_count 2
  .amdhsa_user_sgpr_kernarg_segment_ptr 1
  .amdhsa_system_sgpr_workgroup_id_x 1
.end_amdhsa_kernel
```
